```python
import torch

def _softmax(x, axis=-1):
    return torch.softmax(x, dim=axis)

def _gelu(x):
    return torch.nn.functional.gelu(x, approximate='tanh')

def _silu(x):
    return torch.nn.functional.silu(x)

def _sigmoid(x):
    return torch.sigmoid(x)

def _layernorm(x, axis=-1, eps=1e-05):
    m = x.mean(dim=axis, keepdim=True)
    v = x.var(dim=axis, keepdim=True, unbiased=False)
    return (x - m) / torch.sqrt(v + eps)

def _scatter_add(tgt, idx, src, axis=0):
    return tgt.clone().index_add_(axis, idx, src)

def _segment_sum(src, seg, n):
    out = torch.zeros((n,) + src.shape[1:], dtype=src.dtype)
    return out.index_add_(0, seg, src)

def _pad(x, pw):
    flat = tuple((v for pair in reversed(pw) for v in pair))
    return torch.nn.functional.pad(x, flat)
kernel_name = 'adaLN_cond__ssm_conv_s4__dense_activation_silu__prompt'

def setup_inputs():

    _w = lambda a: (lambda t: t.to(torch.bfloat16) if t.is_floating_point() else t)(torch.as_tensor(a))

    def _A_setup():
        B, L, D, N = (1, 2048, 576, 128)
        A_re = -(lambda _x: torch.exp(torch.as_tensor(_x)))((lambda *s: torch.randn(*s, dtype=torch.bfloat16) * 3.2)(D, N))
        A_im = torch.pi * (lambda *s: torch.randn(*s, dtype=torch.bfloat16) * 0.05)(D, N)
        B_re = (lambda *s: torch.randn(*s, dtype=torch.bfloat16) * 0.1)(D, N)
        B_im = (lambda *s: torch.randn(*s, dtype=torch.bfloat16) * 0.1)(D, N)
        C_re = (lambda *s: torch.randn(*s, dtype=torch.bfloat16) * 0.1)(D, N)
        C_im = (lambda *s: torch.randn(*s, dtype=torch.bfloat16) * 0.1)(D, N)
        log_dt = (lambda *s: torch.randn(*s, dtype=torch.bfloat16) * 0.05)(D) * 0.5 - 4.0
        Dskip = (lambda *s: torch.randn(*s, dtype=torch.bfloat16) * 0.05)(D)
        return {'u': _w((lambda *s: torch.randn(*s, dtype=torch.bfloat16) * 0.05)(B, L, D)), 'A_re': _w(A_re), 'A_im': _w(A_im), 'B_re': _w(B_re), 'B_im': _w(B_im), 'C_re': _w(C_re), 'C_im': _w(C_im), 'log_dt': _w(log_dt), 'Dskip': _w(Dskip)}
    _A_in = _A_setup()

    def _B_setup():
        B, S, D, F = (1, 2048, 576, 4608)
        return {'x': _w((lambda *s: torch.randn(*s, dtype=torch.bfloat16) * 0.05)(B, S, D)), 'w1': _w((lambda *s: torch.randn(*s, dtype=torch.bfloat16) * 3.2)(D, F) * D ** (-0.5)), 'w2': _w((lambda *s: torch.randn(*s, dtype=torch.bfloat16) * 0.4)(F, D) * F ** (-0.5))}
    _B_in = _B_setup()
    return {'A_u': _A_in['u'], 'A_A_re': _A_in['A_re'], 'A_A_im': _A_in['A_im'], 'A_B_re': _A_in['B_re'], 'A_B_im': _A_in['B_im'], 'A_C_re': _A_in['C_re'], 'A_C_im': _A_in['C_im'], 'A_log_dt': _A_in['log_dt'], 'A_Dskip': _A_in['Dskip'], 'B_x': _B_in['x'], 'B_w1': _B_in['w1'], 'B_w2': _B_in['w2'], 'c': _w((lambda *s: torch.randn(*s, dtype=torch.bfloat16) * 0.2)(1, 576) * 8.0), 'w_mod': _w((lambda *s: torch.randn(*s, dtype=torch.bfloat16) * 0.2)(576, 6 * 576) * 576 ** (-0.5) * 8.0)}

def reference(A_u, A_A_re, A_A_im, A_B_re, A_B_im, A_C_re, A_C_im, A_log_dt, A_Dskip, B_x, B_w1, B_w2, c, w_mod):

    def _A_ref(u, A_re, A_im, B_re, B_im, C_re, C_im, log_dt, Dskip):
        Bsz, L, D = u.shape
        dt = torch.exp(log_dt)[:, None]
        A = A_re + 1j * A_im
        Bc = B_re + 1j * B_im
        Cc = C_re + 1j * C_im
        logdA = dt * A
        dB = dt * Bc
        l = (lambda x, dt: x.to(dt))(torch.arange(L), A_re.dtype)
        P = torch.exp(logdA[:, :, None] * l[None, None, :])
        K = torch.einsum('dn,dnl,dn->dl', Cc, P, dB).real
        L2 = 2 * L
        Kp = _pad(K, ((0, 0), (0, L)))
        up = (lambda x, *d: x.permute(*d))(u, 0, 2, 1)
        up = _pad(up, ((0, 0), (0, 0), (0, L)))
        Kf = (lambda x, axes=(-2, -1): torch.fft.rfft2(x.float(), dim=axes))(Kp[:, None, :], axes=(-2, -1))
        Uf = (lambda x, axes=(-2, -1): torch.fft.rfft2(x.float(), dim=axes))(up[:, :, None, :], axes=(-2, -1))
        Yf = Uf * Kf[None, :, :, :]
        y = (lambda x, s, axes=(-2, -1): torch.fft.irfft2(x, s=s, dim=axes).to(torch.bfloat16))(Yf, (1, L2), axes=(-2, -1))[:, :, 0, :L]
        y = (lambda x, *d: x.permute(*d))(y, 0, 2, 1) + u * Dskip[None, None, :]
        return y

    def _B_ref(x, w1, w2):
        h = torch.einsum('bsd,df->bsf', x, w1)
        h = _silu(h)
        out = torch.einsum('bsf,fd->bsd', h, w2)
        return out
    x = A_u
    mod = (_silu(c) @ w_mod).reshape(c.shape[0], 6, 1, -1)
    sa, ca, ga, sb, cb, gb = (mod[:, 0].clone(), mod[:, 1].clone(), mod[:, 2].clone(), mod[:, 3].clone(), mod[:, 4].clone(), mod[:, 5].clone())
    h = _layernorm(x, axis=-1) * (1 + ca) + sa
    x = x + ga * _A_ref(h, A_A_re, A_A_im, A_B_re, A_B_im, A_C_re, A_C_im, A_log_dt, A_Dskip)
    h = _layernorm(x, axis=-1) * (1 + cb) + sb
    x = x + gb * _B_ref(h, B_w1, B_w2)
    return x
```

```asm
; @launch kernel=prep_kernel grid=(1063,1,1) block=(256,1,1) lds=36864
; @launch kernel=conv_kernel grid=(576,1,1) block=(256,1,1) lds=76800
; @launch kernel=ln2_kernel grid=(64,1,1) block=(256,1,1) lds=37376
; @launch kernel=gemm1_kernel grid=(256,1,1) block=(256,1,1) lds=161792
; @launch kernel=gemm2_kernel grid=(256,1,1) block=(256,1,1) lds=106496
; @launch kernel=reduce_kernel grid=(576,1,1) block=(256,1,1) lds=0
.amdgcn_target "amdgcn-amd-amdhsa--gfx950"
.text
.globl prep_kernel
.p2align 8
.type prep_kernel,@function
prep_kernel:
    s_cmp_ge_u32 s2, 1063
    s_cbranch_scc1 L_prep_end
    s_load_dwordx2 s[4:5], s[0:1], 128
    s_cmp_ge_u32 s2, 1036
    s_cbranch_scc1 L_role_mod
    s_cmp_ge_u32 s2, 972
    s_cbranch_scc1 L_role_st
    s_cmp_ge_u32 s2, 900
    s_cbranch_scc1 L_role_xt
    s_cmp_ge_u32 s2, 738
    s_cbranch_scc1 L_role_w2
    s_cmp_ge_u32 s2, 576
    s_cbranch_scc1 L_role_w1
    s_branch L_role_kgen

L_role_mod:
    s_load_dwordx2 s[6:7], s[0:1], 96
    s_load_dwordx2 s[8:9], s[0:1], 104
    s_sub_u32 s3, s2, 1036
    s_waitcnt lgkmcnt(0)

    s_mov_b32 s12, s6
    s_mov_b32 s13, s7
    s_mov_b32 s14, 1152
    s_mov_b32 s15, 0x00020000
    s_mov_b32 s16, s8
    s_mov_b32 s17, s9
    s_mov_b32 s18, 3981312
    s_mov_b32 s19, 0x00020000
    s_mov_b32 s20, s4
    s_mov_b32 s21, s5
    s_mov_b32 s22, 13824
    s_mov_b32 s23, 0x00020000
    s_mov_b32 s60, 0x3fb8aa3b
    v_add_u32 v1, 0, v0
    v_lshlrev_b32 v2, 1, v1
    buffer_load_ushort v3, v2, s[12:15], 0 offen
    s_waitcnt vmcnt(0)
    v_lshlrev_b32 v3, 16, v3
    v_mul_f32 v4, s60, v3
    v_sub_f32 v4, 0, v4
    v_exp_f32 v4, v4
    s_nop 0
    v_add_f32 v4, 1.0, v4
    v_rcp_f32 v4, v4
    s_nop 0
    v_mul_f32 v4, v3, v4

    v_cvt_pk_bf16_f32 v4, v4, v4
    v_lshlrev_b32 v4, 16, v4
    v_lshlrev_b32 v5, 2, v1
    v_cmp_gt_u32 vcc, 576, v1
    s_and_saveexec_b64 s[24:25], vcc
    ds_write_b32 v5, v4
    s_mov_b64 exec, s[24:25]

    v_add_u32 v1, 256, v0
    v_lshlrev_b32 v2, 1, v1
    buffer_load_ushort v3, v2, s[12:15], 0 offen
    s_waitcnt vmcnt(0)
    v_lshlrev_b32 v3, 16, v3
    v_mul_f32 v4, s60, v3
    v_sub_f32 v4, 0, v4
    v_exp_f32 v4, v4
    s_nop 0
    v_add_f32 v4, 1.0, v4
    v_rcp_f32 v4, v4
    s_nop 0
    v_mul_f32 v4, v3, v4

    v_cvt_pk_bf16_f32 v4, v4, v4
    v_lshlrev_b32 v4, 16, v4
    v_lshlrev_b32 v5, 2, v1
    v_cmp_gt_u32 vcc, 576, v1
    s_and_saveexec_b64 s[24:25], vcc
    ds_write_b32 v5, v4
    s_mov_b64 exec, s[24:25]

    v_add_u32 v1, 512, v0
    v_lshlrev_b32 v2, 1, v1
    buffer_load_ushort v3, v2, s[12:15], 0 offen
    s_waitcnt vmcnt(0)
    v_lshlrev_b32 v3, 16, v3
    v_mul_f32 v4, s60, v3
    v_sub_f32 v4, 0, v4
    v_exp_f32 v4, v4
    s_nop 0
    v_add_f32 v4, 1.0, v4
    v_rcp_f32 v4, v4
    s_nop 0
    v_mul_f32 v4, v3, v4

    v_cvt_pk_bf16_f32 v4, v4, v4
    v_lshlrev_b32 v4, 16, v4
    v_lshlrev_b32 v5, 2, v1
    v_cmp_gt_u32 vcc, 576, v1
    s_and_saveexec_b64 s[24:25], vcc
    ds_write_b32 v5, v4
    s_mov_b64 exec, s[24:25]

    s_waitcnt lgkmcnt(0)
    s_barrier
    v_and_b32 v1, 15, v0
    v_lshrrev_b32 v2, 4, v0
    s_lshl_b32 s26, s3, 8
    v_lshlrev_b32 v3, 4, v1
    v_add_u32 v3, s26, v3
    v_mul_u32_u24 v4, 248832, v2
    v_add_u32 v3, v3, v4
    v_mul_u32_u24 v5, 144, v2

    v_mov_b32 v8, 0
    v_mov_b32 v9, 0
    v_mov_b32 v10, 0
    v_mov_b32 v11, 0
    v_mov_b32 v12, 0
    v_mov_b32 v13, 0
    v_mov_b32 v14, 0
    v_mov_b32 v15, 0
    s_mov_b32 s61, 0xffff0000
    v_add_u32 v6, 0, v3
    buffer_load_dwordx4 v[40:43], v6, s[16:19], 0 offen
    v_add_u32 v6, 6912, v3
    buffer_load_dwordx4 v[44:47], v6, s[16:19], 0 offen
    v_add_u32 v6, 13824, v3
    buffer_load_dwordx4 v[48:51], v6, s[16:19], 0 offen
    v_add_u32 v6, 20736, v3
    buffer_load_dwordx4 v[52:55], v6, s[16:19], 0 offen
    v_add_u32 v6, 27648, v3
    buffer_load_dwordx4 v[56:59], v6, s[16:19], 0 offen
    v_add_u32 v6, 34560, v3
    buffer_load_dwordx4 v[60:63], v6, s[16:19], 0 offen
    v_add_u32 v6, 41472, v3
    buffer_load_dwordx4 v[64:67], v6, s[16:19], 0 offen
    v_add_u32 v6, 48384, v3
    buffer_load_dwordx4 v[68:71], v6, s[16:19], 0 offen
    v_add_u32 v6, 55296, v3
    buffer_load_dwordx4 v[72:75], v6, s[16:19], 0 offen
    v_add_u32 v6, 62208, v3
    buffer_load_dwordx4 v[76:79], v6, s[16:19], 0 offen
    v_add_u32 v6, 69120, v3
    buffer_load_dwordx4 v[80:83], v6, s[16:19], 0 offen
    v_add_u32 v6, 76032, v3
    buffer_load_dwordx4 v[84:87], v6, s[16:19], 0 offen
    ds_read_b128 v[100:103], v5 offset:0
    ds_read_b128 v[104:107], v5 offset:16
    ds_read_b128 v[108:111], v5 offset:32
    s_waitcnt lgkmcnt(0)
    s_waitcnt vmcnt(11)
    v_lshlrev_b32 v20, 16, v40
    v_and_b32 v21, s61, v40
    v_fmac_f32 v8, v20, v100
    v_fmac_f32 v9, v21, v100
    v_lshlrev_b32 v20, 16, v41
    v_and_b32 v21, s61, v41
    v_fmac_f32 v10, v20, v100
    v_fmac_f32 v11, v21, v100
    v_lshlrev_b32 v20, 16, v42
    v_and_b32 v21, s61, v42
    v_fmac_f32 v12, v20, v100
    v_fmac_f32 v13, v21, v100
    v_lshlrev_b32 v20, 16, v43
    v_and_b32 v21, s61, v43
    v_fmac_f32 v14, v20, v100
    v_fmac_f32 v15, v21, v100
    s_waitcnt vmcnt(10)
    v_lshlrev_b32 v20, 16, v44
    v_and_b32 v21, s61, v44
    v_fmac_f32 v8, v20, v101
    v_fmac_f32 v9, v21, v101
    v_lshlrev_b32 v20, 16, v45
    v_and_b32 v21, s61, v45
    v_fmac_f32 v10, v20, v101
    v_fmac_f32 v11, v21, v101
    v_lshlrev_b32 v20, 16, v46
    v_and_b32 v21, s61, v46
    v_fmac_f32 v12, v20, v101
    v_fmac_f32 v13, v21, v101
    v_lshlrev_b32 v20, 16, v47
    v_and_b32 v21, s61, v47
    v_fmac_f32 v14, v20, v101
    v_fmac_f32 v15, v21, v101
    s_waitcnt vmcnt(9)
    v_lshlrev_b32 v20, 16, v48
    v_and_b32 v21, s61, v48
    v_fmac_f32 v8, v20, v102
    v_fmac_f32 v9, v21, v102
    v_lshlrev_b32 v20, 16, v49
    v_and_b32 v21, s61, v49
    v_fmac_f32 v10, v20, v102
    v_fmac_f32 v11, v21, v102
    v_lshlrev_b32 v20, 16, v50
    v_and_b32 v21, s61, v50
    v_fmac_f32 v12, v20, v102
    v_fmac_f32 v13, v21, v102
    v_lshlrev_b32 v20, 16, v51
    v_and_b32 v21, s61, v51
    v_fmac_f32 v14, v20, v102
    v_fmac_f32 v15, v21, v102
    s_waitcnt vmcnt(8)
    v_lshlrev_b32 v20, 16, v52
    v_and_b32 v21, s61, v52
    v_fmac_f32 v8, v20, v103
    v_fmac_f32 v9, v21, v103
    v_lshlrev_b32 v20, 16, v53
    v_and_b32 v21, s61, v53
    v_fmac_f32 v10, v20, v103
    v_fmac_f32 v11, v21, v103
    v_lshlrev_b32 v20, 16, v54
    v_and_b32 v21, s61, v54
    v_fmac_f32 v12, v20, v103
    v_fmac_f32 v13, v21, v103
    v_lshlrev_b32 v20, 16, v55
    v_and_b32 v21, s61, v55
    v_fmac_f32 v14, v20, v103
    v_fmac_f32 v15, v21, v103
    s_waitcnt vmcnt(7)
    v_lshlrev_b32 v20, 16, v56
    v_and_b32 v21, s61, v56
    v_fmac_f32 v8, v20, v104
    v_fmac_f32 v9, v21, v104
    v_lshlrev_b32 v20, 16, v57
    v_and_b32 v21, s61, v57
    v_fmac_f32 v10, v20, v104
    v_fmac_f32 v11, v21, v104
    v_lshlrev_b32 v20, 16, v58
    v_and_b32 v21, s61, v58
    v_fmac_f32 v12, v20, v104
    v_fmac_f32 v13, v21, v104
    v_lshlrev_b32 v20, 16, v59
    v_and_b32 v21, s61, v59
    v_fmac_f32 v14, v20, v104
    v_fmac_f32 v15, v21, v104
    s_waitcnt vmcnt(6)
    v_lshlrev_b32 v20, 16, v60
    v_and_b32 v21, s61, v60
    v_fmac_f32 v8, v20, v105
    v_fmac_f32 v9, v21, v105
    v_lshlrev_b32 v20, 16, v61
    v_and_b32 v21, s61, v61
    v_fmac_f32 v10, v20, v105
    v_fmac_f32 v11, v21, v105
    v_lshlrev_b32 v20, 16, v62
    v_and_b32 v21, s61, v62
    v_fmac_f32 v12, v20, v105
    v_fmac_f32 v13, v21, v105
    v_lshlrev_b32 v20, 16, v63
    v_and_b32 v21, s61, v63
    v_fmac_f32 v14, v20, v105
    v_fmac_f32 v15, v21, v105
    s_waitcnt vmcnt(5)
    v_lshlrev_b32 v20, 16, v64
    v_and_b32 v21, s61, v64
    v_fmac_f32 v8, v20, v106
    v_fmac_f32 v9, v21, v106
    v_lshlrev_b32 v20, 16, v65
    v_and_b32 v21, s61, v65
    v_fmac_f32 v10, v20, v106
    v_fmac_f32 v11, v21, v106
    v_lshlrev_b32 v20, 16, v66
    v_and_b32 v21, s61, v66
    v_fmac_f32 v12, v20, v106
    v_fmac_f32 v13, v21, v106
    v_lshlrev_b32 v20, 16, v67
    v_and_b32 v21, s61, v67
    v_fmac_f32 v14, v20, v106
    v_fmac_f32 v15, v21, v106
    s_waitcnt vmcnt(4)
    v_lshlrev_b32 v20, 16, v68
    v_and_b32 v21, s61, v68
    v_fmac_f32 v8, v20, v107
    v_fmac_f32 v9, v21, v107
    v_lshlrev_b32 v20, 16, v69
    v_and_b32 v21, s61, v69
    v_fmac_f32 v10, v20, v107
    v_fmac_f32 v11, v21, v107
    v_lshlrev_b32 v20, 16, v70
    v_and_b32 v21, s61, v70
    v_fmac_f32 v12, v20, v107
    v_fmac_f32 v13, v21, v107
    v_lshlrev_b32 v20, 16, v71
    v_and_b32 v21, s61, v71
    v_fmac_f32 v14, v20, v107
    v_fmac_f32 v15, v21, v107
    s_waitcnt vmcnt(3)
    v_lshlrev_b32 v20, 16, v72
    v_and_b32 v21, s61, v72
    v_fmac_f32 v8, v20, v108
    v_fmac_f32 v9, v21, v108
    v_lshlrev_b32 v20, 16, v73
    v_and_b32 v21, s61, v73
    v_fmac_f32 v10, v20, v108
    v_fmac_f32 v11, v21, v108
    v_lshlrev_b32 v20, 16, v74
    v_and_b32 v21, s61, v74
    v_fmac_f32 v12, v20, v108
    v_fmac_f32 v13, v21, v108
    v_lshlrev_b32 v20, 16, v75
    v_and_b32 v21, s61, v75
    v_fmac_f32 v14, v20, v108
    v_fmac_f32 v15, v21, v108
    s_waitcnt vmcnt(2)
    v_lshlrev_b32 v20, 16, v76
    v_and_b32 v21, s61, v76
    v_fmac_f32 v8, v20, v109
    v_fmac_f32 v9, v21, v109
    v_lshlrev_b32 v20, 16, v77
    v_and_b32 v21, s61, v77
    v_fmac_f32 v10, v20, v109
    v_fmac_f32 v11, v21, v109
    v_lshlrev_b32 v20, 16, v78
    v_and_b32 v21, s61, v78
    v_fmac_f32 v12, v20, v109
    v_fmac_f32 v13, v21, v109
    v_lshlrev_b32 v20, 16, v79
    v_and_b32 v21, s61, v79
    v_fmac_f32 v14, v20, v109
    v_fmac_f32 v15, v21, v109
    s_waitcnt vmcnt(1)
    v_lshlrev_b32 v20, 16, v80
    v_and_b32 v21, s61, v80
    v_fmac_f32 v8, v20, v110
    v_fmac_f32 v9, v21, v110
    v_lshlrev_b32 v20, 16, v81
    v_and_b32 v21, s61, v81
    v_fmac_f32 v10, v20, v110
    v_fmac_f32 v11, v21, v110
    v_lshlrev_b32 v20, 16, v82
    v_and_b32 v21, s61, v82
    v_fmac_f32 v12, v20, v110
    v_fmac_f32 v13, v21, v110
    v_lshlrev_b32 v20, 16, v83
    v_and_b32 v21, s61, v83
    v_fmac_f32 v14, v20, v110
    v_fmac_f32 v15, v21, v110
    s_waitcnt vmcnt(0)
    v_lshlrev_b32 v20, 16, v84
    v_and_b32 v21, s61, v84
    v_fmac_f32 v8, v20, v111
    v_fmac_f32 v9, v21, v111
    v_lshlrev_b32 v20, 16, v85
    v_and_b32 v21, s61, v85
    v_fmac_f32 v10, v20, v111
    v_fmac_f32 v11, v21, v111
    v_lshlrev_b32 v20, 16, v86
    v_and_b32 v21, s61, v86
    v_fmac_f32 v12, v20, v111
    v_fmac_f32 v13, v21, v111
    v_lshlrev_b32 v20, 16, v87
    v_and_b32 v21, s61, v87
    v_fmac_f32 v14, v20, v111
    v_fmac_f32 v15, v21, v111
    v_add_u32 v6, 82944, v3
    buffer_load_dwordx4 v[40:43], v6, s[16:19], 0 offen
    v_add_u32 v6, 89856, v3
    buffer_load_dwordx4 v[44:47], v6, s[16:19], 0 offen
    v_add_u32 v6, 96768, v3
    buffer_load_dwordx4 v[48:51], v6, s[16:19], 0 offen
    v_add_u32 v6, 103680, v3
    buffer_load_dwordx4 v[52:55], v6, s[16:19], 0 offen
    v_add_u32 v6, 110592, v3
    buffer_load_dwordx4 v[56:59], v6, s[16:19], 0 offen
    v_add_u32 v6, 117504, v3
    buffer_load_dwordx4 v[60:63], v6, s[16:19], 0 offen
    v_add_u32 v6, 124416, v3
    buffer_load_dwordx4 v[64:67], v6, s[16:19], 0 offen
    v_add_u32 v6, 131328, v3
    buffer_load_dwordx4 v[68:71], v6, s[16:19], 0 offen
    v_add_u32 v6, 138240, v3
    buffer_load_dwordx4 v[72:75], v6, s[16:19], 0 offen
    v_add_u32 v6, 145152, v3
    buffer_load_dwordx4 v[76:79], v6, s[16:19], 0 offen
    v_add_u32 v6, 152064, v3
    buffer_load_dwordx4 v[80:83], v6, s[16:19], 0 offen
    v_add_u32 v6, 158976, v3
    buffer_load_dwordx4 v[84:87], v6, s[16:19], 0 offen
    ds_read_b128 v[100:103], v5 offset:48
    ds_read_b128 v[104:107], v5 offset:64
    ds_read_b128 v[108:111], v5 offset:80
    s_waitcnt lgkmcnt(0)
    s_waitcnt vmcnt(11)
    v_lshlrev_b32 v20, 16, v40
    v_and_b32 v21, s61, v40
    v_fmac_f32 v8, v20, v100
    v_fmac_f32 v9, v21, v100
    v_lshlrev_b32 v20, 16, v41
    v_and_b32 v21, s61, v41
    v_fmac_f32 v10, v20, v100
    v_fmac_f32 v11, v21, v100
    v_lshlrev_b32 v20, 16, v42
    v_and_b32 v21, s61, v42
    v_fmac_f32 v12, v20, v100
    v_fmac_f32 v13, v21, v100
    v_lshlrev_b32 v20, 16, v43
    v_and_b32 v21, s61, v43
    v_fmac_f32 v14, v20, v100
    v_fmac_f32 v15, v21, v100
    s_waitcnt vmcnt(10)
    v_lshlrev_b32 v20, 16, v44
    v_and_b32 v21, s61, v44
    v_fmac_f32 v8, v20, v101
    v_fmac_f32 v9, v21, v101
    v_lshlrev_b32 v20, 16, v45
    v_and_b32 v21, s61, v45
    v_fmac_f32 v10, v20, v101
    v_fmac_f32 v11, v21, v101
    v_lshlrev_b32 v20, 16, v46
    v_and_b32 v21, s61, v46
    v_fmac_f32 v12, v20, v101
    v_fmac_f32 v13, v21, v101
    v_lshlrev_b32 v20, 16, v47
    v_and_b32 v21, s61, v47
    v_fmac_f32 v14, v20, v101
    v_fmac_f32 v15, v21, v101
    s_waitcnt vmcnt(9)
    v_lshlrev_b32 v20, 16, v48
    v_and_b32 v21, s61, v48
    v_fmac_f32 v8, v20, v102
    v_fmac_f32 v9, v21, v102
    v_lshlrev_b32 v20, 16, v49
    v_and_b32 v21, s61, v49
    v_fmac_f32 v10, v20, v102
    v_fmac_f32 v11, v21, v102
    v_lshlrev_b32 v20, 16, v50
    v_and_b32 v21, s61, v50
    v_fmac_f32 v12, v20, v102
    v_fmac_f32 v13, v21, v102
    v_lshlrev_b32 v20, 16, v51
    v_and_b32 v21, s61, v51
    v_fmac_f32 v14, v20, v102
    v_fmac_f32 v15, v21, v102
    s_waitcnt vmcnt(8)
    v_lshlrev_b32 v20, 16, v52
    v_and_b32 v21, s61, v52
    v_fmac_f32 v8, v20, v103
    v_fmac_f32 v9, v21, v103
    v_lshlrev_b32 v20, 16, v53
    v_and_b32 v21, s61, v53
    v_fmac_f32 v10, v20, v103
    v_fmac_f32 v11, v21, v103
    v_lshlrev_b32 v20, 16, v54
    v_and_b32 v21, s61, v54
    v_fmac_f32 v12, v20, v103
    v_fmac_f32 v13, v21, v103
    v_lshlrev_b32 v20, 16, v55
    v_and_b32 v21, s61, v55
    v_fmac_f32 v14, v20, v103
    v_fmac_f32 v15, v21, v103
    s_waitcnt vmcnt(7)
    v_lshlrev_b32 v20, 16, v56
    v_and_b32 v21, s61, v56
    v_fmac_f32 v8, v20, v104
    v_fmac_f32 v9, v21, v104
    v_lshlrev_b32 v20, 16, v57
    v_and_b32 v21, s61, v57
    v_fmac_f32 v10, v20, v104
    v_fmac_f32 v11, v21, v104
    v_lshlrev_b32 v20, 16, v58
    v_and_b32 v21, s61, v58
    v_fmac_f32 v12, v20, v104
    v_fmac_f32 v13, v21, v104
    v_lshlrev_b32 v20, 16, v59
    v_and_b32 v21, s61, v59
    v_fmac_f32 v14, v20, v104
    v_fmac_f32 v15, v21, v104
    s_waitcnt vmcnt(6)
    v_lshlrev_b32 v20, 16, v60
    v_and_b32 v21, s61, v60
    v_fmac_f32 v8, v20, v105
    v_fmac_f32 v9, v21, v105
    v_lshlrev_b32 v20, 16, v61
    v_and_b32 v21, s61, v61
    v_fmac_f32 v10, v20, v105
    v_fmac_f32 v11, v21, v105
    v_lshlrev_b32 v20, 16, v62
    v_and_b32 v21, s61, v62
    v_fmac_f32 v12, v20, v105
    v_fmac_f32 v13, v21, v105
    v_lshlrev_b32 v20, 16, v63
    v_and_b32 v21, s61, v63
    v_fmac_f32 v14, v20, v105
    v_fmac_f32 v15, v21, v105
    s_waitcnt vmcnt(5)
    v_lshlrev_b32 v20, 16, v64
    v_and_b32 v21, s61, v64
    v_fmac_f32 v8, v20, v106
    v_fmac_f32 v9, v21, v106
    v_lshlrev_b32 v20, 16, v65
    v_and_b32 v21, s61, v65
    v_fmac_f32 v10, v20, v106
    v_fmac_f32 v11, v21, v106
    v_lshlrev_b32 v20, 16, v66
    v_and_b32 v21, s61, v66
    v_fmac_f32 v12, v20, v106
    v_fmac_f32 v13, v21, v106
    v_lshlrev_b32 v20, 16, v67
    v_and_b32 v21, s61, v67
    v_fmac_f32 v14, v20, v106
    v_fmac_f32 v15, v21, v106
    s_waitcnt vmcnt(4)
    v_lshlrev_b32 v20, 16, v68
    v_and_b32 v21, s61, v68
    v_fmac_f32 v8, v20, v107
    v_fmac_f32 v9, v21, v107
    v_lshlrev_b32 v20, 16, v69
    v_and_b32 v21, s61, v69
    v_fmac_f32 v10, v20, v107
    v_fmac_f32 v11, v21, v107
    v_lshlrev_b32 v20, 16, v70
    v_and_b32 v21, s61, v70
    v_fmac_f32 v12, v20, v107
    v_fmac_f32 v13, v21, v107
    v_lshlrev_b32 v20, 16, v71
    v_and_b32 v21, s61, v71
    v_fmac_f32 v14, v20, v107
    v_fmac_f32 v15, v21, v107
    s_waitcnt vmcnt(3)
    v_lshlrev_b32 v20, 16, v72
    v_and_b32 v21, s61, v72
    v_fmac_f32 v8, v20, v108
    v_fmac_f32 v9, v21, v108
    v_lshlrev_b32 v20, 16, v73
    v_and_b32 v21, s61, v73
    v_fmac_f32 v10, v20, v108
    v_fmac_f32 v11, v21, v108
    v_lshlrev_b32 v20, 16, v74
    v_and_b32 v21, s61, v74
    v_fmac_f32 v12, v20, v108
    v_fmac_f32 v13, v21, v108
    v_lshlrev_b32 v20, 16, v75
    v_and_b32 v21, s61, v75
    v_fmac_f32 v14, v20, v108
    v_fmac_f32 v15, v21, v108
    s_waitcnt vmcnt(2)
    v_lshlrev_b32 v20, 16, v76
    v_and_b32 v21, s61, v76
    v_fmac_f32 v8, v20, v109
    v_fmac_f32 v9, v21, v109
    v_lshlrev_b32 v20, 16, v77
    v_and_b32 v21, s61, v77
    v_fmac_f32 v10, v20, v109
    v_fmac_f32 v11, v21, v109
    v_lshlrev_b32 v20, 16, v78
    v_and_b32 v21, s61, v78
    v_fmac_f32 v12, v20, v109
    v_fmac_f32 v13, v21, v109
    v_lshlrev_b32 v20, 16, v79
    v_and_b32 v21, s61, v79
    v_fmac_f32 v14, v20, v109
    v_fmac_f32 v15, v21, v109
    s_waitcnt vmcnt(1)
    v_lshlrev_b32 v20, 16, v80
    v_and_b32 v21, s61, v80
    v_fmac_f32 v8, v20, v110
    v_fmac_f32 v9, v21, v110
    v_lshlrev_b32 v20, 16, v81
    v_and_b32 v21, s61, v81
    v_fmac_f32 v10, v20, v110
    v_fmac_f32 v11, v21, v110
    v_lshlrev_b32 v20, 16, v82
    v_and_b32 v21, s61, v82
    v_fmac_f32 v12, v20, v110
    v_fmac_f32 v13, v21, v110
    v_lshlrev_b32 v20, 16, v83
    v_and_b32 v21, s61, v83
    v_fmac_f32 v14, v20, v110
    v_fmac_f32 v15, v21, v110
    s_waitcnt vmcnt(0)
    v_lshlrev_b32 v20, 16, v84
    v_and_b32 v21, s61, v84
    v_fmac_f32 v8, v20, v111
    v_fmac_f32 v9, v21, v111
    v_lshlrev_b32 v20, 16, v85
    v_and_b32 v21, s61, v85
    v_fmac_f32 v10, v20, v111
    v_fmac_f32 v11, v21, v111
    v_lshlrev_b32 v20, 16, v86
    v_and_b32 v21, s61, v86
    v_fmac_f32 v12, v20, v111
    v_fmac_f32 v13, v21, v111
    v_lshlrev_b32 v20, 16, v87
    v_and_b32 v21, s61, v87
    v_fmac_f32 v14, v20, v111
    v_fmac_f32 v15, v21, v111
    v_add_u32 v6, 165888, v3
    buffer_load_dwordx4 v[40:43], v6, s[16:19], 0 offen
    v_add_u32 v6, 172800, v3
    buffer_load_dwordx4 v[44:47], v6, s[16:19], 0 offen
    v_add_u32 v6, 179712, v3
    buffer_load_dwordx4 v[48:51], v6, s[16:19], 0 offen
    v_add_u32 v6, 186624, v3
    buffer_load_dwordx4 v[52:55], v6, s[16:19], 0 offen
    v_add_u32 v6, 193536, v3
    buffer_load_dwordx4 v[56:59], v6, s[16:19], 0 offen
    v_add_u32 v6, 200448, v3
    buffer_load_dwordx4 v[60:63], v6, s[16:19], 0 offen
    v_add_u32 v6, 207360, v3
    buffer_load_dwordx4 v[64:67], v6, s[16:19], 0 offen
    v_add_u32 v6, 214272, v3
    buffer_load_dwordx4 v[68:71], v6, s[16:19], 0 offen
    v_add_u32 v6, 221184, v3
    buffer_load_dwordx4 v[72:75], v6, s[16:19], 0 offen
    v_add_u32 v6, 228096, v3
    buffer_load_dwordx4 v[76:79], v6, s[16:19], 0 offen
    v_add_u32 v6, 235008, v3
    buffer_load_dwordx4 v[80:83], v6, s[16:19], 0 offen
    v_add_u32 v6, 241920, v3
    buffer_load_dwordx4 v[84:87], v6, s[16:19], 0 offen
    ds_read_b128 v[100:103], v5 offset:96
    ds_read_b128 v[104:107], v5 offset:112
    ds_read_b128 v[108:111], v5 offset:128
    s_waitcnt lgkmcnt(0)
    s_waitcnt vmcnt(11)
    v_lshlrev_b32 v20, 16, v40
    v_and_b32 v21, s61, v40
    v_fmac_f32 v8, v20, v100
    v_fmac_f32 v9, v21, v100
    v_lshlrev_b32 v20, 16, v41
    v_and_b32 v21, s61, v41
    v_fmac_f32 v10, v20, v100
    v_fmac_f32 v11, v21, v100
    v_lshlrev_b32 v20, 16, v42
    v_and_b32 v21, s61, v42
    v_fmac_f32 v12, v20, v100
    v_fmac_f32 v13, v21, v100
    v_lshlrev_b32 v20, 16, v43
    v_and_b32 v21, s61, v43
    v_fmac_f32 v14, v20, v100
    v_fmac_f32 v15, v21, v100
    s_waitcnt vmcnt(10)
    v_lshlrev_b32 v20, 16, v44
    v_and_b32 v21, s61, v44
    v_fmac_f32 v8, v20, v101
    v_fmac_f32 v9, v21, v101
    v_lshlrev_b32 v20, 16, v45
    v_and_b32 v21, s61, v45
    v_fmac_f32 v10, v20, v101
    v_fmac_f32 v11, v21, v101
    v_lshlrev_b32 v20, 16, v46
    v_and_b32 v21, s61, v46
    v_fmac_f32 v12, v20, v101
    v_fmac_f32 v13, v21, v101
    v_lshlrev_b32 v20, 16, v47
    v_and_b32 v21, s61, v47
    v_fmac_f32 v14, v20, v101
    v_fmac_f32 v15, v21, v101
    s_waitcnt vmcnt(9)
    v_lshlrev_b32 v20, 16, v48
    v_and_b32 v21, s61, v48
    v_fmac_f32 v8, v20, v102
    v_fmac_f32 v9, v21, v102
    v_lshlrev_b32 v20, 16, v49
    v_and_b32 v21, s61, v49
    v_fmac_f32 v10, v20, v102
    v_fmac_f32 v11, v21, v102
    v_lshlrev_b32 v20, 16, v50
    v_and_b32 v21, s61, v50
    v_fmac_f32 v12, v20, v102
    v_fmac_f32 v13, v21, v102
    v_lshlrev_b32 v20, 16, v51
    v_and_b32 v21, s61, v51
    v_fmac_f32 v14, v20, v102
    v_fmac_f32 v15, v21, v102
    s_waitcnt vmcnt(8)
    v_lshlrev_b32 v20, 16, v52
    v_and_b32 v21, s61, v52
    v_fmac_f32 v8, v20, v103
    v_fmac_f32 v9, v21, v103
    v_lshlrev_b32 v20, 16, v53
    v_and_b32 v21, s61, v53
    v_fmac_f32 v10, v20, v103
    v_fmac_f32 v11, v21, v103
    v_lshlrev_b32 v20, 16, v54
    v_and_b32 v21, s61, v54
    v_fmac_f32 v12, v20, v103
    v_fmac_f32 v13, v21, v103
    v_lshlrev_b32 v20, 16, v55
    v_and_b32 v21, s61, v55
    v_fmac_f32 v14, v20, v103
    v_fmac_f32 v15, v21, v103
    s_waitcnt vmcnt(7)
    v_lshlrev_b32 v20, 16, v56
    v_and_b32 v21, s61, v56
    v_fmac_f32 v8, v20, v104
    v_fmac_f32 v9, v21, v104
    v_lshlrev_b32 v20, 16, v57
    v_and_b32 v21, s61, v57
    v_fmac_f32 v10, v20, v104
    v_fmac_f32 v11, v21, v104
    v_lshlrev_b32 v20, 16, v58
    v_and_b32 v21, s61, v58
    v_fmac_f32 v12, v20, v104
    v_fmac_f32 v13, v21, v104
    v_lshlrev_b32 v20, 16, v59
    v_and_b32 v21, s61, v59
    v_fmac_f32 v14, v20, v104
    v_fmac_f32 v15, v21, v104
    s_waitcnt vmcnt(6)
    v_lshlrev_b32 v20, 16, v60
    v_and_b32 v21, s61, v60
    v_fmac_f32 v8, v20, v105
    v_fmac_f32 v9, v21, v105
    v_lshlrev_b32 v20, 16, v61
    v_and_b32 v21, s61, v61
    v_fmac_f32 v10, v20, v105
    v_fmac_f32 v11, v21, v105
    v_lshlrev_b32 v20, 16, v62
    v_and_b32 v21, s61, v62
    v_fmac_f32 v12, v20, v105
    v_fmac_f32 v13, v21, v105
    v_lshlrev_b32 v20, 16, v63
    v_and_b32 v21, s61, v63
    v_fmac_f32 v14, v20, v105
    v_fmac_f32 v15, v21, v105
    s_waitcnt vmcnt(5)
    v_lshlrev_b32 v20, 16, v64
    v_and_b32 v21, s61, v64
    v_fmac_f32 v8, v20, v106
    v_fmac_f32 v9, v21, v106
    v_lshlrev_b32 v20, 16, v65
    v_and_b32 v21, s61, v65
    v_fmac_f32 v10, v20, v106
    v_fmac_f32 v11, v21, v106
    v_lshlrev_b32 v20, 16, v66
    v_and_b32 v21, s61, v66
    v_fmac_f32 v12, v20, v106
    v_fmac_f32 v13, v21, v106
    v_lshlrev_b32 v20, 16, v67
    v_and_b32 v21, s61, v67
    v_fmac_f32 v14, v20, v106
    v_fmac_f32 v15, v21, v106
    s_waitcnt vmcnt(4)
    v_lshlrev_b32 v20, 16, v68
    v_and_b32 v21, s61, v68
    v_fmac_f32 v8, v20, v107
    v_fmac_f32 v9, v21, v107
    v_lshlrev_b32 v20, 16, v69
    v_and_b32 v21, s61, v69
    v_fmac_f32 v10, v20, v107
    v_fmac_f32 v11, v21, v107
    v_lshlrev_b32 v20, 16, v70
    v_and_b32 v21, s61, v70
    v_fmac_f32 v12, v20, v107
    v_fmac_f32 v13, v21, v107
    v_lshlrev_b32 v20, 16, v71
    v_and_b32 v21, s61, v71
    v_fmac_f32 v14, v20, v107
    v_fmac_f32 v15, v21, v107
    s_waitcnt vmcnt(3)
    v_lshlrev_b32 v20, 16, v72
    v_and_b32 v21, s61, v72
    v_fmac_f32 v8, v20, v108
    v_fmac_f32 v9, v21, v108
    v_lshlrev_b32 v20, 16, v73
    v_and_b32 v21, s61, v73
    v_fmac_f32 v10, v20, v108
    v_fmac_f32 v11, v21, v108
    v_lshlrev_b32 v20, 16, v74
    v_and_b32 v21, s61, v74
    v_fmac_f32 v12, v20, v108
    v_fmac_f32 v13, v21, v108
    v_lshlrev_b32 v20, 16, v75
    v_and_b32 v21, s61, v75
    v_fmac_f32 v14, v20, v108
    v_fmac_f32 v15, v21, v108
    s_waitcnt vmcnt(2)
    v_lshlrev_b32 v20, 16, v76
    v_and_b32 v21, s61, v76
    v_fmac_f32 v8, v20, v109
    v_fmac_f32 v9, v21, v109
    v_lshlrev_b32 v20, 16, v77
    v_and_b32 v21, s61, v77
    v_fmac_f32 v10, v20, v109
    v_fmac_f32 v11, v21, v109
    v_lshlrev_b32 v20, 16, v78
    v_and_b32 v21, s61, v78
    v_fmac_f32 v12, v20, v109
    v_fmac_f32 v13, v21, v109
    v_lshlrev_b32 v20, 16, v79
    v_and_b32 v21, s61, v79
    v_fmac_f32 v14, v20, v109
    v_fmac_f32 v15, v21, v109
    s_waitcnt vmcnt(1)
    v_lshlrev_b32 v20, 16, v80
    v_and_b32 v21, s61, v80
    v_fmac_f32 v8, v20, v110
    v_fmac_f32 v9, v21, v110
    v_lshlrev_b32 v20, 16, v81
    v_and_b32 v21, s61, v81
    v_fmac_f32 v10, v20, v110
    v_fmac_f32 v11, v21, v110
    v_lshlrev_b32 v20, 16, v82
    v_and_b32 v21, s61, v82
    v_fmac_f32 v12, v20, v110
    v_fmac_f32 v13, v21, v110
    v_lshlrev_b32 v20, 16, v83
    v_and_b32 v21, s61, v83
    v_fmac_f32 v14, v20, v110
    v_fmac_f32 v15, v21, v110
    s_waitcnt vmcnt(0)
    v_lshlrev_b32 v20, 16, v84
    v_and_b32 v21, s61, v84
    v_fmac_f32 v8, v20, v111
    v_fmac_f32 v9, v21, v111
    v_lshlrev_b32 v20, 16, v85
    v_and_b32 v21, s61, v85
    v_fmac_f32 v10, v20, v111
    v_fmac_f32 v11, v21, v111
    v_lshlrev_b32 v20, 16, v86
    v_and_b32 v21, s61, v86
    v_fmac_f32 v12, v20, v111
    v_fmac_f32 v13, v21, v111
    v_lshlrev_b32 v20, 16, v87
    v_and_b32 v21, s61, v87
    v_fmac_f32 v14, v20, v111
    v_fmac_f32 v15, v21, v111
    v_lshlrev_b32 v6, 9, v2
    v_lshlrev_b32 v7, 5, v1
    v_add3_u32 v6, v6, v7, 0
    ds_write_b128 v6, v[8:11] offset:4096
    ds_write_b128 v6, v[12:15] offset:4112
    s_waitcnt lgkmcnt(0)
    s_barrier
    v_cmp_gt_u32 vcc, 128, v0
    s_and_saveexec_b64 s[24:25], vcc
    s_cbranch_execz L_prep_end
    v_lshlrev_b32 v6, 2, v0
    v_mov_b32 v8, 0

    ds_read_b32 v40, v6 offset:4096
    ds_read_b32 v41, v6 offset:4608
    ds_read_b32 v42, v6 offset:5120
    ds_read_b32 v43, v6 offset:5632
    ds_read_b32 v44, v6 offset:6144
    ds_read_b32 v45, v6 offset:6656
    ds_read_b32 v46, v6 offset:7168
    ds_read_b32 v47, v6 offset:7680
    ds_read_b32 v48, v6 offset:8192
    ds_read_b32 v49, v6 offset:8704
    ds_read_b32 v50, v6 offset:9216
    ds_read_b32 v51, v6 offset:9728
    ds_read_b32 v52, v6 offset:10240
    ds_read_b32 v53, v6 offset:10752
    ds_read_b32 v54, v6 offset:11264
    ds_read_b32 v55, v6 offset:11776
    s_waitcnt lgkmcnt(0)
    v_add_f32 v8, v8, v40
    v_add_f32 v8, v8, v41
    v_add_f32 v8, v8, v42
    v_add_f32 v8, v8, v43
    v_add_f32 v8, v8, v44
    v_add_f32 v8, v8, v45
    v_add_f32 v8, v8, v46
    v_add_f32 v8, v8, v47
    v_add_f32 v8, v8, v48
    v_add_f32 v8, v8, v49
    v_add_f32 v8, v8, v50
    v_add_f32 v8, v8, v51
    v_add_f32 v8, v8, v52
    v_add_f32 v8, v8, v53
    v_add_f32 v8, v8, v54
    v_add_f32 v8, v8, v55
    v_cvt_pk_bf16_f32 v8, v8, v8
    v_lshlrev_b32 v8, 16, v8
    s_lshl_b32 s26, s3, 9
    v_add_u32 v6, s26, v6
    buffer_store_dword v8, v6, s[20:23], 0 offen
    s_branch L_prep_end

L_role_st:
    s_load_dwordx2 s[6:7], s[0:1], 0
    s_sub_u32 s3, s2, 972
    s_waitcnt lgkmcnt(0)

    s_mov_b32 s12, s6
    s_mov_b32 s13, s7
    s_mov_b32 s14, 2359296
    s_mov_b32 s15, 0x00020000
    s_add_u32 s16, s4, 16384
    s_addc_u32 s17, s5, 0
    s_mov_b32 s18, 8192
    s_mov_b32 s19, 0x00020000
    s_add_u32 s20, s4, 24576
    s_addc_u32 s21, s5, 0
    s_mov_b32 s22, 8192
    s_mov_b32 s23, 0x00020000
    v_lshrrev_b32 v1, 3, v0
    s_lshl_b32 s26, s3, 5
    v_add_u32 v1, s26, v1
    v_and_b32 v2, 7, v0
    v_mul_u32_u24 v3, 1152, v1
    v_lshlrev_b32 v4, 4, v2
    v_add_u32 v3, v3, v4

    buffer_load_dwordx4 v[40:43], v3, s[12:15], 0 offen offset:0
    buffer_load_dwordx4 v[44:47], v3, s[12:15], 0 offen offset:128
    buffer_load_dwordx4 v[48:51], v3, s[12:15], 0 offen offset:256
    buffer_load_dwordx4 v[52:55], v3, s[12:15], 0 offen offset:384
    buffer_load_dwordx4 v[56:59], v3, s[12:15], 0 offen offset:512
    buffer_load_dwordx4 v[60:63], v3, s[12:15], 0 offen offset:640
    buffer_load_dwordx4 v[64:67], v3, s[12:15], 0 offen offset:768
    buffer_load_dwordx4 v[68:71], v3, s[12:15], 0 offen offset:896
    buffer_load_dwordx4 v[72:75], v3, s[12:15], 0 offen offset:1024
    s_mov_b32 s61, 0xffff0000
    v_mov_b32 v8, 0
    s_waitcnt vmcnt(0)
    v_lshlrev_b32 v80, 16, v40
    v_and_b32 v81, s61, v40
    v_add_f32 v8, v8, v80
    v_add_f32 v8, v8, v81
    v_lshlrev_b32 v80, 16, v41
    v_and_b32 v81, s61, v41
    v_add_f32 v8, v8, v80
    v_add_f32 v8, v8, v81
    v_lshlrev_b32 v80, 16, v42
    v_and_b32 v81, s61, v42
    v_add_f32 v8, v8, v80
    v_add_f32 v8, v8, v81
    v_lshlrev_b32 v80, 16, v43
    v_and_b32 v81, s61, v43
    v_add_f32 v8, v8, v80
    v_add_f32 v8, v8, v81
    v_lshlrev_b32 v80, 16, v44
    v_and_b32 v81, s61, v44
    v_add_f32 v8, v8, v80
    v_add_f32 v8, v8, v81
    v_lshlrev_b32 v80, 16, v45
    v_and_b32 v81, s61, v45
    v_add_f32 v8, v8, v80
    v_add_f32 v8, v8, v81
    v_lshlrev_b32 v80, 16, v46
    v_and_b32 v81, s61, v46
    v_add_f32 v8, v8, v80
    v_add_f32 v8, v8, v81
    v_lshlrev_b32 v80, 16, v47
    v_and_b32 v81, s61, v47
    v_add_f32 v8, v8, v80
    v_add_f32 v8, v8, v81
    v_lshlrev_b32 v80, 16, v48
    v_and_b32 v81, s61, v48
    v_add_f32 v8, v8, v80
    v_add_f32 v8, v8, v81
    v_lshlrev_b32 v80, 16, v49
    v_and_b32 v81, s61, v49
    v_add_f32 v8, v8, v80
    v_add_f32 v8, v8, v81
    v_lshlrev_b32 v80, 16, v50
    v_and_b32 v81, s61, v50
    v_add_f32 v8, v8, v80
    v_add_f32 v8, v8, v81
    v_lshlrev_b32 v80, 16, v51
    v_and_b32 v81, s61, v51
    v_add_f32 v8, v8, v80
    v_add_f32 v8, v8, v81
    v_lshlrev_b32 v80, 16, v52
    v_and_b32 v81, s61, v52
    v_add_f32 v8, v8, v80
    v_add_f32 v8, v8, v81
    v_lshlrev_b32 v80, 16, v53
    v_and_b32 v81, s61, v53
    v_add_f32 v8, v8, v80
    v_add_f32 v8, v8, v81
    v_lshlrev_b32 v80, 16, v54
    v_and_b32 v81, s61, v54
    v_add_f32 v8, v8, v80
    v_add_f32 v8, v8, v81
    v_lshlrev_b32 v80, 16, v55
    v_and_b32 v81, s61, v55
    v_add_f32 v8, v8, v80
    v_add_f32 v8, v8, v81
    v_lshlrev_b32 v80, 16, v56
    v_and_b32 v81, s61, v56
    v_add_f32 v8, v8, v80
    v_add_f32 v8, v8, v81
    v_lshlrev_b32 v80, 16, v57
    v_and_b32 v81, s61, v57
    v_add_f32 v8, v8, v80
    v_add_f32 v8, v8, v81
    v_lshlrev_b32 v80, 16, v58
    v_and_b32 v81, s61, v58
    v_add_f32 v8, v8, v80
    v_add_f32 v8, v8, v81
    v_lshlrev_b32 v80, 16, v59
    v_and_b32 v81, s61, v59
    v_add_f32 v8, v8, v80
    v_add_f32 v8, v8, v81
    v_lshlrev_b32 v80, 16, v60
    v_and_b32 v81, s61, v60
    v_add_f32 v8, v8, v80
    v_add_f32 v8, v8, v81
    v_lshlrev_b32 v80, 16, v61
    v_and_b32 v81, s61, v61
    v_add_f32 v8, v8, v80
    v_add_f32 v8, v8, v81
    v_lshlrev_b32 v80, 16, v62
    v_and_b32 v81, s61, v62
    v_add_f32 v8, v8, v80
    v_add_f32 v8, v8, v81
    v_lshlrev_b32 v80, 16, v63
    v_and_b32 v81, s61, v63
    v_add_f32 v8, v8, v80
    v_add_f32 v8, v8, v81
    v_lshlrev_b32 v80, 16, v64
    v_and_b32 v81, s61, v64
    v_add_f32 v8, v8, v80
    v_add_f32 v8, v8, v81
    v_lshlrev_b32 v80, 16, v65
    v_and_b32 v81, s61, v65
    v_add_f32 v8, v8, v80
    v_add_f32 v8, v8, v81
    v_lshlrev_b32 v80, 16, v66
    v_and_b32 v81, s61, v66
    v_add_f32 v8, v8, v80
    v_add_f32 v8, v8, v81
    v_lshlrev_b32 v80, 16, v67
    v_and_b32 v81, s61, v67
    v_add_f32 v8, v8, v80
    v_add_f32 v8, v8, v81
    v_lshlrev_b32 v80, 16, v68
    v_and_b32 v81, s61, v68
    v_add_f32 v8, v8, v80
    v_add_f32 v8, v8, v81
    v_lshlrev_b32 v80, 16, v69
    v_and_b32 v81, s61, v69
    v_add_f32 v8, v8, v80
    v_add_f32 v8, v8, v81
    v_lshlrev_b32 v80, 16, v70
    v_and_b32 v81, s61, v70
    v_add_f32 v8, v8, v80
    v_add_f32 v8, v8, v81
    v_lshlrev_b32 v80, 16, v71
    v_and_b32 v81, s61, v71
    v_add_f32 v8, v8, v80
    v_add_f32 v8, v8, v81
    v_lshlrev_b32 v80, 16, v72
    v_and_b32 v81, s61, v72
    v_add_f32 v8, v8, v80
    v_add_f32 v8, v8, v81
    v_lshlrev_b32 v80, 16, v73
    v_and_b32 v81, s61, v73
    v_add_f32 v8, v8, v80
    v_add_f32 v8, v8, v81
    v_lshlrev_b32 v80, 16, v74
    v_and_b32 v81, s61, v74
    v_add_f32 v8, v8, v80
    v_add_f32 v8, v8, v81
    v_lshlrev_b32 v80, 16, v75
    v_and_b32 v81, s61, v75
    v_add_f32 v8, v8, v80
    v_add_f32 v8, v8, v81
    ds_swizzle_b32 v9, v8 offset:0x041F
    s_waitcnt lgkmcnt(0)
    v_add_f32 v8, v8, v9
    ds_swizzle_b32 v9, v8 offset:0x081F
    s_waitcnt lgkmcnt(0)
    v_add_f32 v8, v8, v9
    ds_swizzle_b32 v9, v8 offset:0x101F
    s_waitcnt lgkmcnt(0)
    v_add_f32 v8, v8, v9
    s_mov_b32 s62, 0x3ae38e39
    v_mul_f32 v8, s62, v8
    v_mov_b32 v10, 0
    v_lshlrev_b32 v80, 16, v40
    v_and_b32 v81, s61, v40
    v_sub_f32 v80, v80, v8
    v_sub_f32 v81, v81, v8
    v_fmac_f32 v10, v80, v80
    v_fmac_f32 v10, v81, v81
    v_lshlrev_b32 v80, 16, v41
    v_and_b32 v81, s61, v41
    v_sub_f32 v80, v80, v8
    v_sub_f32 v81, v81, v8
    v_fmac_f32 v10, v80, v80
    v_fmac_f32 v10, v81, v81
    v_lshlrev_b32 v80, 16, v42
    v_and_b32 v81, s61, v42
    v_sub_f32 v80, v80, v8
    v_sub_f32 v81, v81, v8
    v_fmac_f32 v10, v80, v80
    v_fmac_f32 v10, v81, v81
    v_lshlrev_b32 v80, 16, v43
    v_and_b32 v81, s61, v43
    v_sub_f32 v80, v80, v8
    v_sub_f32 v81, v81, v8
    v_fmac_f32 v10, v80, v80
    v_fmac_f32 v10, v81, v81
    v_lshlrev_b32 v80, 16, v44
    v_and_b32 v81, s61, v44
    v_sub_f32 v80, v80, v8
    v_sub_f32 v81, v81, v8
    v_fmac_f32 v10, v80, v80
    v_fmac_f32 v10, v81, v81
    v_lshlrev_b32 v80, 16, v45
    v_and_b32 v81, s61, v45
    v_sub_f32 v80, v80, v8
    v_sub_f32 v81, v81, v8
    v_fmac_f32 v10, v80, v80
    v_fmac_f32 v10, v81, v81
    v_lshlrev_b32 v80, 16, v46
    v_and_b32 v81, s61, v46
    v_sub_f32 v80, v80, v8
    v_sub_f32 v81, v81, v8
    v_fmac_f32 v10, v80, v80
    v_fmac_f32 v10, v81, v81
    v_lshlrev_b32 v80, 16, v47
    v_and_b32 v81, s61, v47
    v_sub_f32 v80, v80, v8
    v_sub_f32 v81, v81, v8
    v_fmac_f32 v10, v80, v80
    v_fmac_f32 v10, v81, v81
    v_lshlrev_b32 v80, 16, v48
    v_and_b32 v81, s61, v48
    v_sub_f32 v80, v80, v8
    v_sub_f32 v81, v81, v8
    v_fmac_f32 v10, v80, v80
    v_fmac_f32 v10, v81, v81
    v_lshlrev_b32 v80, 16, v49
    v_and_b32 v81, s61, v49
    v_sub_f32 v80, v80, v8
    v_sub_f32 v81, v81, v8
    v_fmac_f32 v10, v80, v80
    v_fmac_f32 v10, v81, v81
    v_lshlrev_b32 v80, 16, v50
    v_and_b32 v81, s61, v50
    v_sub_f32 v80, v80, v8
    v_sub_f32 v81, v81, v8
    v_fmac_f32 v10, v80, v80
    v_fmac_f32 v10, v81, v81
    v_lshlrev_b32 v80, 16, v51
    v_and_b32 v81, s61, v51
    v_sub_f32 v80, v80, v8
    v_sub_f32 v81, v81, v8
    v_fmac_f32 v10, v80, v80
    v_fmac_f32 v10, v81, v81
    v_lshlrev_b32 v80, 16, v52
    v_and_b32 v81, s61, v52
    v_sub_f32 v80, v80, v8
    v_sub_f32 v81, v81, v8
    v_fmac_f32 v10, v80, v80
    v_fmac_f32 v10, v81, v81
    v_lshlrev_b32 v80, 16, v53
    v_and_b32 v81, s61, v53
    v_sub_f32 v80, v80, v8
    v_sub_f32 v81, v81, v8
    v_fmac_f32 v10, v80, v80
    v_fmac_f32 v10, v81, v81
    v_lshlrev_b32 v80, 16, v54
    v_and_b32 v81, s61, v54
    v_sub_f32 v80, v80, v8
    v_sub_f32 v81, v81, v8
    v_fmac_f32 v10, v80, v80
    v_fmac_f32 v10, v81, v81
    v_lshlrev_b32 v80, 16, v55
    v_and_b32 v81, s61, v55
    v_sub_f32 v80, v80, v8
    v_sub_f32 v81, v81, v8
    v_fmac_f32 v10, v80, v80
    v_fmac_f32 v10, v81, v81
    v_lshlrev_b32 v80, 16, v56
    v_and_b32 v81, s61, v56
    v_sub_f32 v80, v80, v8
    v_sub_f32 v81, v81, v8
    v_fmac_f32 v10, v80, v80
    v_fmac_f32 v10, v81, v81
    v_lshlrev_b32 v80, 16, v57
    v_and_b32 v81, s61, v57
    v_sub_f32 v80, v80, v8
    v_sub_f32 v81, v81, v8
    v_fmac_f32 v10, v80, v80
    v_fmac_f32 v10, v81, v81
    v_lshlrev_b32 v80, 16, v58
    v_and_b32 v81, s61, v58
    v_sub_f32 v80, v80, v8
    v_sub_f32 v81, v81, v8
    v_fmac_f32 v10, v80, v80
    v_fmac_f32 v10, v81, v81
    v_lshlrev_b32 v80, 16, v59
    v_and_b32 v81, s61, v59
    v_sub_f32 v80, v80, v8
    v_sub_f32 v81, v81, v8
    v_fmac_f32 v10, v80, v80
    v_fmac_f32 v10, v81, v81
    v_lshlrev_b32 v80, 16, v60
    v_and_b32 v81, s61, v60
    v_sub_f32 v80, v80, v8
    v_sub_f32 v81, v81, v8
    v_fmac_f32 v10, v80, v80
    v_fmac_f32 v10, v81, v81
    v_lshlrev_b32 v80, 16, v61
    v_and_b32 v81, s61, v61
    v_sub_f32 v80, v80, v8
    v_sub_f32 v81, v81, v8
    v_fmac_f32 v10, v80, v80
    v_fmac_f32 v10, v81, v81
    v_lshlrev_b32 v80, 16, v62
    v_and_b32 v81, s61, v62
    v_sub_f32 v80, v80, v8
    v_sub_f32 v81, v81, v8
    v_fmac_f32 v10, v80, v80
    v_fmac_f32 v10, v81, v81
    v_lshlrev_b32 v80, 16, v63
    v_and_b32 v81, s61, v63
    v_sub_f32 v80, v80, v8
    v_sub_f32 v81, v81, v8
    v_fmac_f32 v10, v80, v80
    v_fmac_f32 v10, v81, v81
    v_lshlrev_b32 v80, 16, v64
    v_and_b32 v81, s61, v64
    v_sub_f32 v80, v80, v8
    v_sub_f32 v81, v81, v8
    v_fmac_f32 v10, v80, v80
    v_fmac_f32 v10, v81, v81
    v_lshlrev_b32 v80, 16, v65
    v_and_b32 v81, s61, v65
    v_sub_f32 v80, v80, v8
    v_sub_f32 v81, v81, v8
    v_fmac_f32 v10, v80, v80
    v_fmac_f32 v10, v81, v81
    v_lshlrev_b32 v80, 16, v66
    v_and_b32 v81, s61, v66
    v_sub_f32 v80, v80, v8
    v_sub_f32 v81, v81, v8
    v_fmac_f32 v10, v80, v80
    v_fmac_f32 v10, v81, v81
    v_lshlrev_b32 v80, 16, v67
    v_and_b32 v81, s61, v67
    v_sub_f32 v80, v80, v8
    v_sub_f32 v81, v81, v8
    v_fmac_f32 v10, v80, v80
    v_fmac_f32 v10, v81, v81
    v_lshlrev_b32 v80, 16, v68
    v_and_b32 v81, s61, v68
    v_sub_f32 v80, v80, v8
    v_sub_f32 v81, v81, v8
    v_fmac_f32 v10, v80, v80
    v_fmac_f32 v10, v81, v81
    v_lshlrev_b32 v80, 16, v69
    v_and_b32 v81, s61, v69
    v_sub_f32 v80, v80, v8
    v_sub_f32 v81, v81, v8
    v_fmac_f32 v10, v80, v80
    v_fmac_f32 v10, v81, v81
    v_lshlrev_b32 v80, 16, v70
    v_and_b32 v81, s61, v70
    v_sub_f32 v80, v80, v8
    v_sub_f32 v81, v81, v8
    v_fmac_f32 v10, v80, v80
    v_fmac_f32 v10, v81, v81
    v_lshlrev_b32 v80, 16, v71
    v_and_b32 v81, s61, v71
    v_sub_f32 v80, v80, v8
    v_sub_f32 v81, v81, v8
    v_fmac_f32 v10, v80, v80
    v_fmac_f32 v10, v81, v81
    v_lshlrev_b32 v80, 16, v72
    v_and_b32 v81, s61, v72
    v_sub_f32 v80, v80, v8
    v_sub_f32 v81, v81, v8
    v_fmac_f32 v10, v80, v80
    v_fmac_f32 v10, v81, v81
    v_lshlrev_b32 v80, 16, v73
    v_and_b32 v81, s61, v73
    v_sub_f32 v80, v80, v8
    v_sub_f32 v81, v81, v8
    v_fmac_f32 v10, v80, v80
    v_fmac_f32 v10, v81, v81
    v_lshlrev_b32 v80, 16, v74
    v_and_b32 v81, s61, v74
    v_sub_f32 v80, v80, v8
    v_sub_f32 v81, v81, v8
    v_fmac_f32 v10, v80, v80
    v_fmac_f32 v10, v81, v81
    v_lshlrev_b32 v80, 16, v75
    v_and_b32 v81, s61, v75
    v_sub_f32 v80, v80, v8
    v_sub_f32 v81, v81, v8
    v_fmac_f32 v10, v80, v80
    v_fmac_f32 v10, v81, v81
    ds_swizzle_b32 v9, v10 offset:0x041F
    s_waitcnt lgkmcnt(0)
    v_add_f32 v10, v10, v9
    ds_swizzle_b32 v9, v10 offset:0x081F
    s_waitcnt lgkmcnt(0)
    v_add_f32 v10, v10, v9
    ds_swizzle_b32 v9, v10 offset:0x101F
    s_waitcnt lgkmcnt(0)
    v_add_f32 v10, v10, v9
    v_mul_f32 v10, s62, v10
    v_cvt_pk_bf16_f32 v8, v8, v8
    v_lshlrev_b32 v8, 16, v8
    v_cvt_pk_bf16_f32 v10, v10, v10
    v_lshlrev_b32 v10, 16, v10
    s_mov_b32 s63, 0x3727C5AC
    v_add_f32 v10, s63, v10
    v_cvt_pk_bf16_f32 v10, v10, v10
    v_lshlrev_b32 v10, 16, v10
    v_sqrt_f32 v10, v10
    s_nop 0
    v_cvt_pk_bf16_f32 v10, v10, v10
    v_lshlrev_b32 v10, 16, v10
    v_lshlrev_b32 v3, 2, v1
    v_cmp_eq_u32 vcc, 0, v2
    s_and_saveexec_b64 s[24:25], vcc
    s_cbranch_execz L_prep_end
    buffer_store_dword v8, v3, s[16:19], 0 offen
    buffer_store_dword v10, v3, s[20:23], 0 offen
    s_branch L_prep_end

L_role_xt:
    s_load_dwordx2 s[6:7], s[0:1], 0
    s_sub_u32 s3, s2, 900
    s_waitcnt lgkmcnt(0)

    s_mov_b32 s12, s6
    s_mov_b32 s13, s7
    s_mov_b32 s14, 2359296
    s_mov_b32 s15, 0x00020000
    s_add_u32 s16, s4, 32768
    s_addc_u32 s17, s5, 0
    s_mov_b32 s18, 2359296
    s_mov_b32 s19, 0x00020000
    v_lshrrev_b32 v1, 6, v0
    s_lshl_b32 s26, s3, 2
    v_add_u32 v1, s26, v1
    v_lshrrev_b32 v2, 3, v1
    s_mov_b32 s27, 0x38E38E39
    v_mul_hi_u32 v2, v1, s27
    v_lshrrev_b32 v2, 1, v2
    v_mul_u32_u24 v3, 9, v2
    v_sub_u32 v3, v1, v3
    v_and_b32 v4, 7, v0
    v_bfe_u32 v5, v0, 3, 3
    v_lshl_add_u32 v6, v2, 3, v4
    v_lshl_add_u32 v7, v3, 3, v5
    v_mul_u32_u24 v8, 9216, v6
    v_lshl_add_u32 v8, v7, 4, v8
    v_lshlrev_b32 v9, 15, v7
    v_lshl_add_u32 v9, v6, 4, v9

    buffer_load_dwordx4 v[40:43], v8, s[12:15], 0 offen offset:0
    buffer_load_dwordx4 v[44:47], v8, s[12:15], 0 offen offset:1152
    buffer_load_dwordx4 v[48:51], v8, s[12:15], 0 offen offset:2304
    buffer_load_dwordx4 v[52:55], v8, s[12:15], 0 offen offset:3456
    v_add_u32 v30, 4608, v8
    buffer_load_dwordx4 v[56:59], v30, s[12:15], 0 offen
    v_add_u32 v30, 5760, v8
    buffer_load_dwordx4 v[60:63], v30, s[12:15], 0 offen
    v_add_u32 v30, 6912, v8
    buffer_load_dwordx4 v[64:67], v30, s[12:15], 0 offen
    v_add_u32 v30, 8064, v8
    buffer_load_dwordx4 v[68:71], v30, s[12:15], 0 offen
    s_mov_b32 s60, 0x05040100
    s_mov_b32 s61, 0x07060302
    s_waitcnt vmcnt(0)
    v_perm_b32 v72, v44, v40, s60
    v_perm_b32 v73, v52, v48, s60
    v_perm_b32 v74, v60, v56, s60
    v_perm_b32 v75, v68, v64, s60
    v_perm_b32 v76, v44, v40, s61
    v_perm_b32 v77, v52, v48, s61
    v_perm_b32 v78, v60, v56, s61
    v_perm_b32 v79, v68, v64, s61
    v_perm_b32 v80, v45, v41, s60
    v_perm_b32 v81, v53, v49, s60
    v_perm_b32 v82, v61, v57, s60
    v_perm_b32 v83, v69, v65, s60
    v_perm_b32 v84, v45, v41, s61
    v_perm_b32 v85, v53, v49, s61
    v_perm_b32 v86, v61, v57, s61
    v_perm_b32 v87, v69, v65, s61
    v_perm_b32 v88, v46, v42, s60
    v_perm_b32 v89, v54, v50, s60
    v_perm_b32 v90, v62, v58, s60
    v_perm_b32 v91, v70, v66, s60
    v_perm_b32 v92, v46, v42, s61
    v_perm_b32 v93, v54, v50, s61
    v_perm_b32 v94, v62, v58, s61
    v_perm_b32 v95, v70, v66, s61
    v_perm_b32 v96, v47, v43, s60
    v_perm_b32 v97, v55, v51, s60
    v_perm_b32 v98, v63, v59, s60
    v_perm_b32 v99, v71, v67, s60
    v_perm_b32 v100, v47, v43, s61
    v_perm_b32 v101, v55, v51, s61
    v_perm_b32 v102, v63, v59, s61
    v_perm_b32 v103, v71, v67, s61
    v_add_u32 v31, 0, v9
    buffer_store_dwordx4 v[72:75], v31, s[16:19], 0 offen
    v_add_u32 v31, 4096, v9
    buffer_store_dwordx4 v[76:79], v31, s[16:19], 0 offen
    v_add_u32 v31, 8192, v9
    buffer_store_dwordx4 v[80:83], v31, s[16:19], 0 offen
    v_add_u32 v31, 12288, v9
    buffer_store_dwordx4 v[84:87], v31, s[16:19], 0 offen
    v_add_u32 v31, 16384, v9
    buffer_store_dwordx4 v[88:91], v31, s[16:19], 0 offen
    v_add_u32 v31, 20480, v9
    buffer_store_dwordx4 v[92:95], v31, s[16:19], 0 offen
    v_add_u32 v31, 24576, v9
    buffer_store_dwordx4 v[96:99], v31, s[16:19], 0 offen
    v_add_u32 v31, 28672, v9
    buffer_store_dwordx4 v[100:103], v31, s[16:19], 0 offen
    s_branch L_prep_end
L_role_w1:
    s_load_dwordx2 s[6:7], s[0:1], 80
    s_sub_u32 s3, s2, 576
    s_waitcnt lgkmcnt(0)

    s_mov_b32 s12, s6
    s_mov_b32 s13, s7
    s_mov_b32 s14, 5308416
    s_mov_b32 s15, 0x00020000
    s_add_u32 s16, s4, 7258112
    s_addc_u32 s17, s5, 0
    s_mov_b32 s18, 5308416
    s_mov_b32 s19, 0x00020000
    v_lshrrev_b32 v1, 6, v0
    s_lshl_b32 s26, s3, 2
    v_add_u32 v1, s26, v1
    s_mov_b32 s27, 477218589
    v_mul_hi_u32 v2, v1, s27
    v_mul_u32_u24 v3, 9, v2
    v_sub_u32 v3, v1, v3
    v_and_b32 v4, 7, v0
    v_bfe_u32 v5, v0, 3, 3
    v_lshl_add_u32 v6, v3, 3, v4
    v_lshl_add_u32 v7, v2, 3, v5
    v_mul_u32_u24 v8, 73728, v6
    v_lshl_add_u32 v8, v7, 4, v8
    s_mov_b32 s27, 119304648
    v_mul_hi_u32 v10, v7, s27
    v_mul_u32_u24 v11, 36, v10
    v_sub_u32 v11, v7, v11
    v_lshlrev_b32 v11, 3, v11
    v_mul_u32_u24 v12, 9, v10
    v_add_u32 v12, v12, v3
    v_mul_u32_u24 v12, 288, v12
    v_add_u32 v12, v12, v11
    v_lshlrev_b32 v12, 7, v12
    v_lshrrev_b32 v13, 1, v11
    v_and_b32 v13, 4, v13
    v_xor_b32 v13, v13, v4

    buffer_load_dwordx4 v[40:43], v8, s[12:15], 0 offen offset:0
    v_add_u32 v30, 9216, v8
    buffer_load_dwordx4 v[44:47], v30, s[12:15], 0 offen
    v_add_u32 v30, 18432, v8
    buffer_load_dwordx4 v[48:51], v30, s[12:15], 0 offen
    v_add_u32 v30, 27648, v8
    buffer_load_dwordx4 v[52:55], v30, s[12:15], 0 offen
    v_add_u32 v30, 36864, v8
    buffer_load_dwordx4 v[56:59], v30, s[12:15], 0 offen
    v_add_u32 v30, 46080, v8
    buffer_load_dwordx4 v[60:63], v30, s[12:15], 0 offen
    v_add_u32 v30, 55296, v8
    buffer_load_dwordx4 v[64:67], v30, s[12:15], 0 offen
    v_add_u32 v30, 64512, v8
    buffer_load_dwordx4 v[68:71], v30, s[12:15], 0 offen
    s_mov_b32 s60, 0x05040100
    s_mov_b32 s61, 0x07060302
    s_waitcnt vmcnt(0)
    v_perm_b32 v72, v44, v40, s60
    v_perm_b32 v73, v52, v48, s60
    v_perm_b32 v74, v60, v56, s60
    v_perm_b32 v75, v68, v64, s60
    v_perm_b32 v76, v44, v40, s61
    v_perm_b32 v77, v52, v48, s61
    v_perm_b32 v78, v60, v56, s61
    v_perm_b32 v79, v68, v64, s61
    v_perm_b32 v80, v45, v41, s60
    v_perm_b32 v81, v53, v49, s60
    v_perm_b32 v82, v61, v57, s60
    v_perm_b32 v83, v69, v65, s60
    v_perm_b32 v84, v45, v41, s61
    v_perm_b32 v85, v53, v49, s61
    v_perm_b32 v86, v61, v57, s61
    v_perm_b32 v87, v69, v65, s61
    v_perm_b32 v88, v46, v42, s60
    v_perm_b32 v89, v54, v50, s60
    v_perm_b32 v90, v62, v58, s60
    v_perm_b32 v91, v70, v66, s60
    v_perm_b32 v92, v46, v42, s61
    v_perm_b32 v93, v54, v50, s61
    v_perm_b32 v94, v62, v58, s61
    v_perm_b32 v95, v70, v66, s61
    v_perm_b32 v96, v47, v43, s60
    v_perm_b32 v97, v55, v51, s60
    v_perm_b32 v98, v63, v59, s60
    v_perm_b32 v99, v71, v67, s60
    v_perm_b32 v100, v47, v43, s61
    v_perm_b32 v101, v55, v51, s61
    v_perm_b32 v102, v63, v59, s61
    v_perm_b32 v103, v71, v67, s61
    v_xor_b32 v31, 0, v13
    v_lshl_add_u32 v31, v31, 4, v12
    buffer_store_dwordx4 v[72:75], v31, s[16:19], 0 offen
    v_xor_b32 v31, 0, v13
    v_lshl_add_u32 v31, v31, 4, v12
    v_add_u32 v31, 128, v31
    buffer_store_dwordx4 v[76:79], v31, s[16:19], 0 offen
    v_xor_b32 v31, 1, v13
    v_lshl_add_u32 v31, v31, 4, v12
    v_add_u32 v31, 256, v31
    buffer_store_dwordx4 v[80:83], v31, s[16:19], 0 offen
    v_xor_b32 v31, 1, v13
    v_lshl_add_u32 v31, v31, 4, v12
    v_add_u32 v31, 384, v31
    buffer_store_dwordx4 v[84:87], v31, s[16:19], 0 offen
    v_xor_b32 v31, 2, v13
    v_lshl_add_u32 v31, v31, 4, v12
    v_add_u32 v31, 512, v31
    buffer_store_dwordx4 v[88:91], v31, s[16:19], 0 offen
    v_xor_b32 v31, 2, v13
    v_lshl_add_u32 v31, v31, 4, v12
    v_add_u32 v31, 640, v31
    buffer_store_dwordx4 v[92:95], v31, s[16:19], 0 offen
    v_xor_b32 v31, 3, v13
    v_lshl_add_u32 v31, v31, 4, v12
    v_add_u32 v31, 768, v31
    buffer_store_dwordx4 v[96:99], v31, s[16:19], 0 offen
    v_xor_b32 v31, 3, v13
    v_lshl_add_u32 v31, v31, 4, v12
    v_add_u32 v31, 896, v31
    buffer_store_dwordx4 v[100:103], v31, s[16:19], 0 offen
    s_branch L_prep_end
L_role_w2:
    s_load_dwordx2 s[6:7], s[0:1], 88
    s_sub_u32 s3, s2, 738
    s_waitcnt lgkmcnt(0)

    s_mov_b32 s12, s6
    s_mov_b32 s13, s7
    s_mov_b32 s14, 5308416
    s_mov_b32 s15, 0x00020000
    s_add_u32 s16, s4, 12566528
    s_addc_u32 s17, s5, 0
    s_mov_b32 s18, 5308416
    s_mov_b32 s19, 0x00020000
    v_lshrrev_b32 v1, 6, v0
    s_lshl_b32 s26, s3, 2
    v_add_u32 v1, s26, v1
    s_mov_b32 s27, 59652324
    v_mul_hi_u32 v2, v1, s27
    v_mul_u32_u24 v3, 72, v2
    v_sub_u32 v3, v1, v3
    v_and_b32 v4, 7, v0
    v_bfe_u32 v5, v0, 3, 3
    v_lshl_add_u32 v6, v3, 3, v4
    v_lshl_add_u32 v7, v2, 3, v5
    v_mul_u32_u24 v8, 9216, v6
    v_lshl_add_u32 v8, v7, 4, v8
    s_mov_b32 s27, 238609295
    v_mul_hi_u32 v10, v7, s27
    v_mul_u32_u24 v11, 18, v10
    v_sub_u32 v11, v7, v11
    v_lshlrev_b32 v11, 3, v11
    v_mul_u32_u24 v12, 72, v10
    v_add_u32 v12, v12, v3
    v_mul_u32_u24 v12, 144, v12
    v_add_u32 v12, v12, v11
    v_lshlrev_b32 v12, 7, v12
    v_lshrrev_b32 v13, 1, v11
    v_and_b32 v13, 4, v13
    v_xor_b32 v13, v13, v4

    buffer_load_dwordx4 v[40:43], v8, s[12:15], 0 offen offset:0
    buffer_load_dwordx4 v[44:47], v8, s[12:15], 0 offen offset:1152
    buffer_load_dwordx4 v[48:51], v8, s[12:15], 0 offen offset:2304
    buffer_load_dwordx4 v[52:55], v8, s[12:15], 0 offen offset:3456
    v_add_u32 v30, 4608, v8
    buffer_load_dwordx4 v[56:59], v30, s[12:15], 0 offen
    v_add_u32 v30, 5760, v8
    buffer_load_dwordx4 v[60:63], v30, s[12:15], 0 offen
    v_add_u32 v30, 6912, v8
    buffer_load_dwordx4 v[64:67], v30, s[12:15], 0 offen
    v_add_u32 v30, 8064, v8
    buffer_load_dwordx4 v[68:71], v30, s[12:15], 0 offen
    s_mov_b32 s60, 0x05040100
    s_mov_b32 s61, 0x07060302
    s_waitcnt vmcnt(0)
    v_perm_b32 v72, v44, v40, s60
    v_perm_b32 v73, v52, v48, s60
    v_perm_b32 v74, v60, v56, s60
    v_perm_b32 v75, v68, v64, s60
    v_perm_b32 v76, v44, v40, s61
    v_perm_b32 v77, v52, v48, s61
    v_perm_b32 v78, v60, v56, s61
    v_perm_b32 v79, v68, v64, s61
    v_perm_b32 v80, v45, v41, s60
    v_perm_b32 v81, v53, v49, s60
    v_perm_b32 v82, v61, v57, s60
    v_perm_b32 v83, v69, v65, s60
    v_perm_b32 v84, v45, v41, s61
    v_perm_b32 v85, v53, v49, s61
    v_perm_b32 v86, v61, v57, s61
    v_perm_b32 v87, v69, v65, s61
    v_perm_b32 v88, v46, v42, s60
    v_perm_b32 v89, v54, v50, s60
    v_perm_b32 v90, v62, v58, s60
    v_perm_b32 v91, v70, v66, s60
    v_perm_b32 v92, v46, v42, s61
    v_perm_b32 v93, v54, v50, s61
    v_perm_b32 v94, v62, v58, s61
    v_perm_b32 v95, v70, v66, s61
    v_perm_b32 v96, v47, v43, s60
    v_perm_b32 v97, v55, v51, s60
    v_perm_b32 v98, v63, v59, s60
    v_perm_b32 v99, v71, v67, s60
    v_perm_b32 v100, v47, v43, s61
    v_perm_b32 v101, v55, v51, s61
    v_perm_b32 v102, v63, v59, s61
    v_perm_b32 v103, v71, v67, s61
    v_xor_b32 v31, 0, v13
    v_lshl_add_u32 v31, v31, 4, v12
    buffer_store_dwordx4 v[72:75], v31, s[16:19], 0 offen
    v_xor_b32 v31, 0, v13
    v_lshl_add_u32 v31, v31, 4, v12
    v_add_u32 v31, 128, v31
    buffer_store_dwordx4 v[76:79], v31, s[16:19], 0 offen
    v_xor_b32 v31, 1, v13
    v_lshl_add_u32 v31, v31, 4, v12
    v_add_u32 v31, 256, v31
    buffer_store_dwordx4 v[80:83], v31, s[16:19], 0 offen
    v_xor_b32 v31, 1, v13
    v_lshl_add_u32 v31, v31, 4, v12
    v_add_u32 v31, 384, v31
    buffer_store_dwordx4 v[84:87], v31, s[16:19], 0 offen
    v_xor_b32 v31, 2, v13
    v_lshl_add_u32 v31, v31, 4, v12
    v_add_u32 v31, 512, v31
    buffer_store_dwordx4 v[88:91], v31, s[16:19], 0 offen
    v_xor_b32 v31, 2, v13
    v_lshl_add_u32 v31, v31, 4, v12
    v_add_u32 v31, 640, v31
    buffer_store_dwordx4 v[92:95], v31, s[16:19], 0 offen
    v_xor_b32 v31, 3, v13
    v_lshl_add_u32 v31, v31, 4, v12
    v_add_u32 v31, 768, v31
    buffer_store_dwordx4 v[96:99], v31, s[16:19], 0 offen
    v_xor_b32 v31, 3, v13
    v_lshl_add_u32 v31, v31, 4, v12
    v_add_u32 v31, 896, v31
    buffer_store_dwordx4 v[100:103], v31, s[16:19], 0 offen
    s_branch L_prep_end
L_role_kgen:
    s_load_dwordx4 s[8:11], s[0:1], 8
    s_load_dwordx4 s[12:15], s[0:1], 24
    s_load_dwordx4 s[16:19], s[0:1], 40
    s_load_dwordx2 s[20:21], s[0:1], 56
    s_mov_b32 s3, s2
    s_waitcnt lgkmcnt(0)

    s_mov_b32 s24, s8
    s_mov_b32 s25, s9
    s_mov_b32 s26, 147456
    s_mov_b32 s27, 0x00020000
    s_mov_b32 s28, s10
    s_mov_b32 s29, s11
    s_mov_b32 s30, 147456
    s_mov_b32 s31, 0x00020000
    s_mov_b32 s32, s12
    s_mov_b32 s33, s13
    s_mov_b32 s34, 147456
    s_mov_b32 s35, 0x00020000
    s_mov_b32 s36, s14
    s_mov_b32 s37, s15
    s_mov_b32 s38, 147456
    s_mov_b32 s39, 0x00020000
    s_mov_b32 s40, s16
    s_mov_b32 s41, s17
    s_mov_b32 s42, 147456
    s_mov_b32 s43, 0x00020000
    s_mov_b32 s44, s18
    s_mov_b32 s45, s19
    s_mov_b32 s46, 147456
    s_mov_b32 s47, 0x00020000
    s_mov_b32 s48, s20
    s_mov_b32 s49, s21
    s_mov_b32 s50, 1152
    s_mov_b32 s51, 0x00020000
    s_add_u32 s52, s4, 2392064
    s_addc_u32 s53, s5, 0
    s_mov_b32 s54, 4866048
    s_mov_b32 s55, 0x00020000
    s_mov_b32 s60, 0x3fb8aa3b
    s_mov_b32 s61, 0x3e22f983
    v_lshrrev_b32 v1, 6, v0
    v_and_b32 v2, 63, v0
    v_and_b32 v3, 31, v0
    v_lshrrev_b32 v4, 5, v2
    v_lshl_add_u32 v5, v1, 5, v3
    s_lshl_b32 s62, s3, 7
    v_add_u32 v6, s62, v5
    v_lshlrev_b32 v6, 1, v6
    s_lshl_b32 s63, s3, 1
    v_mov_b32 v7, s63

    buffer_load_ushort v10, v6, s[24:27], 0 offen
    buffer_load_ushort v11, v6, s[28:31], 0 offen
    buffer_load_ushort v12, v6, s[32:35], 0 offen
    buffer_load_ushort v13, v6, s[36:39], 0 offen
    buffer_load_ushort v14, v6, s[40:43], 0 offen
    buffer_load_ushort v15, v6, s[44:47], 0 offen
    buffer_load_ushort v16, v7, s[48:51], 0 offen
    s_waitcnt vmcnt(0)

    v_lshlrev_b32 v10, 16, v10
    v_lshlrev_b32 v11, 16, v11
    v_lshlrev_b32 v12, 16, v12
    v_lshlrev_b32 v13, 16, v13
    v_lshlrev_b32 v14, 16, v14
    v_lshlrev_b32 v15, 16, v15
    v_lshlrev_b32 v16, 16, v16
    v_mul_f32 v17, s60, v16
    v_exp_f32 v17, v17
    s_nop 0

    v_cvt_pk_bf16_f32 v17, v17, v17
    v_lshlrev_b32 v17, 16, v17
    v_mul_f32 v20, v17, v10
    v_mul_f32 v21, v17, v11
    v_mul_f32 v22, v17, v12
    v_mul_f32 v23, v17, v13
    v_mul_f32 v24, v15, v23
    v_fma_f32 v24, v14, v22, -v24
    v_mul_f32 v25, v15, v22
    v_fma_f32 v25, v14, v23, v25
    v_mul_f32 v20, s60, v20
    v_mul_f32 v21, s61, v21
    v_mov_b32 v22, v24
    v_mov_b32 v23, v25
    v_mul_u32_u24 v26, 2064, v1
    v_lshlrev_b32 v27, 9, v1
    v_lshl_add_u32 v27, v3, 4, v27
    v_add_u32 v27, 33024, v27
    ds_write_b128 v27, v[20:23]

    v_mov_b32 v28, 0x45000000
    v_mul_f32 v29, v20, v28
    v_exp_f32 v29, v29
    v_mul_f32 v30, v21, v28
    v_fract_f32 v30, v30
    v_sin_f32 v31, v30
    v_cos_f32 v32, v30
    s_nop 0
    v_mul_f32 v33, v23, v31
    v_fma_f32 v33, v22, v32, -v33
    v_mul_f32 v33, v29, v33
    v_cmp_gt_u32 vcc, 32, v2
    v_cndmask_b32 v33, 0, v33, vcc

    ds_swizzle_b32 v34, v33 offset:0x041F
    s_waitcnt lgkmcnt(0)
    v_add_f32 v33, v33, v34
    ds_swizzle_b32 v34, v33 offset:0x081F
    s_waitcnt lgkmcnt(0)
    v_add_f32 v33, v33, v34
    ds_swizzle_b32 v34, v33 offset:0x101F
    s_waitcnt lgkmcnt(0)
    v_add_f32 v33, v33, v34
    ds_swizzle_b32 v34, v33 offset:0x201F
    s_waitcnt lgkmcnt(0)
    v_add_f32 v33, v33, v34
    ds_swizzle_b32 v34, v33 offset:0x401F
    s_waitcnt lgkmcnt(0)
    v_add_f32 v33, v33, v34
    s_nop 0
    v_readlane_b32 s64, v33, 32
    s_nop 1
    v_add_f32 v33, s64, v33
    v_lshlrev_b32 v26, 2, v26
    v_add_u32 v34, 8192, v26
    v_cmp_eq_u32 vcc, 0, v2
    s_and_saveexec_b64 s[56:57], vcc
    ds_write_b32 v34, v33
    s_mov_b64 exec, s[56:57]
    v_cvt_f32_u32 v40, v3
    v_mov_b32 v28, 0x42000000
    v_mul_f32 v41, v28, v40
    v_add_f32 v42, 0x44800000, v41
    v_lshlrev_b32 v43, 9, v1
    v_lshl_add_u32 v43, v4, 4, v43
    v_add_u32 v43, 33024, v43

    v_mov_b32 v64, 0
    v_mov_b32 v65, 0
    v_mov_b32 v66, 0
    v_mov_b32 v67, 0
    v_mov_b32 v68, 0
    v_mov_b32 v69, 0
    v_mov_b32 v70, 0
    v_mov_b32 v71, 0
    v_mov_b32 v72, 0
    v_mov_b32 v73, 0
    v_mov_b32 v74, 0
    v_mov_b32 v75, 0
    v_mov_b32 v76, 0
    v_mov_b32 v77, 0
    v_mov_b32 v78, 0
    v_mov_b32 v79, 0
    v_mov_b32 v80, 0
    v_mov_b32 v81, 0
    v_mov_b32 v82, 0
    v_mov_b32 v83, 0
    v_mov_b32 v84, 0
    v_mov_b32 v85, 0
    v_mov_b32 v86, 0
    v_mov_b32 v87, 0
    v_mov_b32 v88, 0
    v_mov_b32 v89, 0
    v_mov_b32 v90, 0
    v_mov_b32 v91, 0
    v_mov_b32 v92, 0
    v_mov_b32 v93, 0
    v_mov_b32 v94, 0
    v_mov_b32 v95, 0
    s_waitcnt lgkmcnt(0)
    s_mov_b32 s65, 0
L_kgen_loop:
    ds_read_b128 v[44:47], v43
    v_add_u32 v43, 32, v43
    s_waitcnt lgkmcnt(0)

    v_mul_f32 v56, v44, v41
    v_mul_f32 v57, v45, v41
    v_exp_f32 v56, v56
    v_fract_f32 v57, v57
    v_sin_f32 v58, v57
    v_cos_f32 v59, v57
    s_nop 0

    v_mul_f32 v60, v47, v58
    v_fma_f32 v60, v46, v59, -v60
    v_mul_f32 v61, v47, v59
    v_fma_f32 v61, v46, v58, v61
    v_mul_f32 v50, v56, v60
    v_mul_f32 v51, v56, v61
    v_sub_f32 v51, 0, v51

    v_mul_f32 v56, v44, v42
    v_mul_f32 v57, v45, v42
    v_exp_f32 v56, v56
    v_fract_f32 v57, v57
    v_sin_f32 v58, v57
    v_cos_f32 v59, v57
    s_nop 0

    v_mul_f32 v60, v47, v58
    v_fma_f32 v60, v46, v59, -v60
    v_mul_f32 v61, v47, v59
    v_fma_f32 v61, v46, v58, v61
    v_mul_f32 v52, v56, v60
    v_mul_f32 v53, v56, v61
    v_sub_f32 v53, 0, v53

    v_mul_f32 v56, v44, v40
    v_mul_f32 v57, v45, v40
    v_exp_f32 v56, v56
    v_fract_f32 v57, v57
    v_sin_f32 v58, v57
    v_cos_f32 v59, v57
    s_nop 0

    v_mul_f32 v54, v56, v59
    v_mul_f32 v55, v56, v58

    s_nop 1
    v_permlane32_swap_b32 v50, v51
    v_permlane32_swap_b32 v52, v53
    v_permlane32_swap_b32 v54, v55
    s_nop 1
    v_mfma_f32_32x32x2_f32 v[64:79], v50, v54, v[64:79]
    v_mfma_f32_32x32x2_f32 v[80:95], v52, v54, v[80:95]
    v_mfma_f32_32x32x2_f32 v[64:79], v51, v55, v[64:79]
    v_mfma_f32_32x32x2_f32 v[80:95], v53, v55, v[80:95]
    s_add_u32 s65, s65, 1
    s_cmp_lt_u32 s65, 16
    s_cbranch_scc1 L_kgen_loop
    s_nop 15
    s_nop 7
    v_lshlrev_b32 v34, 9, v4
    v_lshl_add_u32 v34, v3, 2, v34
    v_add_u32 v34, v26, v34

    ds_write_b32 v34, v64 offset:0
    ds_write_b32 v34, v65 offset:128
    ds_write_b32 v34, v66 offset:256
    ds_write_b32 v34, v67 offset:384
    ds_write_b32 v34, v68 offset:1024
    ds_write_b32 v34, v69 offset:1152
    ds_write_b32 v34, v70 offset:1280
    ds_write_b32 v34, v71 offset:1408
    ds_write_b32 v34, v72 offset:2048
    ds_write_b32 v34, v73 offset:2176
    ds_write_b32 v34, v74 offset:2304
    ds_write_b32 v34, v75 offset:2432
    ds_write_b32 v34, v76 offset:3072
    ds_write_b32 v34, v77 offset:3200
    ds_write_b32 v34, v78 offset:3328
    ds_write_b32 v34, v79 offset:3456
    ds_write_b32 v34, v80 offset:4096
    ds_write_b32 v34, v81 offset:4224
    ds_write_b32 v34, v82 offset:4352
    ds_write_b32 v34, v83 offset:4480
    ds_write_b32 v34, v84 offset:5120
    ds_write_b32 v34, v85 offset:5248
    ds_write_b32 v34, v86 offset:5376
    ds_write_b32 v34, v87 offset:5504
    ds_write_b32 v34, v88 offset:6144
    ds_write_b32 v34, v89 offset:6272
    ds_write_b32 v34, v90 offset:6400
    ds_write_b32 v34, v91 offset:6528
    ds_write_b32 v34, v92 offset:7168
    ds_write_b32 v34, v93 offset:7296
    ds_write_b32 v34, v94 offset:7424
    ds_write_b32 v34, v95 offset:7552
    s_waitcnt lgkmcnt(0)
    s_barrier

    s_mul_i32 s66, s3, 8448
    v_lshlrev_b32 v35, 4, v0
    v_add_u32 v35, s66, v35
    v_lshlrev_b32 v36, 3, v0
    v_sub_u32 v36, 2047, v36

    v_subrev_u32 v37, 0, v36
    v_cvt_f32_u32 v37, v37

    v_cvt_pk_bf16_f32 v37, v37, v37
    v_lshlrev_b32 v37, 16, v37
    v_cvt_u32_f32 v37, v37
    v_lshlrev_b32 v37, 2, v37
    ds_read_b32 v44, v37
    ds_read_b32 v52, v37 offset:8256
    ds_read_b32 v60, v37 offset:16512
    ds_read_b32 v68, v37 offset:24768

    v_subrev_u32 v37, 1, v36
    v_cvt_f32_u32 v37, v37

    v_cvt_pk_bf16_f32 v37, v37, v37
    v_lshlrev_b32 v37, 16, v37
    v_cvt_u32_f32 v37, v37
    v_lshlrev_b32 v37, 2, v37
    ds_read_b32 v45, v37
    ds_read_b32 v53, v37 offset:8256
    ds_read_b32 v61, v37 offset:16512
    ds_read_b32 v69, v37 offset:24768

    v_subrev_u32 v37, 2, v36
    v_cvt_f32_u32 v37, v37

    v_cvt_pk_bf16_f32 v37, v37, v37
    v_lshlrev_b32 v37, 16, v37
    v_cvt_u32_f32 v37, v37
    v_lshlrev_b32 v37, 2, v37
    ds_read_b32 v46, v37
    ds_read_b32 v54, v37 offset:8256
    ds_read_b32 v62, v37 offset:16512
    ds_read_b32 v70, v37 offset:24768

    v_subrev_u32 v37, 3, v36
    v_cvt_f32_u32 v37, v37

    v_cvt_pk_bf16_f32 v37, v37, v37
    v_lshlrev_b32 v37, 16, v37
    v_cvt_u32_f32 v37, v37
    v_lshlrev_b32 v37, 2, v37
    ds_read_b32 v47, v37
    ds_read_b32 v55, v37 offset:8256
    ds_read_b32 v63, v37 offset:16512
    ds_read_b32 v71, v37 offset:24768

    v_subrev_u32 v37, 4, v36
    v_cvt_f32_u32 v37, v37

    v_cvt_pk_bf16_f32 v37, v37, v37
    v_lshlrev_b32 v37, 16, v37
    v_cvt_u32_f32 v37, v37
    v_lshlrev_b32 v37, 2, v37
    ds_read_b32 v48, v37
    ds_read_b32 v56, v37 offset:8256
    ds_read_b32 v64, v37 offset:16512
    ds_read_b32 v72, v37 offset:24768

    v_subrev_u32 v37, 5, v36
    v_cvt_f32_u32 v37, v37

    v_cvt_pk_bf16_f32 v37, v37, v37
    v_lshlrev_b32 v37, 16, v37
    v_cvt_u32_f32 v37, v37
    v_lshlrev_b32 v37, 2, v37
    ds_read_b32 v49, v37
    ds_read_b32 v57, v37 offset:8256
    ds_read_b32 v65, v37 offset:16512
    ds_read_b32 v73, v37 offset:24768

    v_subrev_u32 v37, 6, v36
    v_cvt_f32_u32 v37, v37

    v_cvt_pk_bf16_f32 v37, v37, v37
    v_lshlrev_b32 v37, 16, v37
    v_cvt_u32_f32 v37, v37
    v_lshlrev_b32 v37, 2, v37
    ds_read_b32 v50, v37
    ds_read_b32 v58, v37 offset:8256
    ds_read_b32 v66, v37 offset:16512
    ds_read_b32 v74, v37 offset:24768

    v_subrev_u32 v37, 7, v36
    v_cvt_f32_u32 v37, v37

    v_cvt_pk_bf16_f32 v37, v37, v37
    v_lshlrev_b32 v37, 16, v37
    v_cvt_u32_f32 v37, v37
    v_lshlrev_b32 v37, 2, v37
    ds_read_b32 v51, v37
    ds_read_b32 v59, v37 offset:8256
    ds_read_b32 v67, v37 offset:16512
    ds_read_b32 v75, v37 offset:24768

    s_waitcnt lgkmcnt(0)
    v_add_f32 v44, v44, v52
    v_add_f32 v60, v60, v68
    v_add_f32 v44, v44, v60

    v_add_f32 v45, v45, v53
    v_add_f32 v61, v61, v69
    v_add_f32 v45, v45, v61

    v_add_f32 v46, v46, v54
    v_add_f32 v62, v62, v70
    v_add_f32 v46, v46, v62

    v_add_f32 v47, v47, v55
    v_add_f32 v63, v63, v71
    v_add_f32 v47, v47, v63

    v_add_f32 v48, v48, v56
    v_add_f32 v64, v64, v72
    v_add_f32 v48, v48, v64

    v_add_f32 v49, v49, v57
    v_add_f32 v65, v65, v73
    v_add_f32 v49, v49, v65

    v_add_f32 v50, v50, v58
    v_add_f32 v66, v66, v74
    v_add_f32 v50, v50, v66

    v_add_f32 v51, v51, v59
    v_add_f32 v67, v67, v75
    v_add_f32 v51, v51, v67

    v_cvt_pk_bf16_f32 v52, v44, v44
    v_lshlrev_b32 v52, 16, v52
    v_sub_f32 v60, v44, v52
    v_cvt_pk_bf16_f32 v53, v45, v45
    v_lshlrev_b32 v53, 16, v53
    v_sub_f32 v61, v45, v53
    v_cvt_pk_bf16_f32 v54, v46, v46
    v_lshlrev_b32 v54, 16, v54
    v_sub_f32 v62, v46, v54
    v_cvt_pk_bf16_f32 v55, v47, v47
    v_lshlrev_b32 v55, 16, v55
    v_sub_f32 v63, v47, v55
    v_cvt_pk_bf16_f32 v56, v48, v48
    v_lshlrev_b32 v56, 16, v56
    v_sub_f32 v64, v48, v56
    v_cvt_pk_bf16_f32 v57, v49, v49
    v_lshlrev_b32 v57, 16, v57
    v_sub_f32 v65, v49, v57
    v_cvt_pk_bf16_f32 v58, v50, v50
    v_lshlrev_b32 v58, 16, v58
    v_sub_f32 v66, v50, v58
    v_cvt_pk_bf16_f32 v59, v51, v51
    v_lshlrev_b32 v59, 16, v59
    v_sub_f32 v67, v51, v59
    v_cvt_pk_bf16_f32 v76, v52, v53
    v_cvt_pk_bf16_f32 v80, v60, v61
    v_cvt_pk_bf16_f32 v77, v54, v55
    v_cvt_pk_bf16_f32 v81, v62, v63
    v_cvt_pk_bf16_f32 v78, v56, v57
    v_cvt_pk_bf16_f32 v82, v64, v65
    v_cvt_pk_bf16_f32 v79, v58, v59
    v_cvt_pk_bf16_f32 v83, v66, v67
    buffer_store_dwordx4 v[76:79], v35, s[52:55], 0 offen
    v_add_u32 v36, 4224, v35
    buffer_store_dwordx4 v[80:83], v36, s[52:55], 0 offen
    v_cmp_gt_u32 vcc, 8, v0
    s_and_saveexec_b64 s[56:57], vcc
    s_cbranch_execz L_prep_end
    v_mov_b32 v76, 0
    v_mov_b32 v77, 0
    v_mov_b32 v78, 0
    v_mov_b32 v79, 0
    v_add_u32 v35, 4096, v35
    buffer_store_dwordx4 v[76:79], v35, s[52:55], 0 offen
    v_add_u32 v35, 4224, v35
    buffer_store_dwordx4 v[76:79], v35, s[52:55], 0 offen

L_prep_end:
    s_endpgm

.globl conv_kernel
.p2align 8
.type conv_kernel,@function
conv_kernel:
    s_cmp_ge_u32 s2, 576
    s_cbranch_scc1 L_conv_end
    s_load_dwordx2 s[4:5], s[0:1], 128
    s_load_dwordx2 s[6:7], s[0:1], 64
    s_waitcnt lgkmcnt(0)

    s_add_u32 s8, s4, 2392064
    s_addc_u32 s9, s5, 0
    s_mov_b32 s10, 4866048
    s_mov_b32 s11, 0x00020000
    s_add_u32 s12, s4, 32768
    s_addc_u32 s13, s5, 0
    s_mov_b32 s14, 2359296
    s_mov_b32 s15, 0x00020000
    s_add_u32 s16, s4, 16384
    s_addc_u32 s17, s5, 0
    s_mov_b32 s18, 8192
    s_mov_b32 s19, 0x00020000
    s_add_u32 s20, s4, 24576
    s_addc_u32 s21, s5, 0
    s_mov_b32 s22, 8192
    s_mov_b32 s23, 0x00020000
    s_mov_b32 s24, s4
    s_mov_b32 s25, s5
    s_mov_b32 s26, 13824
    s_mov_b32 s27, 0x00020000
    s_mov_b32 s28, s6
    s_mov_b32 s29, s7
    s_mov_b32 s30, 1152
    s_mov_b32 s31, 0x00020000
    s_add_u32 s32, s4, 17874944
    s_addc_u32 s33, s5, 0
    s_mov_b32 s34, 2359296
    s_mov_b32 s35, 0x00020000
    s_mul_i32 s36, s2, 8448
    v_add_u32 v1, 0, v0
    v_cmp_le_u32 vcc, 260, v1
    v_cndmask_b32 v2, 0, 1, vcc
    v_mul_u32_u24 v3, 260, v2
    v_sub_u32 v3, v1, v3
    v_mul_u32_u24 v4, 4224, v2
    v_lshl_add_u32 v4, v3, 4, v4
    v_add_u32 v4, s36, v4
    v_mul_u32_u24 v5, 33280, v2
    v_lshl_add_u32 v5, v3, 4, v5
    v_cmp_gt_u32 vcc, 520, v1
    s_and_saveexec_b64 s[38:39], vcc
    s_cbranch_execz L_conv_skip0
    buffer_load_dwordx4 v[40:43], v4, s[8:11], 0 offen
    buffer_load_dwordx4 v[44:47], v4, s[8:11], 0 offen offset:16
    s_waitcnt vmcnt(0)

    ds_write_b128 v5, v[40:43] offset:0
    v_alignbit_b32 v50, v41, v40, 16
    v_alignbit_b32 v51, v42, v41, 16
    v_alignbit_b32 v52, v43, v42, 16
    v_alignbit_b32 v53, v44, v43, 16
    ds_write_b128 v5, v[50:53] offset:4160
    v_mov_b32 v50, v41
    v_mov_b32 v51, v42
    v_mov_b32 v52, v43
    v_mov_b32 v53, v44
    ds_write_b128 v5, v[50:53] offset:8320
    v_alignbit_b32 v50, v42, v41, 16
    v_alignbit_b32 v51, v43, v42, 16
    v_alignbit_b32 v52, v44, v43, 16
    v_alignbit_b32 v53, v45, v44, 16
    ds_write_b128 v5, v[50:53] offset:12480
    ds_write_b128 v5, v[42:45] offset:16640
    v_alignbit_b32 v50, v43, v42, 16
    v_alignbit_b32 v51, v44, v43, 16
    v_alignbit_b32 v52, v45, v44, 16
    v_alignbit_b32 v53, v46, v45, 16
    ds_write_b128 v5, v[50:53] offset:20800
    v_mov_b32 v50, v43
    v_mov_b32 v51, v44
    v_mov_b32 v52, v45
    v_mov_b32 v53, v46
    ds_write_b128 v5, v[50:53] offset:24960
    v_alignbit_b32 v50, v44, v43, 16
    v_alignbit_b32 v51, v45, v44, 16
    v_alignbit_b32 v52, v46, v45, 16
    v_alignbit_b32 v53, v47, v46, 16
    ds_write_b128 v5, v[50:53] offset:29120
L_conv_skip0:
    s_mov_b64 exec, s[38:39]
    v_add_u32 v1, 256, v0
    v_cmp_le_u32 vcc, 260, v1
    v_cndmask_b32 v2, 0, 1, vcc
    v_mul_u32_u24 v3, 260, v2
    v_sub_u32 v3, v1, v3
    v_mul_u32_u24 v4, 4224, v2
    v_lshl_add_u32 v4, v3, 4, v4
    v_add_u32 v4, s36, v4
    v_mul_u32_u24 v5, 33280, v2
    v_lshl_add_u32 v5, v3, 4, v5
    v_cmp_gt_u32 vcc, 520, v1
    s_and_saveexec_b64 s[38:39], vcc
    s_cbranch_execz L_conv_skip1
    buffer_load_dwordx4 v[40:43], v4, s[8:11], 0 offen
    buffer_load_dwordx4 v[44:47], v4, s[8:11], 0 offen offset:16
    s_waitcnt vmcnt(0)

    ds_write_b128 v5, v[40:43] offset:0
    v_alignbit_b32 v50, v41, v40, 16
    v_alignbit_b32 v51, v42, v41, 16
    v_alignbit_b32 v52, v43, v42, 16
    v_alignbit_b32 v53, v44, v43, 16
    ds_write_b128 v5, v[50:53] offset:4160
    v_mov_b32 v50, v41
    v_mov_b32 v51, v42
    v_mov_b32 v52, v43
    v_mov_b32 v53, v44
    ds_write_b128 v5, v[50:53] offset:8320
    v_alignbit_b32 v50, v42, v41, 16
    v_alignbit_b32 v51, v43, v42, 16
    v_alignbit_b32 v52, v44, v43, 16
    v_alignbit_b32 v53, v45, v44, 16
    ds_write_b128 v5, v[50:53] offset:12480
    ds_write_b128 v5, v[42:45] offset:16640
    v_alignbit_b32 v50, v43, v42, 16
    v_alignbit_b32 v51, v44, v43, 16
    v_alignbit_b32 v52, v45, v44, 16
    v_alignbit_b32 v53, v46, v45, 16
    ds_write_b128 v5, v[50:53] offset:20800
    v_mov_b32 v50, v43
    v_mov_b32 v51, v44
    v_mov_b32 v52, v45
    v_mov_b32 v53, v46
    ds_write_b128 v5, v[50:53] offset:24960
    v_alignbit_b32 v50, v44, v43, 16
    v_alignbit_b32 v51, v45, v44, 16
    v_alignbit_b32 v52, v46, v45, 16
    v_alignbit_b32 v53, v47, v46, 16
    ds_write_b128 v5, v[50:53] offset:29120
L_conv_skip1:
    s_mov_b64 exec, s[38:39]
    v_add_u32 v1, 512, v0
    v_cmp_le_u32 vcc, 260, v1
    v_cndmask_b32 v2, 0, 1, vcc
    v_mul_u32_u24 v3, 260, v2
    v_sub_u32 v3, v1, v3
    v_mul_u32_u24 v4, 4224, v2
    v_lshl_add_u32 v4, v3, 4, v4
    v_add_u32 v4, s36, v4
    v_mul_u32_u24 v5, 33280, v2
    v_lshl_add_u32 v5, v3, 4, v5
    v_cmp_gt_u32 vcc, 520, v1
    s_and_saveexec_b64 s[38:39], vcc
    s_cbranch_execz L_conv_skip2
    buffer_load_dwordx4 v[40:43], v4, s[8:11], 0 offen
    buffer_load_dwordx4 v[44:47], v4, s[8:11], 0 offen offset:16
    s_waitcnt vmcnt(0)

    ds_write_b128 v5, v[40:43] offset:0
    v_alignbit_b32 v50, v41, v40, 16
    v_alignbit_b32 v51, v42, v41, 16
    v_alignbit_b32 v52, v43, v42, 16
    v_alignbit_b32 v53, v44, v43, 16
    ds_write_b128 v5, v[50:53] offset:4160
    v_mov_b32 v50, v41
    v_mov_b32 v51, v42
    v_mov_b32 v52, v43
    v_mov_b32 v53, v44
    ds_write_b128 v5, v[50:53] offset:8320
    v_alignbit_b32 v50, v42, v41, 16
    v_alignbit_b32 v51, v43, v42, 16
    v_alignbit_b32 v52, v44, v43, 16
    v_alignbit_b32 v53, v45, v44, 16
    ds_write_b128 v5, v[50:53] offset:12480
    ds_write_b128 v5, v[42:45] offset:16640
    v_alignbit_b32 v50, v43, v42, 16
    v_alignbit_b32 v51, v44, v43, 16
    v_alignbit_b32 v52, v45, v44, 16
    v_alignbit_b32 v53, v46, v45, 16
    ds_write_b128 v5, v[50:53] offset:20800
    v_mov_b32 v50, v43
    v_mov_b32 v51, v44
    v_mov_b32 v52, v45
    v_mov_b32 v53, v46
    ds_write_b128 v5, v[50:53] offset:24960
    v_alignbit_b32 v50, v44, v43, 16
    v_alignbit_b32 v51, v45, v44, 16
    v_alignbit_b32 v52, v46, v45, 16
    v_alignbit_b32 v53, v47, v46, 16
    ds_write_b128 v5, v[50:53] offset:29120
L_conv_skip2:
    s_mov_b64 exec, s[38:39]
    s_lshl_b32 s37, s2, 12
    v_lshlrev_b32 v6, 4, v0
    v_add_u32 v7, s37, v6
    buffer_load_dwordx4 v[60:63], v7, s[12:15], 0 offen
    v_lshlrev_b32 v8, 5, v0
    buffer_load_dwordx4 v[64:67], v8, s[16:19], 0 offen
    buffer_load_dwordx4 v[68:71], v8, s[16:19], 0 offen offset:16
    buffer_load_dwordx4 v[72:75], v8, s[20:23], 0 offen
    buffer_load_dwordx4 v[76:79], v8, s[20:23], 0 offen offset:16
    s_lshl_b32 s40, s2, 2
    v_mov_b32 v9, s40
    buffer_load_dword v80, v9, s[24:27], 0 offen
    buffer_load_dword v81, v9, s[24:27], 0 offen offset:2304
    v_add_u32 v10, 4608, v9
    buffer_load_dword v82, v10, s[24:27], 0 offen
    s_lshl_b32 s41, s2, 1
    v_mov_b32 v10, s41
    buffer_load_ushort v83, v10, s[28:31], 0 offen
    s_mov_b32 s42, 0xffff0000
    s_waitcnt vmcnt(0)
    v_lshlrev_b32 v83, 16, v83
    v_add_f32 v81, 1.0, v81

    v_cvt_pk_bf16_f32 v81, v81, v81
    v_lshlrev_b32 v81, 16, v81
    v_lshlrev_b32 v84, 16, v60
    v_sub_f32 v100, v84, v64
    v_cvt_pk_bf16_f32 v100, v100, v100
    v_lshlrev_b32 v100, 16, v100
    v_rcp_f32 v101, v72
    s_nop 0
    v_mul_f32 v102, v100, v101
    v_fma_f32 v103, -v102, v72, v100
    v_fma_f32 v102, v103, v101, v102

    v_cvt_pk_bf16_f32 v102, v102, v102
    v_lshlrev_b32 v102, 16, v102
    v_mul_f32 v102, v102, v81
    v_cvt_pk_bf16_f32 v102, v102, v102
    v_lshlrev_b32 v102, 16, v102
    v_add_f32 v92, v102, v80
    v_cvt_pk_bf16_f32 v92, v92, v92
    v_lshlrev_b32 v92, 16, v92
    v_and_b32 v85, s42, v60
    v_sub_f32 v100, v85, v65
    v_cvt_pk_bf16_f32 v100, v100, v100
    v_lshlrev_b32 v100, 16, v100
    v_rcp_f32 v101, v73
    s_nop 0
    v_mul_f32 v102, v100, v101
    v_fma_f32 v103, -v102, v73, v100
    v_fma_f32 v102, v103, v101, v102

    v_cvt_pk_bf16_f32 v102, v102, v102
    v_lshlrev_b32 v102, 16, v102
    v_mul_f32 v102, v102, v81
    v_cvt_pk_bf16_f32 v102, v102, v102
    v_lshlrev_b32 v102, 16, v102
    v_add_f32 v93, v102, v80
    v_cvt_pk_bf16_f32 v93, v93, v93
    v_lshlrev_b32 v93, 16, v93
    v_lshlrev_b32 v86, 16, v61
    v_sub_f32 v100, v86, v66
    v_cvt_pk_bf16_f32 v100, v100, v100
    v_lshlrev_b32 v100, 16, v100
    v_rcp_f32 v101, v74
    s_nop 0
    v_mul_f32 v102, v100, v101
    v_fma_f32 v103, -v102, v74, v100
    v_fma_f32 v102, v103, v101, v102

    v_cvt_pk_bf16_f32 v102, v102, v102
    v_lshlrev_b32 v102, 16, v102
    v_mul_f32 v102, v102, v81
    v_cvt_pk_bf16_f32 v102, v102, v102
    v_lshlrev_b32 v102, 16, v102
    v_add_f32 v94, v102, v80
    v_cvt_pk_bf16_f32 v94, v94, v94
    v_lshlrev_b32 v94, 16, v94
    v_and_b32 v87, s42, v61
    v_sub_f32 v100, v87, v67
    v_cvt_pk_bf16_f32 v100, v100, v100
    v_lshlrev_b32 v100, 16, v100
    v_rcp_f32 v101, v75
    s_nop 0
    v_mul_f32 v102, v100, v101
    v_fma_f32 v103, -v102, v75, v100
    v_fma_f32 v102, v103, v101, v102

    v_cvt_pk_bf16_f32 v102, v102, v102
    v_lshlrev_b32 v102, 16, v102
    v_mul_f32 v102, v102, v81
    v_cvt_pk_bf16_f32 v102, v102, v102
    v_lshlrev_b32 v102, 16, v102
    v_add_f32 v95, v102, v80
    v_cvt_pk_bf16_f32 v95, v95, v95
    v_lshlrev_b32 v95, 16, v95
    v_lshlrev_b32 v88, 16, v62
    v_sub_f32 v100, v88, v68
    v_cvt_pk_bf16_f32 v100, v100, v100
    v_lshlrev_b32 v100, 16, v100
    v_rcp_f32 v101, v76
    s_nop 0
    v_mul_f32 v102, v100, v101
    v_fma_f32 v103, -v102, v76, v100
    v_fma_f32 v102, v103, v101, v102

    v_cvt_pk_bf16_f32 v102, v102, v102
    v_lshlrev_b32 v102, 16, v102
    v_mul_f32 v102, v102, v81
    v_cvt_pk_bf16_f32 v102, v102, v102
    v_lshlrev_b32 v102, 16, v102
    v_add_f32 v96, v102, v80
    v_cvt_pk_bf16_f32 v96, v96, v96
    v_lshlrev_b32 v96, 16, v96
    v_and_b32 v89, s42, v62
    v_sub_f32 v100, v89, v69
    v_cvt_pk_bf16_f32 v100, v100, v100
    v_lshlrev_b32 v100, 16, v100
    v_rcp_f32 v101, v77
    s_nop 0
    v_mul_f32 v102, v100, v101
    v_fma_f32 v103, -v102, v77, v100
    v_fma_f32 v102, v103, v101, v102

    v_cvt_pk_bf16_f32 v102, v102, v102
    v_lshlrev_b32 v102, 16, v102
    v_mul_f32 v102, v102, v81
    v_cvt_pk_bf16_f32 v102, v102, v102
    v_lshlrev_b32 v102, 16, v102
    v_add_f32 v97, v102, v80
    v_cvt_pk_bf16_f32 v97, v97, v97
    v_lshlrev_b32 v97, 16, v97
    v_lshlrev_b32 v90, 16, v63
    v_sub_f32 v100, v90, v70
    v_cvt_pk_bf16_f32 v100, v100, v100
    v_lshlrev_b32 v100, 16, v100
    v_rcp_f32 v101, v78
    s_nop 0
    v_mul_f32 v102, v100, v101
    v_fma_f32 v103, -v102, v78, v100
    v_fma_f32 v102, v103, v101, v102

    v_cvt_pk_bf16_f32 v102, v102, v102
    v_lshlrev_b32 v102, 16, v102
    v_mul_f32 v102, v102, v81
    v_cvt_pk_bf16_f32 v102, v102, v102
    v_lshlrev_b32 v102, 16, v102
    v_add_f32 v98, v102, v80
    v_cvt_pk_bf16_f32 v98, v98, v98
    v_lshlrev_b32 v98, 16, v98
    v_and_b32 v91, s42, v63
    v_sub_f32 v100, v91, v71
    v_cvt_pk_bf16_f32 v100, v100, v100
    v_lshlrev_b32 v100, 16, v100
    v_rcp_f32 v101, v79
    s_nop 0
    v_mul_f32 v102, v100, v101
    v_fma_f32 v103, -v102, v79, v100
    v_fma_f32 v102, v103, v101, v102

    v_cvt_pk_bf16_f32 v102, v102, v102
    v_lshlrev_b32 v102, 16, v102
    v_mul_f32 v102, v102, v81
    v_cvt_pk_bf16_f32 v102, v102, v102
    v_lshlrev_b32 v102, 16, v102
    v_add_f32 v99, v102, v80
    v_cvt_pk_bf16_f32 v99, v99, v99
    v_lshlrev_b32 v99, 16, v99
    v_cvt_pk_bf16_f32 v104, v92, v93
    v_cvt_pk_bf16_f32 v105, v94, v95
    v_cvt_pk_bf16_f32 v106, v96, v97
    v_cvt_pk_bf16_f32 v107, v98, v99
    v_lshrrev_b32 v11, 2, v0
    v_mul_u32_u24 v11, 80, v11
    v_and_b32 v12, 3, v0
    v_lshl_add_u32 v11, v12, 4, v11
    v_add_u32 v11, 66560, v11
    ds_write_b128 v11, v[104:107] offset:5120
    v_mov_b32 v104, 0
    v_mov_b32 v105, 0
    v_mov_b32 v106, 0
    v_mov_b32 v107, 0
    ds_write_b128 v11, v[104:107]
    v_and_b32 v13, 31, v0
    v_bfe_u32 v14, v0, 5, 1
    v_lshrrev_b32 v15, 6, v0
    v_sub_u32 v16, 7, v13
    v_and_b32 v16, 7, v16
    v_mul_u32_u24 v17, 4160, v16
    v_sub_u32 v18, 2047, v13
    v_lshl_add_u32 v18, v14, 3, v18
    v_sub_u32 v18, v18, v16
    v_lshl_add_u32 v17, v18, 1, v17
    v_subrev_u32 v17, 4032, v17
    v_add_u32 v18, 64, v13
    v_mul_u32_u24 v18, 80, v18
    v_lshl_add_u32 v18, v14, 4, v18
    v_add_u32 v18, 61440, v18
    v_readfirstlane_b32 s43, v15
    s_waitcnt lgkmcnt(0)
    s_barrier

    v_mov_b32 v110, 0
    v_mov_b32 v111, 0
    v_mov_b32 v112, 0
    v_mov_b32 v113, 0
    v_mov_b32 v114, 0
    v_mov_b32 v115, 0
    v_mov_b32 v116, 0
    v_mov_b32 v117, 0
    v_mov_b32 v118, 0
    v_mov_b32 v119, 0
    v_mov_b32 v120, 0
    v_mov_b32 v121, 0
    v_mov_b32 v122, 0
    v_mov_b32 v123, 0
    v_mov_b32 v124, 0
    v_mov_b32 v125, 0
    v_mov_b32 v126, 0
    v_mov_b32 v127, 0
    v_mov_b32 v128, 0
    v_mov_b32 v129, 0
    v_mov_b32 v130, 0
    v_mov_b32 v131, 0
    v_mov_b32 v132, 0
    v_mov_b32 v133, 0
    v_mov_b32 v134, 0
    v_mov_b32 v135, 0
    v_mov_b32 v136, 0
    v_mov_b32 v137, 0
    v_mov_b32 v138, 0
    v_mov_b32 v139, 0
    v_mov_b32 v140, 0
    v_mov_b32 v141, 0
    s_cmp_lg_u32 s43, 0
    s_cbranch_scc1 L_conv_w1
    ds_read_b128 v[142:145], v17 offset:4032
    ds_read_b128 v[146:149], v17 offset:4064
    ds_read_b128 v[150:153], v17 offset:37312
    ds_read_b128 v[154:157], v17 offset:37344
    ds_read_b128 v[174:177], v18 offset:5120
    ds_read_b128 v[178:181], v18 offset:5152
    ds_read_b128 v[182:185], v18 offset:7680
    ds_read_b128 v[186:189], v18 offset:7712
    ds_read_b128 v[158:161], v17 offset:3968
    ds_read_b128 v[162:165], v17 offset:4000
    ds_read_b128 v[166:169], v17 offset:37248
    ds_read_b128 v[170:173], v17 offset:37280
    ds_read_b128 v[190:193], v18 offset:5040
    ds_read_b128 v[194:197], v18 offset:5072
    ds_read_b128 v[198:201], v18 offset:7600
    ds_read_b128 v[202:205], v18 offset:7632
    s_waitcnt lgkmcnt(8)
    v_mfma_f32_32x32x16_bf16 v[110:125], v[142:145], v[174:177], v[110:125]
    v_mfma_f32_32x32x16_bf16 v[110:125], v[146:149], v[178:181], v[110:125]
    v_mfma_f32_32x32x16_bf16 v[110:125], v[150:153], v[174:177], v[110:125]
    v_mfma_f32_32x32x16_bf16 v[110:125], v[154:157], v[178:181], v[110:125]
    v_mfma_f32_32x32x16_bf16 v[126:141], v[142:145], v[182:185], v[126:141]
    v_mfma_f32_32x32x16_bf16 v[126:141], v[146:149], v[186:189], v[126:141]
    v_mfma_f32_32x32x16_bf16 v[126:141], v[150:153], v[182:185], v[126:141]
    v_mfma_f32_32x32x16_bf16 v[126:141], v[154:157], v[186:189], v[126:141]
    ds_read_b128 v[142:145], v17 offset:3904
    ds_read_b128 v[146:149], v17 offset:3936
    ds_read_b128 v[150:153], v17 offset:37184
    ds_read_b128 v[154:157], v17 offset:37216
    ds_read_b128 v[174:177], v18 offset:4960
    ds_read_b128 v[178:181], v18 offset:4992
    ds_read_b128 v[182:185], v18 offset:7520
    ds_read_b128 v[186:189], v18 offset:7552
    s_waitcnt lgkmcnt(8)
    v_mfma_f32_32x32x16_bf16 v[110:125], v[158:161], v[190:193], v[110:125]
    v_mfma_f32_32x32x16_bf16 v[110:125], v[162:165], v[194:197], v[110:125]
    v_mfma_f32_32x32x16_bf16 v[110:125], v[166:169], v[190:193], v[110:125]
    v_mfma_f32_32x32x16_bf16 v[110:125], v[170:173], v[194:197], v[110:125]
    v_mfma_f32_32x32x16_bf16 v[126:141], v[158:161], v[198:201], v[126:141]
    v_mfma_f32_32x32x16_bf16 v[126:141], v[162:165], v[202:205], v[126:141]
    v_mfma_f32_32x32x16_bf16 v[126:141], v[166:169], v[198:201], v[126:141]
    v_mfma_f32_32x32x16_bf16 v[126:141], v[170:173], v[202:205], v[126:141]
    ds_read_b128 v[158:161], v17 offset:3840
    ds_read_b128 v[162:165], v17 offset:3872
    ds_read_b128 v[166:169], v17 offset:37120
    ds_read_b128 v[170:173], v17 offset:37152
    ds_read_b128 v[190:193], v18 offset:4880
    ds_read_b128 v[194:197], v18 offset:4912
    ds_read_b128 v[198:201], v18 offset:7440
    ds_read_b128 v[202:205], v18 offset:7472
    s_waitcnt lgkmcnt(8)
    v_mfma_f32_32x32x16_bf16 v[110:125], v[142:145], v[174:177], v[110:125]
    v_mfma_f32_32x32x16_bf16 v[110:125], v[146:149], v[178:181], v[110:125]
    v_mfma_f32_32x32x16_bf16 v[110:125], v[150:153], v[174:177], v[110:125]
    v_mfma_f32_32x32x16_bf16 v[110:125], v[154:157], v[178:181], v[110:125]
    v_mfma_f32_32x32x16_bf16 v[126:141], v[142:145], v[182:185], v[126:141]
    v_mfma_f32_32x32x16_bf16 v[126:141], v[146:149], v[186:189], v[126:141]
    v_mfma_f32_32x32x16_bf16 v[126:141], v[150:153], v[182:185], v[126:141]
    v_mfma_f32_32x32x16_bf16 v[126:141], v[154:157], v[186:189], v[126:141]
    ds_read_b128 v[142:145], v17 offset:3776
    ds_read_b128 v[146:149], v17 offset:3808
    ds_read_b128 v[150:153], v17 offset:37056
    ds_read_b128 v[154:157], v17 offset:37088
    ds_read_b128 v[174:177], v18 offset:4800
    ds_read_b128 v[178:181], v18 offset:4832
    ds_read_b128 v[182:185], v18 offset:7360
    ds_read_b128 v[186:189], v18 offset:7392
    s_waitcnt lgkmcnt(8)
    v_mfma_f32_32x32x16_bf16 v[110:125], v[158:161], v[190:193], v[110:125]
    v_mfma_f32_32x32x16_bf16 v[110:125], v[162:165], v[194:197], v[110:125]
    v_mfma_f32_32x32x16_bf16 v[110:125], v[166:169], v[190:193], v[110:125]
    v_mfma_f32_32x32x16_bf16 v[110:125], v[170:173], v[194:197], v[110:125]
    v_mfma_f32_32x32x16_bf16 v[126:141], v[158:161], v[198:201], v[126:141]
    v_mfma_f32_32x32x16_bf16 v[126:141], v[162:165], v[202:205], v[126:141]
    v_mfma_f32_32x32x16_bf16 v[126:141], v[166:169], v[198:201], v[126:141]
    v_mfma_f32_32x32x16_bf16 v[126:141], v[170:173], v[202:205], v[126:141]
    ds_read_b128 v[158:161], v17 offset:3712
    ds_read_b128 v[162:165], v17 offset:3744
    ds_read_b128 v[166:169], v17 offset:36992
    ds_read_b128 v[170:173], v17 offset:37024
    ds_read_b128 v[190:193], v18 offset:4720
    ds_read_b128 v[194:197], v18 offset:4752
    ds_read_b128 v[198:201], v18 offset:7280
    ds_read_b128 v[202:205], v18 offset:7312
    s_waitcnt lgkmcnt(8)
    v_mfma_f32_32x32x16_bf16 v[110:125], v[142:145], v[174:177], v[110:125]
    v_mfma_f32_32x32x16_bf16 v[110:125], v[146:149], v[178:181], v[110:125]
    v_mfma_f32_32x32x16_bf16 v[110:125], v[150:153], v[174:177], v[110:125]
    v_mfma_f32_32x32x16_bf16 v[110:125], v[154:157], v[178:181], v[110:125]
    v_mfma_f32_32x32x16_bf16 v[126:141], v[142:145], v[182:185], v[126:141]
    v_mfma_f32_32x32x16_bf16 v[126:141], v[146:149], v[186:189], v[126:141]
    v_mfma_f32_32x32x16_bf16 v[126:141], v[150:153], v[182:185], v[126:141]
    v_mfma_f32_32x32x16_bf16 v[126:141], v[154:157], v[186:189], v[126:141]
    ds_read_b128 v[142:145], v17 offset:3648
    ds_read_b128 v[146:149], v17 offset:3680
    ds_read_b128 v[150:153], v17 offset:36928
    ds_read_b128 v[154:157], v17 offset:36960
    ds_read_b128 v[174:177], v18 offset:4640
    ds_read_b128 v[178:181], v18 offset:4672
    ds_read_b128 v[182:185], v18 offset:7200
    ds_read_b128 v[186:189], v18 offset:7232
    s_waitcnt lgkmcnt(8)
    v_mfma_f32_32x32x16_bf16 v[110:125], v[158:161], v[190:193], v[110:125]
    v_mfma_f32_32x32x16_bf16 v[110:125], v[162:165], v[194:197], v[110:125]
    v_mfma_f32_32x32x16_bf16 v[110:125], v[166:169], v[190:193], v[110:125]
    v_mfma_f32_32x32x16_bf16 v[110:125], v[170:173], v[194:197], v[110:125]
    v_mfma_f32_32x32x16_bf16 v[126:141], v[158:161], v[198:201], v[126:141]
    v_mfma_f32_32x32x16_bf16 v[126:141], v[162:165], v[202:205], v[126:141]
    v_mfma_f32_32x32x16_bf16 v[126:141], v[166:169], v[198:201], v[126:141]
    v_mfma_f32_32x32x16_bf16 v[126:141], v[170:173], v[202:205], v[126:141]
    ds_read_b128 v[158:161], v17 offset:3584
    ds_read_b128 v[162:165], v17 offset:3616
    ds_read_b128 v[166:169], v17 offset:36864
    ds_read_b128 v[170:173], v17 offset:36896
    ds_read_b128 v[190:193], v18 offset:4560
    ds_read_b128 v[194:197], v18 offset:4592
    ds_read_b128 v[198:201], v18 offset:7120
    ds_read_b128 v[202:205], v18 offset:7152
    s_waitcnt lgkmcnt(8)
    v_mfma_f32_32x32x16_bf16 v[110:125], v[142:145], v[174:177], v[110:125]
    v_mfma_f32_32x32x16_bf16 v[110:125], v[146:149], v[178:181], v[110:125]
    v_mfma_f32_32x32x16_bf16 v[110:125], v[150:153], v[174:177], v[110:125]
    v_mfma_f32_32x32x16_bf16 v[110:125], v[154:157], v[178:181], v[110:125]
    v_mfma_f32_32x32x16_bf16 v[126:141], v[142:145], v[182:185], v[126:141]
    v_mfma_f32_32x32x16_bf16 v[126:141], v[146:149], v[186:189], v[126:141]
    v_mfma_f32_32x32x16_bf16 v[126:141], v[150:153], v[182:185], v[126:141]
    v_mfma_f32_32x32x16_bf16 v[126:141], v[154:157], v[186:189], v[126:141]
    ds_read_b128 v[142:145], v17 offset:3520
    ds_read_b128 v[146:149], v17 offset:3552
    ds_read_b128 v[150:153], v17 offset:36800
    ds_read_b128 v[154:157], v17 offset:36832
    ds_read_b128 v[174:177], v18 offset:4480
    ds_read_b128 v[178:181], v18 offset:4512
    ds_read_b128 v[182:185], v18 offset:7040
    ds_read_b128 v[186:189], v18 offset:7072
    s_waitcnt lgkmcnt(8)
    v_mfma_f32_32x32x16_bf16 v[110:125], v[158:161], v[190:193], v[110:125]
    v_mfma_f32_32x32x16_bf16 v[110:125], v[162:165], v[194:197], v[110:125]
    v_mfma_f32_32x32x16_bf16 v[110:125], v[166:169], v[190:193], v[110:125]
    v_mfma_f32_32x32x16_bf16 v[110:125], v[170:173], v[194:197], v[110:125]
    v_mfma_f32_32x32x16_bf16 v[126:141], v[158:161], v[198:201], v[126:141]
    v_mfma_f32_32x32x16_bf16 v[126:141], v[162:165], v[202:205], v[126:141]
    v_mfma_f32_32x32x16_bf16 v[126:141], v[166:169], v[198:201], v[126:141]
    v_mfma_f32_32x32x16_bf16 v[126:141], v[170:173], v[202:205], v[126:141]
    ds_read_b128 v[158:161], v17 offset:3456
    ds_read_b128 v[162:165], v17 offset:3488
    ds_read_b128 v[166:169], v17 offset:36736
    ds_read_b128 v[170:173], v17 offset:36768
    ds_read_b128 v[190:193], v18 offset:4400
    ds_read_b128 v[194:197], v18 offset:4432
    ds_read_b128 v[198:201], v18 offset:6960
    ds_read_b128 v[202:205], v18 offset:6992
    s_waitcnt lgkmcnt(8)
    v_mfma_f32_32x32x16_bf16 v[110:125], v[142:145], v[174:177], v[110:125]
    v_mfma_f32_32x32x16_bf16 v[110:125], v[146:149], v[178:181], v[110:125]
    v_mfma_f32_32x32x16_bf16 v[110:125], v[150:153], v[174:177], v[110:125]
    v_mfma_f32_32x32x16_bf16 v[110:125], v[154:157], v[178:181], v[110:125]
    v_mfma_f32_32x32x16_bf16 v[126:141], v[142:145], v[182:185], v[126:141]
    v_mfma_f32_32x32x16_bf16 v[126:141], v[146:149], v[186:189], v[126:141]
    v_mfma_f32_32x32x16_bf16 v[126:141], v[150:153], v[182:185], v[126:141]
    v_mfma_f32_32x32x16_bf16 v[126:141], v[154:157], v[186:189], v[126:141]
    ds_read_b128 v[142:145], v17 offset:3392
    ds_read_b128 v[146:149], v17 offset:3424
    ds_read_b128 v[150:153], v17 offset:36672
    ds_read_b128 v[154:157], v17 offset:36704
    ds_read_b128 v[174:177], v18 offset:4320
    ds_read_b128 v[178:181], v18 offset:4352
    ds_read_b128 v[182:185], v18 offset:6880
    ds_read_b128 v[186:189], v18 offset:6912
    s_waitcnt lgkmcnt(8)
    v_mfma_f32_32x32x16_bf16 v[110:125], v[158:161], v[190:193], v[110:125]
    v_mfma_f32_32x32x16_bf16 v[110:125], v[162:165], v[194:197], v[110:125]
    v_mfma_f32_32x32x16_bf16 v[110:125], v[166:169], v[190:193], v[110:125]
    v_mfma_f32_32x32x16_bf16 v[110:125], v[170:173], v[194:197], v[110:125]
    v_mfma_f32_32x32x16_bf16 v[126:141], v[158:161], v[198:201], v[126:141]
    v_mfma_f32_32x32x16_bf16 v[126:141], v[162:165], v[202:205], v[126:141]
    v_mfma_f32_32x32x16_bf16 v[126:141], v[166:169], v[198:201], v[126:141]
    v_mfma_f32_32x32x16_bf16 v[126:141], v[170:173], v[202:205], v[126:141]
    ds_read_b128 v[158:161], v17 offset:3328
    ds_read_b128 v[162:165], v17 offset:3360
    ds_read_b128 v[166:169], v17 offset:36608
    ds_read_b128 v[170:173], v17 offset:36640
    ds_read_b128 v[190:193], v18 offset:4240
    ds_read_b128 v[194:197], v18 offset:4272
    ds_read_b128 v[198:201], v18 offset:6800
    ds_read_b128 v[202:205], v18 offset:6832
    s_waitcnt lgkmcnt(8)
    v_mfma_f32_32x32x16_bf16 v[110:125], v[142:145], v[174:177], v[110:125]
    v_mfma_f32_32x32x16_bf16 v[110:125], v[146:149], v[178:181], v[110:125]
    v_mfma_f32_32x32x16_bf16 v[110:125], v[150:153], v[174:177], v[110:125]
    v_mfma_f32_32x32x16_bf16 v[110:125], v[154:157], v[178:181], v[110:125]
    v_mfma_f32_32x32x16_bf16 v[126:141], v[142:145], v[182:185], v[126:141]
    v_mfma_f32_32x32x16_bf16 v[126:141], v[146:149], v[186:189], v[126:141]
    v_mfma_f32_32x32x16_bf16 v[126:141], v[150:153], v[182:185], v[126:141]
    v_mfma_f32_32x32x16_bf16 v[126:141], v[154:157], v[186:189], v[126:141]
    s_waitcnt lgkmcnt(0)
    v_mfma_f32_32x32x16_bf16 v[110:125], v[158:161], v[190:193], v[110:125]
    v_mfma_f32_32x32x16_bf16 v[110:125], v[162:165], v[194:197], v[110:125]
    v_mfma_f32_32x32x16_bf16 v[110:125], v[166:169], v[190:193], v[110:125]
    v_mfma_f32_32x32x16_bf16 v[110:125], v[170:173], v[194:197], v[110:125]
    v_mfma_f32_32x32x16_bf16 v[126:141], v[158:161], v[198:201], v[126:141]
    v_mfma_f32_32x32x16_bf16 v[126:141], v[162:165], v[202:205], v[126:141]
    v_mfma_f32_32x32x16_bf16 v[126:141], v[166:169], v[198:201], v[126:141]
    v_mfma_f32_32x32x16_bf16 v[126:141], v[170:173], v[202:205], v[126:141]
    s_branch L_conv_epi
L_conv_w1:
    s_cmp_lg_u32 s43, 1
    s_cbranch_scc1 L_conv_w2
    ds_read_b128 v[142:145], v17 offset:3264
    ds_read_b128 v[146:149], v17 offset:3296
    ds_read_b128 v[150:153], v17 offset:36544
    ds_read_b128 v[154:157], v17 offset:36576
    ds_read_b128 v[174:177], v18 offset:4160
    ds_read_b128 v[178:181], v18 offset:4192
    ds_read_b128 v[182:185], v18 offset:6720
    ds_read_b128 v[186:189], v18 offset:6752
    ds_read_b128 v[158:161], v17 offset:3200
    ds_read_b128 v[162:165], v17 offset:3232
    ds_read_b128 v[166:169], v17 offset:36480
    ds_read_b128 v[170:173], v17 offset:36512
    ds_read_b128 v[190:193], v18 offset:4080
    ds_read_b128 v[194:197], v18 offset:4112
    ds_read_b128 v[198:201], v18 offset:6640
    ds_read_b128 v[202:205], v18 offset:6672
    s_waitcnt lgkmcnt(8)
    v_mfma_f32_32x32x16_bf16 v[110:125], v[142:145], v[174:177], v[110:125]
    v_mfma_f32_32x32x16_bf16 v[110:125], v[146:149], v[178:181], v[110:125]
    v_mfma_f32_32x32x16_bf16 v[110:125], v[150:153], v[174:177], v[110:125]
    v_mfma_f32_32x32x16_bf16 v[110:125], v[154:157], v[178:181], v[110:125]
    v_mfma_f32_32x32x16_bf16 v[126:141], v[142:145], v[182:185], v[126:141]
    v_mfma_f32_32x32x16_bf16 v[126:141], v[146:149], v[186:189], v[126:141]
    v_mfma_f32_32x32x16_bf16 v[126:141], v[150:153], v[182:185], v[126:141]
    v_mfma_f32_32x32x16_bf16 v[126:141], v[154:157], v[186:189], v[126:141]
    ds_read_b128 v[142:145], v17 offset:3136
    ds_read_b128 v[146:149], v17 offset:3168
    ds_read_b128 v[150:153], v17 offset:36416
    ds_read_b128 v[154:157], v17 offset:36448
    ds_read_b128 v[174:177], v18 offset:4000
    ds_read_b128 v[178:181], v18 offset:4032
    ds_read_b128 v[182:185], v18 offset:6560
    ds_read_b128 v[186:189], v18 offset:6592
    s_waitcnt lgkmcnt(8)
    v_mfma_f32_32x32x16_bf16 v[110:125], v[158:161], v[190:193], v[110:125]
    v_mfma_f32_32x32x16_bf16 v[110:125], v[162:165], v[194:197], v[110:125]
    v_mfma_f32_32x32x16_bf16 v[110:125], v[166:169], v[190:193], v[110:125]
    v_mfma_f32_32x32x16_bf16 v[110:125], v[170:173], v[194:197], v[110:125]
    v_mfma_f32_32x32x16_bf16 v[126:141], v[158:161], v[198:201], v[126:141]
    v_mfma_f32_32x32x16_bf16 v[126:141], v[162:165], v[202:205], v[126:141]
    v_mfma_f32_32x32x16_bf16 v[126:141], v[166:169], v[198:201], v[126:141]
    v_mfma_f32_32x32x16_bf16 v[126:141], v[170:173], v[202:205], v[126:141]
    ds_read_b128 v[158:161], v17 offset:3072
    ds_read_b128 v[162:165], v17 offset:3104
    ds_read_b128 v[166:169], v17 offset:36352
    ds_read_b128 v[170:173], v17 offset:36384
    ds_read_b128 v[190:193], v18 offset:3920
    ds_read_b128 v[194:197], v18 offset:3952
    ds_read_b128 v[198:201], v18 offset:6480
    ds_read_b128 v[202:205], v18 offset:6512
    s_waitcnt lgkmcnt(8)
    v_mfma_f32_32x32x16_bf16 v[110:125], v[142:145], v[174:177], v[110:125]
    v_mfma_f32_32x32x16_bf16 v[110:125], v[146:149], v[178:181], v[110:125]
    v_mfma_f32_32x32x16_bf16 v[110:125], v[150:153], v[174:177], v[110:125]
    v_mfma_f32_32x32x16_bf16 v[110:125], v[154:157], v[178:181], v[110:125]
    v_mfma_f32_32x32x16_bf16 v[126:141], v[142:145], v[182:185], v[126:141]
    v_mfma_f32_32x32x16_bf16 v[126:141], v[146:149], v[186:189], v[126:141]
    v_mfma_f32_32x32x16_bf16 v[126:141], v[150:153], v[182:185], v[126:141]
    v_mfma_f32_32x32x16_bf16 v[126:141], v[154:157], v[186:189], v[126:141]
    ds_read_b128 v[142:145], v17 offset:3008
    ds_read_b128 v[146:149], v17 offset:3040
    ds_read_b128 v[150:153], v17 offset:36288
    ds_read_b128 v[154:157], v17 offset:36320
    ds_read_b128 v[174:177], v18 offset:3840
    ds_read_b128 v[178:181], v18 offset:3872
    ds_read_b128 v[182:185], v18 offset:6400
    ds_read_b128 v[186:189], v18 offset:6432
    s_waitcnt lgkmcnt(8)
    v_mfma_f32_32x32x16_bf16 v[110:125], v[158:161], v[190:193], v[110:125]
    v_mfma_f32_32x32x16_bf16 v[110:125], v[162:165], v[194:197], v[110:125]
    v_mfma_f32_32x32x16_bf16 v[110:125], v[166:169], v[190:193], v[110:125]
    v_mfma_f32_32x32x16_bf16 v[110:125], v[170:173], v[194:197], v[110:125]
    v_mfma_f32_32x32x16_bf16 v[126:141], v[158:161], v[198:201], v[126:141]
    v_mfma_f32_32x32x16_bf16 v[126:141], v[162:165], v[202:205], v[126:141]
    v_mfma_f32_32x32x16_bf16 v[126:141], v[166:169], v[198:201], v[126:141]
    v_mfma_f32_32x32x16_bf16 v[126:141], v[170:173], v[202:205], v[126:141]
    ds_read_b128 v[158:161], v17 offset:2944
    ds_read_b128 v[162:165], v17 offset:2976
    ds_read_b128 v[166:169], v17 offset:36224
    ds_read_b128 v[170:173], v17 offset:36256
    ds_read_b128 v[190:193], v18 offset:3760
    ds_read_b128 v[194:197], v18 offset:3792
    ds_read_b128 v[198:201], v18 offset:6320
    ds_read_b128 v[202:205], v18 offset:6352
    s_waitcnt lgkmcnt(8)
    v_mfma_f32_32x32x16_bf16 v[110:125], v[142:145], v[174:177], v[110:125]
    v_mfma_f32_32x32x16_bf16 v[110:125], v[146:149], v[178:181], v[110:125]
    v_mfma_f32_32x32x16_bf16 v[110:125], v[150:153], v[174:177], v[110:125]
    v_mfma_f32_32x32x16_bf16 v[110:125], v[154:157], v[178:181], v[110:125]
    v_mfma_f32_32x32x16_bf16 v[126:141], v[142:145], v[182:185], v[126:141]
    v_mfma_f32_32x32x16_bf16 v[126:141], v[146:149], v[186:189], v[126:141]
    v_mfma_f32_32x32x16_bf16 v[126:141], v[150:153], v[182:185], v[126:141]
    v_mfma_f32_32x32x16_bf16 v[126:141], v[154:157], v[186:189], v[126:141]
    ds_read_b128 v[142:145], v17 offset:2880
    ds_read_b128 v[146:149], v17 offset:2912
    ds_read_b128 v[150:153], v17 offset:36160
    ds_read_b128 v[154:157], v17 offset:36192
    ds_read_b128 v[174:177], v18 offset:3680
    ds_read_b128 v[178:181], v18 offset:3712
    ds_read_b128 v[182:185], v18 offset:6240
    ds_read_b128 v[186:189], v18 offset:6272
    s_waitcnt lgkmcnt(8)
    v_mfma_f32_32x32x16_bf16 v[110:125], v[158:161], v[190:193], v[110:125]
    v_mfma_f32_32x32x16_bf16 v[110:125], v[162:165], v[194:197], v[110:125]
    v_mfma_f32_32x32x16_bf16 v[110:125], v[166:169], v[190:193], v[110:125]
    v_mfma_f32_32x32x16_bf16 v[110:125], v[170:173], v[194:197], v[110:125]
    v_mfma_f32_32x32x16_bf16 v[126:141], v[158:161], v[198:201], v[126:141]
    v_mfma_f32_32x32x16_bf16 v[126:141], v[162:165], v[202:205], v[126:141]
    v_mfma_f32_32x32x16_bf16 v[126:141], v[166:169], v[198:201], v[126:141]
    v_mfma_f32_32x32x16_bf16 v[126:141], v[170:173], v[202:205], v[126:141]
    ds_read_b128 v[158:161], v17 offset:2816
    ds_read_b128 v[162:165], v17 offset:2848
    ds_read_b128 v[166:169], v17 offset:36096
    ds_read_b128 v[170:173], v17 offset:36128
    ds_read_b128 v[190:193], v18 offset:3600
    ds_read_b128 v[194:197], v18 offset:3632
    ds_read_b128 v[198:201], v18 offset:6160
    ds_read_b128 v[202:205], v18 offset:6192
    s_waitcnt lgkmcnt(8)
    v_mfma_f32_32x32x16_bf16 v[110:125], v[142:145], v[174:177], v[110:125]
    v_mfma_f32_32x32x16_bf16 v[110:125], v[146:149], v[178:181], v[110:125]
    v_mfma_f32_32x32x16_bf16 v[110:125], v[150:153], v[174:177], v[110:125]
    v_mfma_f32_32x32x16_bf16 v[110:125], v[154:157], v[178:181], v[110:125]
    v_mfma_f32_32x32x16_bf16 v[126:141], v[142:145], v[182:185], v[126:141]
    v_mfma_f32_32x32x16_bf16 v[126:141], v[146:149], v[186:189], v[126:141]
    v_mfma_f32_32x32x16_bf16 v[126:141], v[150:153], v[182:185], v[126:141]
    v_mfma_f32_32x32x16_bf16 v[126:141], v[154:157], v[186:189], v[126:141]
    ds_read_b128 v[142:145], v17 offset:2752
    ds_read_b128 v[146:149], v17 offset:2784
    ds_read_b128 v[150:153], v17 offset:36032
    ds_read_b128 v[154:157], v17 offset:36064
    ds_read_b128 v[174:177], v18 offset:3520
    ds_read_b128 v[178:181], v18 offset:3552
    ds_read_b128 v[182:185], v18 offset:6080
    ds_read_b128 v[186:189], v18 offset:6112
    s_waitcnt lgkmcnt(8)
    v_mfma_f32_32x32x16_bf16 v[110:125], v[158:161], v[190:193], v[110:125]
    v_mfma_f32_32x32x16_bf16 v[110:125], v[162:165], v[194:197], v[110:125]
    v_mfma_f32_32x32x16_bf16 v[110:125], v[166:169], v[190:193], v[110:125]
    v_mfma_f32_32x32x16_bf16 v[110:125], v[170:173], v[194:197], v[110:125]
    v_mfma_f32_32x32x16_bf16 v[126:141], v[158:161], v[198:201], v[126:141]
    v_mfma_f32_32x32x16_bf16 v[126:141], v[162:165], v[202:205], v[126:141]
    v_mfma_f32_32x32x16_bf16 v[126:141], v[166:169], v[198:201], v[126:141]
    v_mfma_f32_32x32x16_bf16 v[126:141], v[170:173], v[202:205], v[126:141]
    ds_read_b128 v[158:161], v17 offset:2688
    ds_read_b128 v[162:165], v17 offset:2720
    ds_read_b128 v[166:169], v17 offset:35968
    ds_read_b128 v[170:173], v17 offset:36000
    ds_read_b128 v[190:193], v18 offset:3440
    ds_read_b128 v[194:197], v18 offset:3472
    ds_read_b128 v[198:201], v18 offset:6000
    ds_read_b128 v[202:205], v18 offset:6032
    s_waitcnt lgkmcnt(8)
    v_mfma_f32_32x32x16_bf16 v[110:125], v[142:145], v[174:177], v[110:125]
    v_mfma_f32_32x32x16_bf16 v[110:125], v[146:149], v[178:181], v[110:125]
    v_mfma_f32_32x32x16_bf16 v[110:125], v[150:153], v[174:177], v[110:125]
    v_mfma_f32_32x32x16_bf16 v[110:125], v[154:157], v[178:181], v[110:125]
    v_mfma_f32_32x32x16_bf16 v[126:141], v[142:145], v[182:185], v[126:141]
    v_mfma_f32_32x32x16_bf16 v[126:141], v[146:149], v[186:189], v[126:141]
    v_mfma_f32_32x32x16_bf16 v[126:141], v[150:153], v[182:185], v[126:141]
    v_mfma_f32_32x32x16_bf16 v[126:141], v[154:157], v[186:189], v[126:141]
    ds_read_b128 v[142:145], v17 offset:2624
    ds_read_b128 v[146:149], v17 offset:2656
    ds_read_b128 v[150:153], v17 offset:35904
    ds_read_b128 v[154:157], v17 offset:35936
    ds_read_b128 v[174:177], v18 offset:3360
    ds_read_b128 v[178:181], v18 offset:3392
    ds_read_b128 v[182:185], v18 offset:5920
    ds_read_b128 v[186:189], v18 offset:5952
    s_waitcnt lgkmcnt(8)
    v_mfma_f32_32x32x16_bf16 v[110:125], v[158:161], v[190:193], v[110:125]
    v_mfma_f32_32x32x16_bf16 v[110:125], v[162:165], v[194:197], v[110:125]
    v_mfma_f32_32x32x16_bf16 v[110:125], v[166:169], v[190:193], v[110:125]
    v_mfma_f32_32x32x16_bf16 v[110:125], v[170:173], v[194:197], v[110:125]
    v_mfma_f32_32x32x16_bf16 v[126:141], v[158:161], v[198:201], v[126:141]
    v_mfma_f32_32x32x16_bf16 v[126:141], v[162:165], v[202:205], v[126:141]
    v_mfma_f32_32x32x16_bf16 v[126:141], v[166:169], v[198:201], v[126:141]
    v_mfma_f32_32x32x16_bf16 v[126:141], v[170:173], v[202:205], v[126:141]
    ds_read_b128 v[158:161], v17 offset:2560
    ds_read_b128 v[162:165], v17 offset:2592
    ds_read_b128 v[166:169], v17 offset:35840
    ds_read_b128 v[170:173], v17 offset:35872
    ds_read_b128 v[190:193], v18 offset:3280
    ds_read_b128 v[194:197], v18 offset:3312
    ds_read_b128 v[198:201], v18 offset:5840
    ds_read_b128 v[202:205], v18 offset:5872
    s_waitcnt lgkmcnt(8)
    v_mfma_f32_32x32x16_bf16 v[110:125], v[142:145], v[174:177], v[110:125]
    v_mfma_f32_32x32x16_bf16 v[110:125], v[146:149], v[178:181], v[110:125]
    v_mfma_f32_32x32x16_bf16 v[110:125], v[150:153], v[174:177], v[110:125]
    v_mfma_f32_32x32x16_bf16 v[110:125], v[154:157], v[178:181], v[110:125]
    v_mfma_f32_32x32x16_bf16 v[126:141], v[142:145], v[182:185], v[126:141]
    v_mfma_f32_32x32x16_bf16 v[126:141], v[146:149], v[186:189], v[126:141]
    v_mfma_f32_32x32x16_bf16 v[126:141], v[150:153], v[182:185], v[126:141]
    v_mfma_f32_32x32x16_bf16 v[126:141], v[154:157], v[186:189], v[126:141]
    s_waitcnt lgkmcnt(0)
    v_mfma_f32_32x32x16_bf16 v[110:125], v[158:161], v[190:193], v[110:125]
    v_mfma_f32_32x32x16_bf16 v[110:125], v[162:165], v[194:197], v[110:125]
    v_mfma_f32_32x32x16_bf16 v[110:125], v[166:169], v[190:193], v[110:125]
    v_mfma_f32_32x32x16_bf16 v[110:125], v[170:173], v[194:197], v[110:125]
    v_mfma_f32_32x32x16_bf16 v[126:141], v[158:161], v[198:201], v[126:141]
    v_mfma_f32_32x32x16_bf16 v[126:141], v[162:165], v[202:205], v[126:141]
    v_mfma_f32_32x32x16_bf16 v[126:141], v[166:169], v[198:201], v[126:141]
    v_mfma_f32_32x32x16_bf16 v[126:141], v[170:173], v[202:205], v[126:141]
    s_branch L_conv_epi
L_conv_w2:
    s_cmp_lg_u32 s43, 2
    s_cbranch_scc1 L_conv_w3
    ds_read_b128 v[142:145], v17 offset:2496
    ds_read_b128 v[146:149], v17 offset:2528
    ds_read_b128 v[150:153], v17 offset:35776
    ds_read_b128 v[154:157], v17 offset:35808
    ds_read_b128 v[174:177], v18 offset:3200
    ds_read_b128 v[178:181], v18 offset:3232
    ds_read_b128 v[182:185], v18 offset:5760
    ds_read_b128 v[186:189], v18 offset:5792
    ds_read_b128 v[158:161], v17 offset:2432
    ds_read_b128 v[162:165], v17 offset:2464
    ds_read_b128 v[166:169], v17 offset:35712
    ds_read_b128 v[170:173], v17 offset:35744
    ds_read_b128 v[190:193], v18 offset:3120
    ds_read_b128 v[194:197], v18 offset:3152
    ds_read_b128 v[198:201], v18 offset:5680
    ds_read_b128 v[202:205], v18 offset:5712
    s_waitcnt lgkmcnt(8)
    v_mfma_f32_32x32x16_bf16 v[110:125], v[142:145], v[174:177], v[110:125]
    v_mfma_f32_32x32x16_bf16 v[110:125], v[146:149], v[178:181], v[110:125]
    v_mfma_f32_32x32x16_bf16 v[110:125], v[150:153], v[174:177], v[110:125]
    v_mfma_f32_32x32x16_bf16 v[110:125], v[154:157], v[178:181], v[110:125]
    v_mfma_f32_32x32x16_bf16 v[126:141], v[142:145], v[182:185], v[126:141]
    v_mfma_f32_32x32x16_bf16 v[126:141], v[146:149], v[186:189], v[126:141]
    v_mfma_f32_32x32x16_bf16 v[126:141], v[150:153], v[182:185], v[126:141]
    v_mfma_f32_32x32x16_bf16 v[126:141], v[154:157], v[186:189], v[126:141]
    ds_read_b128 v[142:145], v17 offset:2368
    ds_read_b128 v[146:149], v17 offset:2400
    ds_read_b128 v[150:153], v17 offset:35648
    ds_read_b128 v[154:157], v17 offset:35680
    ds_read_b128 v[174:177], v18 offset:3040
    ds_read_b128 v[178:181], v18 offset:3072
    ds_read_b128 v[182:185], v18 offset:5600
    ds_read_b128 v[186:189], v18 offset:5632
    s_waitcnt lgkmcnt(8)
    v_mfma_f32_32x32x16_bf16 v[110:125], v[158:161], v[190:193], v[110:125]
    v_mfma_f32_32x32x16_bf16 v[110:125], v[162:165], v[194:197], v[110:125]
    v_mfma_f32_32x32x16_bf16 v[110:125], v[166:169], v[190:193], v[110:125]
    v_mfma_f32_32x32x16_bf16 v[110:125], v[170:173], v[194:197], v[110:125]
    v_mfma_f32_32x32x16_bf16 v[126:141], v[158:161], v[198:201], v[126:141]
    v_mfma_f32_32x32x16_bf16 v[126:141], v[162:165], v[202:205], v[126:141]
    v_mfma_f32_32x32x16_bf16 v[126:141], v[166:169], v[198:201], v[126:141]
    v_mfma_f32_32x32x16_bf16 v[126:141], v[170:173], v[202:205], v[126:141]
    ds_read_b128 v[158:161], v17 offset:2304
    ds_read_b128 v[162:165], v17 offset:2336
    ds_read_b128 v[166:169], v17 offset:35584
    ds_read_b128 v[170:173], v17 offset:35616
    ds_read_b128 v[190:193], v18 offset:2960
    ds_read_b128 v[194:197], v18 offset:2992
    ds_read_b128 v[198:201], v18 offset:5520
    ds_read_b128 v[202:205], v18 offset:5552
    s_waitcnt lgkmcnt(8)
    v_mfma_f32_32x32x16_bf16 v[110:125], v[142:145], v[174:177], v[110:125]
    v_mfma_f32_32x32x16_bf16 v[110:125], v[146:149], v[178:181], v[110:125]
    v_mfma_f32_32x32x16_bf16 v[110:125], v[150:153], v[174:177], v[110:125]
    v_mfma_f32_32x32x16_bf16 v[110:125], v[154:157], v[178:181], v[110:125]
    v_mfma_f32_32x32x16_bf16 v[126:141], v[142:145], v[182:185], v[126:141]
    v_mfma_f32_32x32x16_bf16 v[126:141], v[146:149], v[186:189], v[126:141]
    v_mfma_f32_32x32x16_bf16 v[126:141], v[150:153], v[182:185], v[126:141]
    v_mfma_f32_32x32x16_bf16 v[126:141], v[154:157], v[186:189], v[126:141]
    ds_read_b128 v[142:145], v17 offset:2240
    ds_read_b128 v[146:149], v17 offset:2272
    ds_read_b128 v[150:153], v17 offset:35520
    ds_read_b128 v[154:157], v17 offset:35552
    ds_read_b128 v[174:177], v18 offset:2880
    ds_read_b128 v[178:181], v18 offset:2912
    ds_read_b128 v[182:185], v18 offset:5440
    ds_read_b128 v[186:189], v18 offset:5472
    s_waitcnt lgkmcnt(8)
    v_mfma_f32_32x32x16_bf16 v[110:125], v[158:161], v[190:193], v[110:125]
    v_mfma_f32_32x32x16_bf16 v[110:125], v[162:165], v[194:197], v[110:125]
    v_mfma_f32_32x32x16_bf16 v[110:125], v[166:169], v[190:193], v[110:125]
    v_mfma_f32_32x32x16_bf16 v[110:125], v[170:173], v[194:197], v[110:125]
    v_mfma_f32_32x32x16_bf16 v[126:141], v[158:161], v[198:201], v[126:141]
    v_mfma_f32_32x32x16_bf16 v[126:141], v[162:165], v[202:205], v[126:141]
    v_mfma_f32_32x32x16_bf16 v[126:141], v[166:169], v[198:201], v[126:141]
    v_mfma_f32_32x32x16_bf16 v[126:141], v[170:173], v[202:205], v[126:141]
    ds_read_b128 v[158:161], v17 offset:2176
    ds_read_b128 v[162:165], v17 offset:2208
    ds_read_b128 v[166:169], v17 offset:35456
    ds_read_b128 v[170:173], v17 offset:35488
    ds_read_b128 v[190:193], v18 offset:2800
    ds_read_b128 v[194:197], v18 offset:2832
    ds_read_b128 v[198:201], v18 offset:5360
    ds_read_b128 v[202:205], v18 offset:5392
    s_waitcnt lgkmcnt(8)
    v_mfma_f32_32x32x16_bf16 v[110:125], v[142:145], v[174:177], v[110:125]
    v_mfma_f32_32x32x16_bf16 v[110:125], v[146:149], v[178:181], v[110:125]
    v_mfma_f32_32x32x16_bf16 v[110:125], v[150:153], v[174:177], v[110:125]
    v_mfma_f32_32x32x16_bf16 v[110:125], v[154:157], v[178:181], v[110:125]
    v_mfma_f32_32x32x16_bf16 v[126:141], v[142:145], v[182:185], v[126:141]
    v_mfma_f32_32x32x16_bf16 v[126:141], v[146:149], v[186:189], v[126:141]
    v_mfma_f32_32x32x16_bf16 v[126:141], v[150:153], v[182:185], v[126:141]
    v_mfma_f32_32x32x16_bf16 v[126:141], v[154:157], v[186:189], v[126:141]
    ds_read_b128 v[142:145], v17 offset:2112
    ds_read_b128 v[146:149], v17 offset:2144
    ds_read_b128 v[150:153], v17 offset:35392
    ds_read_b128 v[154:157], v17 offset:35424
    ds_read_b128 v[174:177], v18 offset:2720
    ds_read_b128 v[178:181], v18 offset:2752
    ds_read_b128 v[182:185], v18 offset:5280
    ds_read_b128 v[186:189], v18 offset:5312
    s_waitcnt lgkmcnt(8)
    v_mfma_f32_32x32x16_bf16 v[110:125], v[158:161], v[190:193], v[110:125]
    v_mfma_f32_32x32x16_bf16 v[110:125], v[162:165], v[194:197], v[110:125]
    v_mfma_f32_32x32x16_bf16 v[110:125], v[166:169], v[190:193], v[110:125]
    v_mfma_f32_32x32x16_bf16 v[110:125], v[170:173], v[194:197], v[110:125]
    v_mfma_f32_32x32x16_bf16 v[126:141], v[158:161], v[198:201], v[126:141]
    v_mfma_f32_32x32x16_bf16 v[126:141], v[162:165], v[202:205], v[126:141]
    v_mfma_f32_32x32x16_bf16 v[126:141], v[166:169], v[198:201], v[126:141]
    v_mfma_f32_32x32x16_bf16 v[126:141], v[170:173], v[202:205], v[126:141]
    ds_read_b128 v[158:161], v17 offset:2048
    ds_read_b128 v[162:165], v17 offset:2080
    ds_read_b128 v[166:169], v17 offset:35328
    ds_read_b128 v[170:173], v17 offset:35360
    ds_read_b128 v[190:193], v18 offset:2640
    ds_read_b128 v[194:197], v18 offset:2672
    ds_read_b128 v[198:201], v18 offset:5200
    ds_read_b128 v[202:205], v18 offset:5232
    s_waitcnt lgkmcnt(8)
    v_mfma_f32_32x32x16_bf16 v[110:125], v[142:145], v[174:177], v[110:125]
    v_mfma_f32_32x32x16_bf16 v[110:125], v[146:149], v[178:181], v[110:125]
    v_mfma_f32_32x32x16_bf16 v[110:125], v[150:153], v[174:177], v[110:125]
    v_mfma_f32_32x32x16_bf16 v[110:125], v[154:157], v[178:181], v[110:125]
    v_mfma_f32_32x32x16_bf16 v[126:141], v[142:145], v[182:185], v[126:141]
    v_mfma_f32_32x32x16_bf16 v[126:141], v[146:149], v[186:189], v[126:141]
    v_mfma_f32_32x32x16_bf16 v[126:141], v[150:153], v[182:185], v[126:141]
    v_mfma_f32_32x32x16_bf16 v[126:141], v[154:157], v[186:189], v[126:141]
    ds_read_b128 v[142:145], v17 offset:1984
    ds_read_b128 v[146:149], v17 offset:2016
    ds_read_b128 v[150:153], v17 offset:35264
    ds_read_b128 v[154:157], v17 offset:35296
    ds_read_b128 v[182:185], v18 offset:5120
    ds_read_b128 v[186:189], v18 offset:5152
    s_waitcnt lgkmcnt(6)
    v_mfma_f32_32x32x16_bf16 v[110:125], v[158:161], v[190:193], v[110:125]
    v_mfma_f32_32x32x16_bf16 v[110:125], v[162:165], v[194:197], v[110:125]
    v_mfma_f32_32x32x16_bf16 v[110:125], v[166:169], v[190:193], v[110:125]
    v_mfma_f32_32x32x16_bf16 v[110:125], v[170:173], v[194:197], v[110:125]
    v_mfma_f32_32x32x16_bf16 v[126:141], v[158:161], v[198:201], v[126:141]
    v_mfma_f32_32x32x16_bf16 v[126:141], v[162:165], v[202:205], v[126:141]
    v_mfma_f32_32x32x16_bf16 v[126:141], v[166:169], v[198:201], v[126:141]
    v_mfma_f32_32x32x16_bf16 v[126:141], v[170:173], v[202:205], v[126:141]
    ds_read_b128 v[158:161], v17 offset:1920
    ds_read_b128 v[162:165], v17 offset:1952
    ds_read_b128 v[166:169], v17 offset:35200
    ds_read_b128 v[170:173], v17 offset:35232
    ds_read_b128 v[198:201], v18 offset:5040
    ds_read_b128 v[202:205], v18 offset:5072
    s_waitcnt lgkmcnt(6)
    v_mfma_f32_32x32x16_bf16 v[126:141], v[142:145], v[182:185], v[126:141]
    v_mfma_f32_32x32x16_bf16 v[126:141], v[146:149], v[186:189], v[126:141]
    v_mfma_f32_32x32x16_bf16 v[126:141], v[150:153], v[182:185], v[126:141]
    v_mfma_f32_32x32x16_bf16 v[126:141], v[154:157], v[186:189], v[126:141]
    ds_read_b128 v[142:145], v17 offset:1856
    ds_read_b128 v[146:149], v17 offset:1888
    ds_read_b128 v[150:153], v17 offset:35136
    ds_read_b128 v[154:157], v17 offset:35168
    ds_read_b128 v[182:185], v18 offset:4960
    ds_read_b128 v[186:189], v18 offset:4992
    s_waitcnt lgkmcnt(6)
    v_mfma_f32_32x32x16_bf16 v[126:141], v[158:161], v[198:201], v[126:141]
    v_mfma_f32_32x32x16_bf16 v[126:141], v[162:165], v[202:205], v[126:141]
    v_mfma_f32_32x32x16_bf16 v[126:141], v[166:169], v[198:201], v[126:141]
    v_mfma_f32_32x32x16_bf16 v[126:141], v[170:173], v[202:205], v[126:141]
    ds_read_b128 v[158:161], v17 offset:1792
    ds_read_b128 v[162:165], v17 offset:1824
    ds_read_b128 v[166:169], v17 offset:35072
    ds_read_b128 v[170:173], v17 offset:35104
    ds_read_b128 v[198:201], v18 offset:4880
    ds_read_b128 v[202:205], v18 offset:4912
    s_waitcnt lgkmcnt(6)
    v_mfma_f32_32x32x16_bf16 v[126:141], v[142:145], v[182:185], v[126:141]
    v_mfma_f32_32x32x16_bf16 v[126:141], v[146:149], v[186:189], v[126:141]
    v_mfma_f32_32x32x16_bf16 v[126:141], v[150:153], v[182:185], v[126:141]
    v_mfma_f32_32x32x16_bf16 v[126:141], v[154:157], v[186:189], v[126:141]
    ds_read_b128 v[142:145], v17 offset:1728
    ds_read_b128 v[146:149], v17 offset:1760
    ds_read_b128 v[150:153], v17 offset:35008
    ds_read_b128 v[154:157], v17 offset:35040
    ds_read_b128 v[182:185], v18 offset:4800
    ds_read_b128 v[186:189], v18 offset:4832
    s_waitcnt lgkmcnt(6)
    v_mfma_f32_32x32x16_bf16 v[126:141], v[158:161], v[198:201], v[126:141]
    v_mfma_f32_32x32x16_bf16 v[126:141], v[162:165], v[202:205], v[126:141]
    v_mfma_f32_32x32x16_bf16 v[126:141], v[166:169], v[198:201], v[126:141]
    v_mfma_f32_32x32x16_bf16 v[126:141], v[170:173], v[202:205], v[126:141]
    ds_read_b128 v[158:161], v17 offset:1664
    ds_read_b128 v[162:165], v17 offset:1696
    ds_read_b128 v[166:169], v17 offset:34944
    ds_read_b128 v[170:173], v17 offset:34976
    ds_read_b128 v[198:201], v18 offset:4720
    ds_read_b128 v[202:205], v18 offset:4752
    s_waitcnt lgkmcnt(6)
    v_mfma_f32_32x32x16_bf16 v[126:141], v[142:145], v[182:185], v[126:141]
    v_mfma_f32_32x32x16_bf16 v[126:141], v[146:149], v[186:189], v[126:141]
    v_mfma_f32_32x32x16_bf16 v[126:141], v[150:153], v[182:185], v[126:141]
    v_mfma_f32_32x32x16_bf16 v[126:141], v[154:157], v[186:189], v[126:141]
    ds_read_b128 v[142:145], v17 offset:1600
    ds_read_b128 v[146:149], v17 offset:1632
    ds_read_b128 v[150:153], v17 offset:34880
    ds_read_b128 v[154:157], v17 offset:34912
    ds_read_b128 v[182:185], v18 offset:4640
    ds_read_b128 v[186:189], v18 offset:4672
    s_waitcnt lgkmcnt(6)
    v_mfma_f32_32x32x16_bf16 v[126:141], v[158:161], v[198:201], v[126:141]
    v_mfma_f32_32x32x16_bf16 v[126:141], v[162:165], v[202:205], v[126:141]
    v_mfma_f32_32x32x16_bf16 v[126:141], v[166:169], v[198:201], v[126:141]
    v_mfma_f32_32x32x16_bf16 v[126:141], v[170:173], v[202:205], v[126:141]
    ds_read_b128 v[158:161], v17 offset:1536
    ds_read_b128 v[162:165], v17 offset:1568
    ds_read_b128 v[166:169], v17 offset:34816
    ds_read_b128 v[170:173], v17 offset:34848
    ds_read_b128 v[198:201], v18 offset:4560
    ds_read_b128 v[202:205], v18 offset:4592
    s_waitcnt lgkmcnt(6)
    v_mfma_f32_32x32x16_bf16 v[126:141], v[142:145], v[182:185], v[126:141]
    v_mfma_f32_32x32x16_bf16 v[126:141], v[146:149], v[186:189], v[126:141]
    v_mfma_f32_32x32x16_bf16 v[126:141], v[150:153], v[182:185], v[126:141]
    v_mfma_f32_32x32x16_bf16 v[126:141], v[154:157], v[186:189], v[126:141]
    s_waitcnt lgkmcnt(0)
    v_mfma_f32_32x32x16_bf16 v[126:141], v[158:161], v[198:201], v[126:141]
    v_mfma_f32_32x32x16_bf16 v[126:141], v[162:165], v[202:205], v[126:141]
    v_mfma_f32_32x32x16_bf16 v[126:141], v[166:169], v[198:201], v[126:141]
    v_mfma_f32_32x32x16_bf16 v[126:141], v[170:173], v[202:205], v[126:141]
    s_branch L_conv_epi
L_conv_w3:
    ds_read_b128 v[142:145], v17 offset:1472
    ds_read_b128 v[146:149], v17 offset:1504
    ds_read_b128 v[150:153], v17 offset:34752
    ds_read_b128 v[154:157], v17 offset:34784
    ds_read_b128 v[182:185], v18 offset:4480
    ds_read_b128 v[186:189], v18 offset:4512
    ds_read_b128 v[158:161], v17 offset:1408
    ds_read_b128 v[162:165], v17 offset:1440
    ds_read_b128 v[166:169], v17 offset:34688
    ds_read_b128 v[170:173], v17 offset:34720
    ds_read_b128 v[198:201], v18 offset:4400
    ds_read_b128 v[202:205], v18 offset:4432
    s_waitcnt lgkmcnt(6)
    v_mfma_f32_32x32x16_bf16 v[126:141], v[142:145], v[182:185], v[126:141]
    v_mfma_f32_32x32x16_bf16 v[126:141], v[146:149], v[186:189], v[126:141]
    v_mfma_f32_32x32x16_bf16 v[126:141], v[150:153], v[182:185], v[126:141]
    v_mfma_f32_32x32x16_bf16 v[126:141], v[154:157], v[186:189], v[126:141]
    ds_read_b128 v[142:145], v17 offset:1344
    ds_read_b128 v[146:149], v17 offset:1376
    ds_read_b128 v[150:153], v17 offset:34624
    ds_read_b128 v[154:157], v17 offset:34656
    ds_read_b128 v[182:185], v18 offset:4320
    ds_read_b128 v[186:189], v18 offset:4352
    s_waitcnt lgkmcnt(6)
    v_mfma_f32_32x32x16_bf16 v[126:141], v[158:161], v[198:201], v[126:141]
    v_mfma_f32_32x32x16_bf16 v[126:141], v[162:165], v[202:205], v[126:141]
    v_mfma_f32_32x32x16_bf16 v[126:141], v[166:169], v[198:201], v[126:141]
    v_mfma_f32_32x32x16_bf16 v[126:141], v[170:173], v[202:205], v[126:141]
    ds_read_b128 v[158:161], v17 offset:1280
    ds_read_b128 v[162:165], v17 offset:1312
    ds_read_b128 v[166:169], v17 offset:34560
    ds_read_b128 v[170:173], v17 offset:34592
    ds_read_b128 v[198:201], v18 offset:4240
    ds_read_b128 v[202:205], v18 offset:4272
    s_waitcnt lgkmcnt(6)
    v_mfma_f32_32x32x16_bf16 v[126:141], v[142:145], v[182:185], v[126:141]
    v_mfma_f32_32x32x16_bf16 v[126:141], v[146:149], v[186:189], v[126:141]
    v_mfma_f32_32x32x16_bf16 v[126:141], v[150:153], v[182:185], v[126:141]
    v_mfma_f32_32x32x16_bf16 v[126:141], v[154:157], v[186:189], v[126:141]
    ds_read_b128 v[142:145], v17 offset:1216
    ds_read_b128 v[146:149], v17 offset:1248
    ds_read_b128 v[150:153], v17 offset:34496
    ds_read_b128 v[154:157], v17 offset:34528
    ds_read_b128 v[182:185], v18 offset:4160
    ds_read_b128 v[186:189], v18 offset:4192
    s_waitcnt lgkmcnt(6)
    v_mfma_f32_32x32x16_bf16 v[126:141], v[158:161], v[198:201], v[126:141]
    v_mfma_f32_32x32x16_bf16 v[126:141], v[162:165], v[202:205], v[126:141]
    v_mfma_f32_32x32x16_bf16 v[126:141], v[166:169], v[198:201], v[126:141]
    v_mfma_f32_32x32x16_bf16 v[126:141], v[170:173], v[202:205], v[126:141]
    ds_read_b128 v[158:161], v17 offset:1152
    ds_read_b128 v[162:165], v17 offset:1184
    ds_read_b128 v[166:169], v17 offset:34432
    ds_read_b128 v[170:173], v17 offset:34464
    ds_read_b128 v[198:201], v18 offset:4080
    ds_read_b128 v[202:205], v18 offset:4112
    s_waitcnt lgkmcnt(6)
    v_mfma_f32_32x32x16_bf16 v[126:141], v[142:145], v[182:185], v[126:141]
    v_mfma_f32_32x32x16_bf16 v[126:141], v[146:149], v[186:189], v[126:141]
    v_mfma_f32_32x32x16_bf16 v[126:141], v[150:153], v[182:185], v[126:141]
    v_mfma_f32_32x32x16_bf16 v[126:141], v[154:157], v[186:189], v[126:141]
    ds_read_b128 v[142:145], v17 offset:1088
    ds_read_b128 v[146:149], v17 offset:1120
    ds_read_b128 v[150:153], v17 offset:34368
    ds_read_b128 v[154:157], v17 offset:34400
    ds_read_b128 v[182:185], v18 offset:4000
    ds_read_b128 v[186:189], v18 offset:4032
    s_waitcnt lgkmcnt(6)
    v_mfma_f32_32x32x16_bf16 v[126:141], v[158:161], v[198:201], v[126:141]
    v_mfma_f32_32x32x16_bf16 v[126:141], v[162:165], v[202:205], v[126:141]
    v_mfma_f32_32x32x16_bf16 v[126:141], v[166:169], v[198:201], v[126:141]
    v_mfma_f32_32x32x16_bf16 v[126:141], v[170:173], v[202:205], v[126:141]
    ds_read_b128 v[158:161], v17 offset:1024
    ds_read_b128 v[162:165], v17 offset:1056
    ds_read_b128 v[166:169], v17 offset:34304
    ds_read_b128 v[170:173], v17 offset:34336
    ds_read_b128 v[198:201], v18 offset:3920
    ds_read_b128 v[202:205], v18 offset:3952
    s_waitcnt lgkmcnt(6)
    v_mfma_f32_32x32x16_bf16 v[126:141], v[142:145], v[182:185], v[126:141]
    v_mfma_f32_32x32x16_bf16 v[126:141], v[146:149], v[186:189], v[126:141]
    v_mfma_f32_32x32x16_bf16 v[126:141], v[150:153], v[182:185], v[126:141]
    v_mfma_f32_32x32x16_bf16 v[126:141], v[154:157], v[186:189], v[126:141]
    ds_read_b128 v[142:145], v17 offset:960
    ds_read_b128 v[146:149], v17 offset:992
    ds_read_b128 v[150:153], v17 offset:34240
    ds_read_b128 v[154:157], v17 offset:34272
    ds_read_b128 v[182:185], v18 offset:3840
    ds_read_b128 v[186:189], v18 offset:3872
    s_waitcnt lgkmcnt(6)
    v_mfma_f32_32x32x16_bf16 v[126:141], v[158:161], v[198:201], v[126:141]
    v_mfma_f32_32x32x16_bf16 v[126:141], v[162:165], v[202:205], v[126:141]
    v_mfma_f32_32x32x16_bf16 v[126:141], v[166:169], v[198:201], v[126:141]
    v_mfma_f32_32x32x16_bf16 v[126:141], v[170:173], v[202:205], v[126:141]
    ds_read_b128 v[158:161], v17 offset:896
    ds_read_b128 v[162:165], v17 offset:928
    ds_read_b128 v[166:169], v17 offset:34176
    ds_read_b128 v[170:173], v17 offset:34208
    ds_read_b128 v[198:201], v18 offset:3760
    ds_read_b128 v[202:205], v18 offset:3792
    s_waitcnt lgkmcnt(6)
    v_mfma_f32_32x32x16_bf16 v[126:141], v[142:145], v[182:185], v[126:141]
    v_mfma_f32_32x32x16_bf16 v[126:141], v[146:149], v[186:189], v[126:141]
    v_mfma_f32_32x32x16_bf16 v[126:141], v[150:153], v[182:185], v[126:141]
    v_mfma_f32_32x32x16_bf16 v[126:141], v[154:157], v[186:189], v[126:141]
    ds_read_b128 v[142:145], v17 offset:832
    ds_read_b128 v[146:149], v17 offset:864
    ds_read_b128 v[150:153], v17 offset:34112
    ds_read_b128 v[154:157], v17 offset:34144
    ds_read_b128 v[182:185], v18 offset:3680
    ds_read_b128 v[186:189], v18 offset:3712
    s_waitcnt lgkmcnt(6)
    v_mfma_f32_32x32x16_bf16 v[126:141], v[158:161], v[198:201], v[126:141]
    v_mfma_f32_32x32x16_bf16 v[126:141], v[162:165], v[202:205], v[126:141]
    v_mfma_f32_32x32x16_bf16 v[126:141], v[166:169], v[198:201], v[126:141]
    v_mfma_f32_32x32x16_bf16 v[126:141], v[170:173], v[202:205], v[126:141]
    ds_read_b128 v[158:161], v17 offset:768
    ds_read_b128 v[162:165], v17 offset:800
    ds_read_b128 v[166:169], v17 offset:34048
    ds_read_b128 v[170:173], v17 offset:34080
    ds_read_b128 v[198:201], v18 offset:3600
    ds_read_b128 v[202:205], v18 offset:3632
    s_waitcnt lgkmcnt(6)
    v_mfma_f32_32x32x16_bf16 v[126:141], v[142:145], v[182:185], v[126:141]
    v_mfma_f32_32x32x16_bf16 v[126:141], v[146:149], v[186:189], v[126:141]
    v_mfma_f32_32x32x16_bf16 v[126:141], v[150:153], v[182:185], v[126:141]
    v_mfma_f32_32x32x16_bf16 v[126:141], v[154:157], v[186:189], v[126:141]
    ds_read_b128 v[142:145], v17 offset:704
    ds_read_b128 v[146:149], v17 offset:736
    ds_read_b128 v[150:153], v17 offset:33984
    ds_read_b128 v[154:157], v17 offset:34016
    ds_read_b128 v[182:185], v18 offset:3520
    ds_read_b128 v[186:189], v18 offset:3552
    s_waitcnt lgkmcnt(6)
    v_mfma_f32_32x32x16_bf16 v[126:141], v[158:161], v[198:201], v[126:141]
    v_mfma_f32_32x32x16_bf16 v[126:141], v[162:165], v[202:205], v[126:141]
    v_mfma_f32_32x32x16_bf16 v[126:141], v[166:169], v[198:201], v[126:141]
    v_mfma_f32_32x32x16_bf16 v[126:141], v[170:173], v[202:205], v[126:141]
    ds_read_b128 v[158:161], v17 offset:640
    ds_read_b128 v[162:165], v17 offset:672
    ds_read_b128 v[166:169], v17 offset:33920
    ds_read_b128 v[170:173], v17 offset:33952
    ds_read_b128 v[198:201], v18 offset:3440
    ds_read_b128 v[202:205], v18 offset:3472
    s_waitcnt lgkmcnt(6)
    v_mfma_f32_32x32x16_bf16 v[126:141], v[142:145], v[182:185], v[126:141]
    v_mfma_f32_32x32x16_bf16 v[126:141], v[146:149], v[186:189], v[126:141]
    v_mfma_f32_32x32x16_bf16 v[126:141], v[150:153], v[182:185], v[126:141]
    v_mfma_f32_32x32x16_bf16 v[126:141], v[154:157], v[186:189], v[126:141]
    ds_read_b128 v[142:145], v17 offset:576
    ds_read_b128 v[146:149], v17 offset:608
    ds_read_b128 v[150:153], v17 offset:33856
    ds_read_b128 v[154:157], v17 offset:33888
    ds_read_b128 v[182:185], v18 offset:3360
    ds_read_b128 v[186:189], v18 offset:3392
    s_waitcnt lgkmcnt(6)
    v_mfma_f32_32x32x16_bf16 v[126:141], v[158:161], v[198:201], v[126:141]
    v_mfma_f32_32x32x16_bf16 v[126:141], v[162:165], v[202:205], v[126:141]
    v_mfma_f32_32x32x16_bf16 v[126:141], v[166:169], v[198:201], v[126:141]
    v_mfma_f32_32x32x16_bf16 v[126:141], v[170:173], v[202:205], v[126:141]
    ds_read_b128 v[158:161], v17 offset:512
    ds_read_b128 v[162:165], v17 offset:544
    ds_read_b128 v[166:169], v17 offset:33792
    ds_read_b128 v[170:173], v17 offset:33824
    ds_read_b128 v[198:201], v18 offset:3280
    ds_read_b128 v[202:205], v18 offset:3312
    s_waitcnt lgkmcnt(6)
    v_mfma_f32_32x32x16_bf16 v[126:141], v[142:145], v[182:185], v[126:141]
    v_mfma_f32_32x32x16_bf16 v[126:141], v[146:149], v[186:189], v[126:141]
    v_mfma_f32_32x32x16_bf16 v[126:141], v[150:153], v[182:185], v[126:141]
    v_mfma_f32_32x32x16_bf16 v[126:141], v[154:157], v[186:189], v[126:141]
    ds_read_b128 v[142:145], v17 offset:448
    ds_read_b128 v[146:149], v17 offset:480
    ds_read_b128 v[150:153], v17 offset:33728
    ds_read_b128 v[154:157], v17 offset:33760
    ds_read_b128 v[182:185], v18 offset:3200
    ds_read_b128 v[186:189], v18 offset:3232
    s_waitcnt lgkmcnt(6)
    v_mfma_f32_32x32x16_bf16 v[126:141], v[158:161], v[198:201], v[126:141]
    v_mfma_f32_32x32x16_bf16 v[126:141], v[162:165], v[202:205], v[126:141]
    v_mfma_f32_32x32x16_bf16 v[126:141], v[166:169], v[198:201], v[126:141]
    v_mfma_f32_32x32x16_bf16 v[126:141], v[170:173], v[202:205], v[126:141]
    ds_read_b128 v[158:161], v17 offset:384
    ds_read_b128 v[162:165], v17 offset:416
    ds_read_b128 v[166:169], v17 offset:33664
    ds_read_b128 v[170:173], v17 offset:33696
    ds_read_b128 v[198:201], v18 offset:3120
    ds_read_b128 v[202:205], v18 offset:3152
    s_waitcnt lgkmcnt(6)
    v_mfma_f32_32x32x16_bf16 v[126:141], v[142:145], v[182:185], v[126:141]
    v_mfma_f32_32x32x16_bf16 v[126:141], v[146:149], v[186:189], v[126:141]
    v_mfma_f32_32x32x16_bf16 v[126:141], v[150:153], v[182:185], v[126:141]
    v_mfma_f32_32x32x16_bf16 v[126:141], v[154:157], v[186:189], v[126:141]
    ds_read_b128 v[142:145], v17 offset:320
    ds_read_b128 v[146:149], v17 offset:352
    ds_read_b128 v[150:153], v17 offset:33600
    ds_read_b128 v[154:157], v17 offset:33632
    ds_read_b128 v[182:185], v18 offset:3040
    ds_read_b128 v[186:189], v18 offset:3072
    s_waitcnt lgkmcnt(6)
    v_mfma_f32_32x32x16_bf16 v[126:141], v[158:161], v[198:201], v[126:141]
    v_mfma_f32_32x32x16_bf16 v[126:141], v[162:165], v[202:205], v[126:141]
    v_mfma_f32_32x32x16_bf16 v[126:141], v[166:169], v[198:201], v[126:141]
    v_mfma_f32_32x32x16_bf16 v[126:141], v[170:173], v[202:205], v[126:141]
    ds_read_b128 v[158:161], v17 offset:256
    ds_read_b128 v[162:165], v17 offset:288
    ds_read_b128 v[166:169], v17 offset:33536
    ds_read_b128 v[170:173], v17 offset:33568
    ds_read_b128 v[198:201], v18 offset:2960
    ds_read_b128 v[202:205], v18 offset:2992
    s_waitcnt lgkmcnt(6)
    v_mfma_f32_32x32x16_bf16 v[126:141], v[142:145], v[182:185], v[126:141]
    v_mfma_f32_32x32x16_bf16 v[126:141], v[146:149], v[186:189], v[126:141]
    v_mfma_f32_32x32x16_bf16 v[126:141], v[150:153], v[182:185], v[126:141]
    v_mfma_f32_32x32x16_bf16 v[126:141], v[154:157], v[186:189], v[126:141]
    ds_read_b128 v[142:145], v17 offset:192
    ds_read_b128 v[146:149], v17 offset:224
    ds_read_b128 v[150:153], v17 offset:33472
    ds_read_b128 v[154:157], v17 offset:33504
    ds_read_b128 v[182:185], v18 offset:2880
    ds_read_b128 v[186:189], v18 offset:2912
    s_waitcnt lgkmcnt(6)
    v_mfma_f32_32x32x16_bf16 v[126:141], v[158:161], v[198:201], v[126:141]
    v_mfma_f32_32x32x16_bf16 v[126:141], v[162:165], v[202:205], v[126:141]
    v_mfma_f32_32x32x16_bf16 v[126:141], v[166:169], v[198:201], v[126:141]
    v_mfma_f32_32x32x16_bf16 v[126:141], v[170:173], v[202:205], v[126:141]
    ds_read_b128 v[158:161], v17 offset:128
    ds_read_b128 v[162:165], v17 offset:160
    ds_read_b128 v[166:169], v17 offset:33408
    ds_read_b128 v[170:173], v17 offset:33440
    ds_read_b128 v[198:201], v18 offset:2800
    ds_read_b128 v[202:205], v18 offset:2832
    s_waitcnt lgkmcnt(6)
    v_mfma_f32_32x32x16_bf16 v[126:141], v[142:145], v[182:185], v[126:141]
    v_mfma_f32_32x32x16_bf16 v[126:141], v[146:149], v[186:189], v[126:141]
    v_mfma_f32_32x32x16_bf16 v[126:141], v[150:153], v[182:185], v[126:141]
    v_mfma_f32_32x32x16_bf16 v[126:141], v[154:157], v[186:189], v[126:141]
    ds_read_b128 v[142:145], v17 offset:64
    ds_read_b128 v[146:149], v17 offset:96
    ds_read_b128 v[150:153], v17 offset:33344
    ds_read_b128 v[154:157], v17 offset:33376
    ds_read_b128 v[182:185], v18 offset:2720
    ds_read_b128 v[186:189], v18 offset:2752
    s_waitcnt lgkmcnt(6)
    v_mfma_f32_32x32x16_bf16 v[126:141], v[158:161], v[198:201], v[126:141]
    v_mfma_f32_32x32x16_bf16 v[126:141], v[162:165], v[202:205], v[126:141]
    v_mfma_f32_32x32x16_bf16 v[126:141], v[166:169], v[198:201], v[126:141]
    v_mfma_f32_32x32x16_bf16 v[126:141], v[170:173], v[202:205], v[126:141]
    ds_read_b128 v[158:161], v17 offset:0
    ds_read_b128 v[162:165], v17 offset:32
    ds_read_b128 v[166:169], v17 offset:33280
    ds_read_b128 v[170:173], v17 offset:33312
    ds_read_b128 v[198:201], v18 offset:2640
    ds_read_b128 v[202:205], v18 offset:2672
    s_waitcnt lgkmcnt(6)
    v_mfma_f32_32x32x16_bf16 v[126:141], v[142:145], v[182:185], v[126:141]
    v_mfma_f32_32x32x16_bf16 v[126:141], v[146:149], v[186:189], v[126:141]
    v_mfma_f32_32x32x16_bf16 v[126:141], v[150:153], v[182:185], v[126:141]
    v_mfma_f32_32x32x16_bf16 v[126:141], v[154:157], v[186:189], v[126:141]
    s_waitcnt lgkmcnt(0)
    v_mfma_f32_32x32x16_bf16 v[126:141], v[158:161], v[198:201], v[126:141]
    v_mfma_f32_32x32x16_bf16 v[126:141], v[162:165], v[202:205], v[126:141]
    v_mfma_f32_32x32x16_bf16 v[126:141], v[166:169], v[198:201], v[126:141]
    v_mfma_f32_32x32x16_bf16 v[126:141], v[170:173], v[202:205], v[126:141]
L_conv_epi:
    s_nop 15
    s_nop 3
    s_barrier
    v_lshlrev_b32 v19, 7, v13
    v_lshl_add_u32 v19, v14, 4, v19
    v_lshl_add_u32 v19, v15, 13, v19

    ds_write_b128 v19, v[110:113] offset:0
    ds_write_b128 v19, v[114:117] offset:32
    ds_write_b128 v19, v[118:121] offset:64
    ds_write_b128 v19, v[122:125] offset:96
    ds_write_b128 v19, v[126:129] offset:4096
    ds_write_b128 v19, v[130:133] offset:4128
    ds_write_b128 v19, v[134:137] offset:4160
    ds_write_b128 v19, v[138:141] offset:4192
    s_waitcnt lgkmcnt(0)
    s_barrier
    v_lshlrev_b32 v19, 5, v0

    ds_read_b128 v[142:145], v19 offset:0
    ds_read_b128 v[146:149], v19 offset:16
    ds_read_b128 v[150:153], v19 offset:8192
    ds_read_b128 v[154:157], v19 offset:8208
    ds_read_b128 v[158:161], v19 offset:16384
    ds_read_b128 v[162:165], v19 offset:16400
    ds_read_b128 v[166:169], v19 offset:24576
    ds_read_b128 v[170:173], v19 offset:24592
    s_waitcnt lgkmcnt(0)
    v_add_f32 v142, v142, v150
    v_add_f32 v158, v158, v166
    v_add_f32 v142, v142, v158
    v_cvt_pk_bf16_f32 v142, v142, v142
    v_lshlrev_b32 v142, 16, v142
    v_mul_f32 v100, v92, v83
    v_cvt_pk_bf16_f32 v100, v100, v100
    v_lshlrev_b32 v100, 16, v100
    v_add_f32 v100, v142, v100
    v_cvt_pk_bf16_f32 v100, v100, v100
    v_lshlrev_b32 v100, 16, v100
    v_mul_f32 v100, v82, v100
    v_cvt_pk_bf16_f32 v100, v100, v100
    v_lshlrev_b32 v100, 16, v100
    v_add_f32 v142, v84, v100
    v_add_f32 v143, v143, v151
    v_add_f32 v159, v159, v167
    v_add_f32 v143, v143, v159
    v_cvt_pk_bf16_f32 v143, v143, v143
    v_lshlrev_b32 v143, 16, v143
    v_mul_f32 v100, v93, v83
    v_cvt_pk_bf16_f32 v100, v100, v100
    v_lshlrev_b32 v100, 16, v100
    v_add_f32 v100, v143, v100
    v_cvt_pk_bf16_f32 v100, v100, v100
    v_lshlrev_b32 v100, 16, v100
    v_mul_f32 v100, v82, v100
    v_cvt_pk_bf16_f32 v100, v100, v100
    v_lshlrev_b32 v100, 16, v100
    v_add_f32 v143, v85, v100
    v_add_f32 v144, v144, v152
    v_add_f32 v160, v160, v168
    v_add_f32 v144, v144, v160
    v_cvt_pk_bf16_f32 v144, v144, v144
    v_lshlrev_b32 v144, 16, v144
    v_mul_f32 v100, v94, v83
    v_cvt_pk_bf16_f32 v100, v100, v100
    v_lshlrev_b32 v100, 16, v100
    v_add_f32 v100, v144, v100
    v_cvt_pk_bf16_f32 v100, v100, v100
    v_lshlrev_b32 v100, 16, v100
    v_mul_f32 v100, v82, v100
    v_cvt_pk_bf16_f32 v100, v100, v100
    v_lshlrev_b32 v100, 16, v100
    v_add_f32 v144, v86, v100
    v_add_f32 v145, v145, v153
    v_add_f32 v161, v161, v169
    v_add_f32 v145, v145, v161
    v_cvt_pk_bf16_f32 v145, v145, v145
    v_lshlrev_b32 v145, 16, v145
    v_mul_f32 v100, v95, v83
    v_cvt_pk_bf16_f32 v100, v100, v100
    v_lshlrev_b32 v100, 16, v100
    v_add_f32 v100, v145, v100
    v_cvt_pk_bf16_f32 v100, v100, v100
    v_lshlrev_b32 v100, 16, v100
    v_mul_f32 v100, v82, v100
    v_cvt_pk_bf16_f32 v100, v100, v100
    v_lshlrev_b32 v100, 16, v100
    v_add_f32 v145, v87, v100
    v_add_f32 v146, v146, v154
    v_add_f32 v162, v162, v170
    v_add_f32 v146, v146, v162
    v_cvt_pk_bf16_f32 v146, v146, v146
    v_lshlrev_b32 v146, 16, v146
    v_mul_f32 v100, v96, v83
    v_cvt_pk_bf16_f32 v100, v100, v100
    v_lshlrev_b32 v100, 16, v100
    v_add_f32 v100, v146, v100
    v_cvt_pk_bf16_f32 v100, v100, v100
    v_lshlrev_b32 v100, 16, v100
    v_mul_f32 v100, v82, v100
    v_cvt_pk_bf16_f32 v100, v100, v100
    v_lshlrev_b32 v100, 16, v100
    v_add_f32 v146, v88, v100
    v_add_f32 v147, v147, v155
    v_add_f32 v163, v163, v171
    v_add_f32 v147, v147, v163
    v_cvt_pk_bf16_f32 v147, v147, v147
    v_lshlrev_b32 v147, 16, v147
    v_mul_f32 v100, v97, v83
    v_cvt_pk_bf16_f32 v100, v100, v100
    v_lshlrev_b32 v100, 16, v100
    v_add_f32 v100, v147, v100
    v_cvt_pk_bf16_f32 v100, v100, v100
    v_lshlrev_b32 v100, 16, v100
    v_mul_f32 v100, v82, v100
    v_cvt_pk_bf16_f32 v100, v100, v100
    v_lshlrev_b32 v100, 16, v100
    v_add_f32 v147, v89, v100
    v_add_f32 v148, v148, v156
    v_add_f32 v164, v164, v172
    v_add_f32 v148, v148, v164
    v_cvt_pk_bf16_f32 v148, v148, v148
    v_lshlrev_b32 v148, 16, v148
    v_mul_f32 v100, v98, v83
    v_cvt_pk_bf16_f32 v100, v100, v100
    v_lshlrev_b32 v100, 16, v100
    v_add_f32 v100, v148, v100
    v_cvt_pk_bf16_f32 v100, v100, v100
    v_lshlrev_b32 v100, 16, v100
    v_mul_f32 v100, v82, v100
    v_cvt_pk_bf16_f32 v100, v100, v100
    v_lshlrev_b32 v100, 16, v100
    v_add_f32 v148, v90, v100
    v_add_f32 v149, v149, v157
    v_add_f32 v165, v165, v173
    v_add_f32 v149, v149, v165
    v_cvt_pk_bf16_f32 v149, v149, v149
    v_lshlrev_b32 v149, 16, v149
    v_mul_f32 v100, v99, v83
    v_cvt_pk_bf16_f32 v100, v100, v100
    v_lshlrev_b32 v100, 16, v100
    v_add_f32 v100, v149, v100
    v_cvt_pk_bf16_f32 v100, v100, v100
    v_lshlrev_b32 v100, 16, v100
    v_mul_f32 v100, v82, v100
    v_cvt_pk_bf16_f32 v100, v100, v100
    v_lshlrev_b32 v100, 16, v100
    v_add_f32 v149, v91, v100
    v_cvt_pk_bf16_f32 v104, v142, v143
    v_cvt_pk_bf16_f32 v105, v144, v145
    v_cvt_pk_bf16_f32 v106, v146, v147
    v_cvt_pk_bf16_f32 v107, v148, v149
    buffer_store_dwordx4 v[104:107], v7, s[32:35], 0 offen
L_conv_end:
    s_endpgm

.globl ln2_kernel
.p2align 8
.type ln2_kernel,@function
ln2_kernel:
    s_cmp_ge_u32 s2, 64
    s_cbranch_scc1 L_ln2_end
    s_load_dwordx2 s[4:5], s[0:1], 128
    s_waitcnt lgkmcnt(0)

    s_add_u32 s8, s4, 17874944
    s_addc_u32 s9, s5, 0
    s_mov_b32 s10, 2359296
    s_mov_b32 s11, 0x00020000
    s_mov_b32 s12, s4
    s_mov_b32 s13, s5
    s_mov_b32 s14, 13824
    s_mov_b32 s15, 0x00020000
    s_add_u32 s16, s4, 22593536
    s_addc_u32 s17, s5, 0
    s_mov_b32 s18, 2359296
    s_mov_b32 s19, 0x00020000
    s_add_u32 s20, s4, 20234240
    s_addc_u32 s21, s5, 0
    s_mov_b32 s22, 2359296
    s_mov_b32 s23, 0x00020000
    s_mov_b32 s60, 0x05040100
    s_mov_b32 s61, 0x07060302
    s_lshl_b32 s36, s2, 6
    v_add_u32 v1, 0, v0
    v_lshrrev_b32 v2, 2, v1
    v_and_b32 v3, 3, v1
    v_lshlrev_b32 v4, 15, v2
    v_lshl_add_u32 v4, v3, 4, v4
    v_add_u32 v4, s36, v4
    v_lshlrev_b32 v5, 3, v3
    v_mul_u32_u24 v5, 1168, v5
    v_lshl_add_u32 v5, v2, 4, v5
    v_cmp_gt_u32 vcc, 288, v1
    s_and_saveexec_b64 s[38:39], vcc
    s_cbranch_execz L_ln2_skip0

    v_add_u32 v6, 0, v4
    buffer_load_dwordx4 v[40:43], v6, s[8:11], 0 offen
    v_add_u32 v6, 4096, v4
    buffer_load_dwordx4 v[44:47], v6, s[8:11], 0 offen
    v_add_u32 v6, 8192, v4
    buffer_load_dwordx4 v[48:51], v6, s[8:11], 0 offen
    v_add_u32 v6, 12288, v4
    buffer_load_dwordx4 v[52:55], v6, s[8:11], 0 offen
    v_add_u32 v6, 16384, v4
    buffer_load_dwordx4 v[56:59], v6, s[8:11], 0 offen
    v_add_u32 v6, 20480, v4
    buffer_load_dwordx4 v[60:63], v6, s[8:11], 0 offen
    v_add_u32 v6, 24576, v4
    buffer_load_dwordx4 v[64:67], v6, s[8:11], 0 offen
    v_add_u32 v6, 28672, v4
    buffer_load_dwordx4 v[68:71], v6, s[8:11], 0 offen
    s_waitcnt vmcnt(0)
    v_perm_b32 v72, v44, v40, s60
    v_perm_b32 v73, v52, v48, s60
    v_perm_b32 v74, v60, v56, s60
    v_perm_b32 v75, v68, v64, s60
    v_perm_b32 v76, v44, v40, s61
    v_perm_b32 v77, v52, v48, s61
    v_perm_b32 v78, v60, v56, s61
    v_perm_b32 v79, v68, v64, s61
    v_perm_b32 v80, v45, v41, s60
    v_perm_b32 v81, v53, v49, s60
    v_perm_b32 v82, v61, v57, s60
    v_perm_b32 v83, v69, v65, s60
    v_perm_b32 v84, v45, v41, s61
    v_perm_b32 v85, v53, v49, s61
    v_perm_b32 v86, v61, v57, s61
    v_perm_b32 v87, v69, v65, s61
    v_perm_b32 v88, v46, v42, s60
    v_perm_b32 v89, v54, v50, s60
    v_perm_b32 v90, v62, v58, s60
    v_perm_b32 v91, v70, v66, s60
    v_perm_b32 v92, v46, v42, s61
    v_perm_b32 v93, v54, v50, s61
    v_perm_b32 v94, v62, v58, s61
    v_perm_b32 v95, v70, v66, s61
    v_perm_b32 v96, v47, v43, s60
    v_perm_b32 v97, v55, v51, s60
    v_perm_b32 v98, v63, v59, s60
    v_perm_b32 v99, v71, v67, s60
    v_perm_b32 v100, v47, v43, s61
    v_perm_b32 v101, v55, v51, s61
    v_perm_b32 v102, v63, v59, s61
    v_perm_b32 v103, v71, v67, s61
    ds_write_b128 v5, v[72:75] offset:0
    ds_write_b128 v5, v[76:79] offset:1168
    ds_write_b128 v5, v[80:83] offset:2336
    ds_write_b128 v5, v[84:87] offset:3504
    ds_write_b128 v5, v[88:91] offset:4672
    ds_write_b128 v5, v[92:95] offset:5840
    ds_write_b128 v5, v[96:99] offset:7008
    ds_write_b128 v5, v[100:103] offset:8176
L_ln2_skip0:
    s_mov_b64 exec, s[38:39]
    v_add_u32 v1, 256, v0
    v_lshrrev_b32 v2, 2, v1
    v_and_b32 v3, 3, v1
    v_lshlrev_b32 v4, 15, v2
    v_lshl_add_u32 v4, v3, 4, v4
    v_add_u32 v4, s36, v4
    v_lshlrev_b32 v5, 3, v3
    v_mul_u32_u24 v5, 1168, v5
    v_lshl_add_u32 v5, v2, 4, v5
    v_cmp_gt_u32 vcc, 288, v1
    s_and_saveexec_b64 s[38:39], vcc
    s_cbranch_execz L_ln2_skip1

    v_add_u32 v6, 0, v4
    buffer_load_dwordx4 v[40:43], v6, s[8:11], 0 offen
    v_add_u32 v6, 4096, v4
    buffer_load_dwordx4 v[44:47], v6, s[8:11], 0 offen
    v_add_u32 v6, 8192, v4
    buffer_load_dwordx4 v[48:51], v6, s[8:11], 0 offen
    v_add_u32 v6, 12288, v4
    buffer_load_dwordx4 v[52:55], v6, s[8:11], 0 offen
    v_add_u32 v6, 16384, v4
    buffer_load_dwordx4 v[56:59], v6, s[8:11], 0 offen
    v_add_u32 v6, 20480, v4
    buffer_load_dwordx4 v[60:63], v6, s[8:11], 0 offen
    v_add_u32 v6, 24576, v4
    buffer_load_dwordx4 v[64:67], v6, s[8:11], 0 offen
    v_add_u32 v6, 28672, v4
    buffer_load_dwordx4 v[68:71], v6, s[8:11], 0 offen
    s_waitcnt vmcnt(0)
    v_perm_b32 v72, v44, v40, s60
    v_perm_b32 v73, v52, v48, s60
    v_perm_b32 v74, v60, v56, s60
    v_perm_b32 v75, v68, v64, s60
    v_perm_b32 v76, v44, v40, s61
    v_perm_b32 v77, v52, v48, s61
    v_perm_b32 v78, v60, v56, s61
    v_perm_b32 v79, v68, v64, s61
    v_perm_b32 v80, v45, v41, s60
    v_perm_b32 v81, v53, v49, s60
    v_perm_b32 v82, v61, v57, s60
    v_perm_b32 v83, v69, v65, s60
    v_perm_b32 v84, v45, v41, s61
    v_perm_b32 v85, v53, v49, s61
    v_perm_b32 v86, v61, v57, s61
    v_perm_b32 v87, v69, v65, s61
    v_perm_b32 v88, v46, v42, s60
    v_perm_b32 v89, v54, v50, s60
    v_perm_b32 v90, v62, v58, s60
    v_perm_b32 v91, v70, v66, s60
    v_perm_b32 v92, v46, v42, s61
    v_perm_b32 v93, v54, v50, s61
    v_perm_b32 v94, v62, v58, s61
    v_perm_b32 v95, v70, v66, s61
    v_perm_b32 v96, v47, v43, s60
    v_perm_b32 v97, v55, v51, s60
    v_perm_b32 v98, v63, v59, s60
    v_perm_b32 v99, v71, v67, s60
    v_perm_b32 v100, v47, v43, s61
    v_perm_b32 v101, v55, v51, s61
    v_perm_b32 v102, v63, v59, s61
    v_perm_b32 v103, v71, v67, s61
    ds_write_b128 v5, v[72:75] offset:0
    ds_write_b128 v5, v[76:79] offset:1168
    ds_write_b128 v5, v[80:83] offset:2336
    ds_write_b128 v5, v[84:87] offset:3504
    ds_write_b128 v5, v[88:91] offset:4672
    ds_write_b128 v5, v[92:95] offset:5840
    ds_write_b128 v5, v[96:99] offset:7008
    ds_write_b128 v5, v[100:103] offset:8176
L_ln2_skip1:
    s_mov_b64 exec, s[38:39]
    s_waitcnt lgkmcnt(0)
    s_barrier
    v_lshrrev_b32 v1, 3, v0
    v_and_b32 v2, 7, v0
    v_mul_u32_u24 v3, 1168, v1
    v_lshl_add_u32 v3, v2, 4, v3

    ds_read_b128 v[40:43], v3 offset:0
    ds_read_b128 v[44:47], v3 offset:128
    ds_read_b128 v[48:51], v3 offset:256
    ds_read_b128 v[52:55], v3 offset:384
    ds_read_b128 v[56:59], v3 offset:512
    ds_read_b128 v[60:63], v3 offset:640
    ds_read_b128 v[64:67], v3 offset:768
    ds_read_b128 v[68:71], v3 offset:896
    ds_read_b128 v[72:75], v3 offset:1024
    v_lshlrev_b32 v4, 5, v2
    v_add_u32 v5, 6912, v4
    buffer_load_dwordx4 v[80:83], v5, s[12:15], 0 offen
    buffer_load_dwordx4 v[84:87], v5, s[12:15], 0 offen offset:16
    v_add_u32 v5, 7168, v4
    buffer_load_dwordx4 v[88:91], v5, s[12:15], 0 offen
    buffer_load_dwordx4 v[92:95], v5, s[12:15], 0 offen offset:16
    v_add_u32 v5, 7424, v4
    buffer_load_dwordx4 v[96:99], v5, s[12:15], 0 offen
    buffer_load_dwordx4 v[100:103], v5, s[12:15], 0 offen offset:16
    v_add_u32 v5, 7680, v4
    buffer_load_dwordx4 v[104:107], v5, s[12:15], 0 offen
    buffer_load_dwordx4 v[108:111], v5, s[12:15], 0 offen offset:16
    v_add_u32 v5, 7936, v4
    buffer_load_dwordx4 v[112:115], v5, s[12:15], 0 offen
    buffer_load_dwordx4 v[116:119], v5, s[12:15], 0 offen offset:16
    v_add_u32 v5, 8192, v4
    buffer_load_dwordx4 v[120:123], v5, s[12:15], 0 offen
    buffer_load_dwordx4 v[124:127], v5, s[12:15], 0 offen offset:16
    v_add_u32 v5, 8448, v4
    buffer_load_dwordx4 v[128:131], v5, s[12:15], 0 offen
    buffer_load_dwordx4 v[132:135], v5, s[12:15], 0 offen offset:16
    v_add_u32 v5, 8704, v4
    buffer_load_dwordx4 v[136:139], v5, s[12:15], 0 offen
    buffer_load_dwordx4 v[140:143], v5, s[12:15], 0 offen offset:16
    v_add_u32 v5, 8960, v4
    buffer_load_dwordx4 v[144:147], v5, s[12:15], 0 offen
    buffer_load_dwordx4 v[148:151], v5, s[12:15], 0 offen offset:16
    s_mov_b32 s62, 0xffff0000
    s_mov_b32 s63, 0x3AE38E39
    v_mov_b32 v8, 0
    s_waitcnt lgkmcnt(0)
    v_lshlrev_b32 v10, 16, v40
    v_and_b32 v11, s62, v40
    v_add_f32 v8, v8, v10
    v_add_f32 v8, v8, v11
    v_lshlrev_b32 v10, 16, v41
    v_and_b32 v11, s62, v41
    v_add_f32 v8, v8, v10
    v_add_f32 v8, v8, v11
    v_lshlrev_b32 v10, 16, v42
    v_and_b32 v11, s62, v42
    v_add_f32 v8, v8, v10
    v_add_f32 v8, v8, v11
    v_lshlrev_b32 v10, 16, v43
    v_and_b32 v11, s62, v43
    v_add_f32 v8, v8, v10
    v_add_f32 v8, v8, v11
    v_lshlrev_b32 v10, 16, v44
    v_and_b32 v11, s62, v44
    v_add_f32 v8, v8, v10
    v_add_f32 v8, v8, v11
    v_lshlrev_b32 v10, 16, v45
    v_and_b32 v11, s62, v45
    v_add_f32 v8, v8, v10
    v_add_f32 v8, v8, v11
    v_lshlrev_b32 v10, 16, v46
    v_and_b32 v11, s62, v46
    v_add_f32 v8, v8, v10
    v_add_f32 v8, v8, v11
    v_lshlrev_b32 v10, 16, v47
    v_and_b32 v11, s62, v47
    v_add_f32 v8, v8, v10
    v_add_f32 v8, v8, v11
    v_lshlrev_b32 v10, 16, v48
    v_and_b32 v11, s62, v48
    v_add_f32 v8, v8, v10
    v_add_f32 v8, v8, v11
    v_lshlrev_b32 v10, 16, v49
    v_and_b32 v11, s62, v49
    v_add_f32 v8, v8, v10
    v_add_f32 v8, v8, v11
    v_lshlrev_b32 v10, 16, v50
    v_and_b32 v11, s62, v50
    v_add_f32 v8, v8, v10
    v_add_f32 v8, v8, v11
    v_lshlrev_b32 v10, 16, v51
    v_and_b32 v11, s62, v51
    v_add_f32 v8, v8, v10
    v_add_f32 v8, v8, v11
    v_lshlrev_b32 v10, 16, v52
    v_and_b32 v11, s62, v52
    v_add_f32 v8, v8, v10
    v_add_f32 v8, v8, v11
    v_lshlrev_b32 v10, 16, v53
    v_and_b32 v11, s62, v53
    v_add_f32 v8, v8, v10
    v_add_f32 v8, v8, v11
    v_lshlrev_b32 v10, 16, v54
    v_and_b32 v11, s62, v54
    v_add_f32 v8, v8, v10
    v_add_f32 v8, v8, v11
    v_lshlrev_b32 v10, 16, v55
    v_and_b32 v11, s62, v55
    v_add_f32 v8, v8, v10
    v_add_f32 v8, v8, v11
    v_lshlrev_b32 v10, 16, v56
    v_and_b32 v11, s62, v56
    v_add_f32 v8, v8, v10
    v_add_f32 v8, v8, v11
    v_lshlrev_b32 v10, 16, v57
    v_and_b32 v11, s62, v57
    v_add_f32 v8, v8, v10
    v_add_f32 v8, v8, v11
    v_lshlrev_b32 v10, 16, v58
    v_and_b32 v11, s62, v58
    v_add_f32 v8, v8, v10
    v_add_f32 v8, v8, v11
    v_lshlrev_b32 v10, 16, v59
    v_and_b32 v11, s62, v59
    v_add_f32 v8, v8, v10
    v_add_f32 v8, v8, v11
    v_lshlrev_b32 v10, 16, v60
    v_and_b32 v11, s62, v60
    v_add_f32 v8, v8, v10
    v_add_f32 v8, v8, v11
    v_lshlrev_b32 v10, 16, v61
    v_and_b32 v11, s62, v61
    v_add_f32 v8, v8, v10
    v_add_f32 v8, v8, v11
    v_lshlrev_b32 v10, 16, v62
    v_and_b32 v11, s62, v62
    v_add_f32 v8, v8, v10
    v_add_f32 v8, v8, v11
    v_lshlrev_b32 v10, 16, v63
    v_and_b32 v11, s62, v63
    v_add_f32 v8, v8, v10
    v_add_f32 v8, v8, v11
    v_lshlrev_b32 v10, 16, v64
    v_and_b32 v11, s62, v64
    v_add_f32 v8, v8, v10
    v_add_f32 v8, v8, v11
    v_lshlrev_b32 v10, 16, v65
    v_and_b32 v11, s62, v65
    v_add_f32 v8, v8, v10
    v_add_f32 v8, v8, v11
    v_lshlrev_b32 v10, 16, v66
    v_and_b32 v11, s62, v66
    v_add_f32 v8, v8, v10
    v_add_f32 v8, v8, v11
    v_lshlrev_b32 v10, 16, v67
    v_and_b32 v11, s62, v67
    v_add_f32 v8, v8, v10
    v_add_f32 v8, v8, v11
    v_lshlrev_b32 v10, 16, v68
    v_and_b32 v11, s62, v68
    v_add_f32 v8, v8, v10
    v_add_f32 v8, v8, v11
    v_lshlrev_b32 v10, 16, v69
    v_and_b32 v11, s62, v69
    v_add_f32 v8, v8, v10
    v_add_f32 v8, v8, v11
    v_lshlrev_b32 v10, 16, v70
    v_and_b32 v11, s62, v70
    v_add_f32 v8, v8, v10
    v_add_f32 v8, v8, v11
    v_lshlrev_b32 v10, 16, v71
    v_and_b32 v11, s62, v71
    v_add_f32 v8, v8, v10
    v_add_f32 v8, v8, v11
    v_lshlrev_b32 v10, 16, v72
    v_and_b32 v11, s62, v72
    v_add_f32 v8, v8, v10
    v_add_f32 v8, v8, v11
    v_lshlrev_b32 v10, 16, v73
    v_and_b32 v11, s62, v73
    v_add_f32 v8, v8, v10
    v_add_f32 v8, v8, v11
    v_lshlrev_b32 v10, 16, v74
    v_and_b32 v11, s62, v74
    v_add_f32 v8, v8, v10
    v_add_f32 v8, v8, v11
    v_lshlrev_b32 v10, 16, v75
    v_and_b32 v11, s62, v75
    v_add_f32 v8, v8, v10
    v_add_f32 v8, v8, v11
    ds_swizzle_b32 v9, v8 offset:0x041F
    s_waitcnt lgkmcnt(0)
    v_add_f32 v8, v8, v9
    ds_swizzle_b32 v9, v8 offset:0x081F
    s_waitcnt lgkmcnt(0)
    v_add_f32 v8, v8, v9
    ds_swizzle_b32 v9, v8 offset:0x101F
    s_waitcnt lgkmcnt(0)
    v_add_f32 v8, v8, v9
    v_mul_f32 v8, s63, v8
    v_mov_b32 v12, 0
    v_lshlrev_b32 v10, 16, v40
    v_and_b32 v11, s62, v40
    v_sub_f32 v10, v10, v8
    v_sub_f32 v11, v11, v8
    v_fmac_f32 v12, v10, v10
    v_fmac_f32 v12, v11, v11
    v_lshlrev_b32 v10, 16, v41
    v_and_b32 v11, s62, v41
    v_sub_f32 v10, v10, v8
    v_sub_f32 v11, v11, v8
    v_fmac_f32 v12, v10, v10
    v_fmac_f32 v12, v11, v11
    v_lshlrev_b32 v10, 16, v42
    v_and_b32 v11, s62, v42
    v_sub_f32 v10, v10, v8
    v_sub_f32 v11, v11, v8
    v_fmac_f32 v12, v10, v10
    v_fmac_f32 v12, v11, v11
    v_lshlrev_b32 v10, 16, v43
    v_and_b32 v11, s62, v43
    v_sub_f32 v10, v10, v8
    v_sub_f32 v11, v11, v8
    v_fmac_f32 v12, v10, v10
    v_fmac_f32 v12, v11, v11
    v_lshlrev_b32 v10, 16, v44
    v_and_b32 v11, s62, v44
    v_sub_f32 v10, v10, v8
    v_sub_f32 v11, v11, v8
    v_fmac_f32 v12, v10, v10
    v_fmac_f32 v12, v11, v11
    v_lshlrev_b32 v10, 16, v45
    v_and_b32 v11, s62, v45
    v_sub_f32 v10, v10, v8
    v_sub_f32 v11, v11, v8
    v_fmac_f32 v12, v10, v10
    v_fmac_f32 v12, v11, v11
    v_lshlrev_b32 v10, 16, v46
    v_and_b32 v11, s62, v46
    v_sub_f32 v10, v10, v8
    v_sub_f32 v11, v11, v8
    v_fmac_f32 v12, v10, v10
    v_fmac_f32 v12, v11, v11
    v_lshlrev_b32 v10, 16, v47
    v_and_b32 v11, s62, v47
    v_sub_f32 v10, v10, v8
    v_sub_f32 v11, v11, v8
    v_fmac_f32 v12, v10, v10
    v_fmac_f32 v12, v11, v11
    v_lshlrev_b32 v10, 16, v48
    v_and_b32 v11, s62, v48
    v_sub_f32 v10, v10, v8
    v_sub_f32 v11, v11, v8
    v_fmac_f32 v12, v10, v10
    v_fmac_f32 v12, v11, v11
    v_lshlrev_b32 v10, 16, v49
    v_and_b32 v11, s62, v49
    v_sub_f32 v10, v10, v8
    v_sub_f32 v11, v11, v8
    v_fmac_f32 v12, v10, v10
    v_fmac_f32 v12, v11, v11
    v_lshlrev_b32 v10, 16, v50
    v_and_b32 v11, s62, v50
    v_sub_f32 v10, v10, v8
    v_sub_f32 v11, v11, v8
    v_fmac_f32 v12, v10, v10
    v_fmac_f32 v12, v11, v11
    v_lshlrev_b32 v10, 16, v51
    v_and_b32 v11, s62, v51
    v_sub_f32 v10, v10, v8
    v_sub_f32 v11, v11, v8
    v_fmac_f32 v12, v10, v10
    v_fmac_f32 v12, v11, v11
    v_lshlrev_b32 v10, 16, v52
    v_and_b32 v11, s62, v52
    v_sub_f32 v10, v10, v8
    v_sub_f32 v11, v11, v8
    v_fmac_f32 v12, v10, v10
    v_fmac_f32 v12, v11, v11
    v_lshlrev_b32 v10, 16, v53
    v_and_b32 v11, s62, v53
    v_sub_f32 v10, v10, v8
    v_sub_f32 v11, v11, v8
    v_fmac_f32 v12, v10, v10
    v_fmac_f32 v12, v11, v11
    v_lshlrev_b32 v10, 16, v54
    v_and_b32 v11, s62, v54
    v_sub_f32 v10, v10, v8
    v_sub_f32 v11, v11, v8
    v_fmac_f32 v12, v10, v10
    v_fmac_f32 v12, v11, v11
    v_lshlrev_b32 v10, 16, v55
    v_and_b32 v11, s62, v55
    v_sub_f32 v10, v10, v8
    v_sub_f32 v11, v11, v8
    v_fmac_f32 v12, v10, v10
    v_fmac_f32 v12, v11, v11
    v_lshlrev_b32 v10, 16, v56
    v_and_b32 v11, s62, v56
    v_sub_f32 v10, v10, v8
    v_sub_f32 v11, v11, v8
    v_fmac_f32 v12, v10, v10
    v_fmac_f32 v12, v11, v11
    v_lshlrev_b32 v10, 16, v57
    v_and_b32 v11, s62, v57
    v_sub_f32 v10, v10, v8
    v_sub_f32 v11, v11, v8
    v_fmac_f32 v12, v10, v10
    v_fmac_f32 v12, v11, v11
    v_lshlrev_b32 v10, 16, v58
    v_and_b32 v11, s62, v58
    v_sub_f32 v10, v10, v8
    v_sub_f32 v11, v11, v8
    v_fmac_f32 v12, v10, v10
    v_fmac_f32 v12, v11, v11
    v_lshlrev_b32 v10, 16, v59
    v_and_b32 v11, s62, v59
    v_sub_f32 v10, v10, v8
    v_sub_f32 v11, v11, v8
    v_fmac_f32 v12, v10, v10
    v_fmac_f32 v12, v11, v11
    v_lshlrev_b32 v10, 16, v60
    v_and_b32 v11, s62, v60
    v_sub_f32 v10, v10, v8
    v_sub_f32 v11, v11, v8
    v_fmac_f32 v12, v10, v10
    v_fmac_f32 v12, v11, v11
    v_lshlrev_b32 v10, 16, v61
    v_and_b32 v11, s62, v61
    v_sub_f32 v10, v10, v8
    v_sub_f32 v11, v11, v8
    v_fmac_f32 v12, v10, v10
    v_fmac_f32 v12, v11, v11
    v_lshlrev_b32 v10, 16, v62
    v_and_b32 v11, s62, v62
    v_sub_f32 v10, v10, v8
    v_sub_f32 v11, v11, v8
    v_fmac_f32 v12, v10, v10
    v_fmac_f32 v12, v11, v11
    v_lshlrev_b32 v10, 16, v63
    v_and_b32 v11, s62, v63
    v_sub_f32 v10, v10, v8
    v_sub_f32 v11, v11, v8
    v_fmac_f32 v12, v10, v10
    v_fmac_f32 v12, v11, v11
    v_lshlrev_b32 v10, 16, v64
    v_and_b32 v11, s62, v64
    v_sub_f32 v10, v10, v8
    v_sub_f32 v11, v11, v8
    v_fmac_f32 v12, v10, v10
    v_fmac_f32 v12, v11, v11
    v_lshlrev_b32 v10, 16, v65
    v_and_b32 v11, s62, v65
    v_sub_f32 v10, v10, v8
    v_sub_f32 v11, v11, v8
    v_fmac_f32 v12, v10, v10
    v_fmac_f32 v12, v11, v11
    v_lshlrev_b32 v10, 16, v66
    v_and_b32 v11, s62, v66
    v_sub_f32 v10, v10, v8
    v_sub_f32 v11, v11, v8
    v_fmac_f32 v12, v10, v10
    v_fmac_f32 v12, v11, v11
    v_lshlrev_b32 v10, 16, v67
    v_and_b32 v11, s62, v67
    v_sub_f32 v10, v10, v8
    v_sub_f32 v11, v11, v8
    v_fmac_f32 v12, v10, v10
    v_fmac_f32 v12, v11, v11
    v_lshlrev_b32 v10, 16, v68
    v_and_b32 v11, s62, v68
    v_sub_f32 v10, v10, v8
    v_sub_f32 v11, v11, v8
    v_fmac_f32 v12, v10, v10
    v_fmac_f32 v12, v11, v11
    v_lshlrev_b32 v10, 16, v69
    v_and_b32 v11, s62, v69
    v_sub_f32 v10, v10, v8
    v_sub_f32 v11, v11, v8
    v_fmac_f32 v12, v10, v10
    v_fmac_f32 v12, v11, v11
    v_lshlrev_b32 v10, 16, v70
    v_and_b32 v11, s62, v70
    v_sub_f32 v10, v10, v8
    v_sub_f32 v11, v11, v8
    v_fmac_f32 v12, v10, v10
    v_fmac_f32 v12, v11, v11
    v_lshlrev_b32 v10, 16, v71
    v_and_b32 v11, s62, v71
    v_sub_f32 v10, v10, v8
    v_sub_f32 v11, v11, v8
    v_fmac_f32 v12, v10, v10
    v_fmac_f32 v12, v11, v11
    v_lshlrev_b32 v10, 16, v72
    v_and_b32 v11, s62, v72
    v_sub_f32 v10, v10, v8
    v_sub_f32 v11, v11, v8
    v_fmac_f32 v12, v10, v10
    v_fmac_f32 v12, v11, v11
    v_lshlrev_b32 v10, 16, v73
    v_and_b32 v11, s62, v73
    v_sub_f32 v10, v10, v8
    v_sub_f32 v11, v11, v8
    v_fmac_f32 v12, v10, v10
    v_fmac_f32 v12, v11, v11
    v_lshlrev_b32 v10, 16, v74
    v_and_b32 v11, s62, v74
    v_sub_f32 v10, v10, v8
    v_sub_f32 v11, v11, v8
    v_fmac_f32 v12, v10, v10
    v_fmac_f32 v12, v11, v11
    v_lshlrev_b32 v10, 16, v75
    v_and_b32 v11, s62, v75
    v_sub_f32 v10, v10, v8
    v_sub_f32 v11, v11, v8
    v_fmac_f32 v12, v10, v10
    v_fmac_f32 v12, v11, v11
    ds_swizzle_b32 v9, v12 offset:0x041F
    s_waitcnt lgkmcnt(0)
    v_add_f32 v12, v12, v9
    ds_swizzle_b32 v9, v12 offset:0x081F
    s_waitcnt lgkmcnt(0)
    v_add_f32 v12, v12, v9
    ds_swizzle_b32 v9, v12 offset:0x101F
    s_waitcnt lgkmcnt(0)
    v_add_f32 v12, v12, v9
    v_mul_f32 v12, s63, v12
    v_cvt_pk_bf16_f32 v8, v8, v8
    v_lshlrev_b32 v8, 16, v8
    v_cvt_pk_bf16_f32 v12, v12, v12
    v_lshlrev_b32 v12, 16, v12
    s_mov_b32 s64, 0x3727C5AC
    v_add_f32 v12, s64, v12
    v_cvt_pk_bf16_f32 v12, v12, v12
    v_lshlrev_b32 v12, 16, v12
    v_sqrt_f32 v12, v12
    s_nop 0
    v_cvt_pk_bf16_f32 v12, v12, v12
    v_lshlrev_b32 v12, 16, v12
    v_rcp_f32 v13, v12
    v_add_u32 v5, 9216, v4
    buffer_load_dwordx4 v[152:155], v5, s[12:15], 0 offen
    buffer_load_dwordx4 v[156:159], v5, s[12:15], 0 offen offset:16
    v_add_u32 v5, 9472, v4
    buffer_load_dwordx4 v[160:163], v5, s[12:15], 0 offen
    buffer_load_dwordx4 v[164:167], v5, s[12:15], 0 offen offset:16
    v_add_u32 v5, 9728, v4
    buffer_load_dwordx4 v[168:171], v5, s[12:15], 0 offen
    buffer_load_dwordx4 v[172:175], v5, s[12:15], 0 offen offset:16
    v_add_u32 v5, 9984, v4
    buffer_load_dwordx4 v[176:179], v5, s[12:15], 0 offen
    buffer_load_dwordx4 v[180:183], v5, s[12:15], 0 offen offset:16
    v_add_u32 v5, 10240, v4
    buffer_load_dwordx4 v[184:187], v5, s[12:15], 0 offen
    buffer_load_dwordx4 v[188:191], v5, s[12:15], 0 offen offset:16
    v_add_u32 v5, 10496, v4
    buffer_load_dwordx4 v[192:195], v5, s[12:15], 0 offen
    buffer_load_dwordx4 v[196:199], v5, s[12:15], 0 offen offset:16
    v_add_u32 v5, 10752, v4
    buffer_load_dwordx4 v[200:203], v5, s[12:15], 0 offen
    buffer_load_dwordx4 v[204:207], v5, s[12:15], 0 offen offset:16
    v_add_u32 v5, 11008, v4
    buffer_load_dwordx4 v[208:211], v5, s[12:15], 0 offen
    buffer_load_dwordx4 v[212:215], v5, s[12:15], 0 offen offset:16
    v_add_u32 v5, 11264, v4
    buffer_load_dwordx4 v[216:219], v5, s[12:15], 0 offen
    buffer_load_dwordx4 v[220:223], v5, s[12:15], 0 offen offset:16
    s_lshl_b32 s37, s2, 5
    v_add_u32 v14, s37, v1
    v_mul_u32_u24 v15, 1152, v14
    v_lshl_add_u32 v15, v2, 4, v15
    v_lshrrev_b32 v16, 7, v14
    v_and_b32 v17, 127, v14
    v_mul_u32_u24 v18, 1152, v16
    v_add_u32 v18, v18, v17
    v_lshlrev_b32 v18, 7, v18
    v_lshrrev_b32 v19, 1, v17
    v_and_b32 v19, 7, v19
    v_xor_b32 v19, v19, v2
    s_waitcnt vmcnt(0)

    v_lshlrev_b32 v20, 16, v40
    v_sub_f32 v20, v20, v8
    v_cvt_pk_bf16_f32 v20, v20, v20
    v_lshlrev_b32 v20, 16, v20
    v_mul_f32 v21, v20, v13
    v_fma_f32 v22, -v21, v12, v20
    v_fma_f32 v21, v22, v13, v21

    v_cvt_pk_bf16_f32 v21, v21, v21
    v_lshlrev_b32 v21, 16, v21
    v_add_f32 v22, 1.0, v152
    v_cvt_pk_bf16_f32 v22, v22, v22
    v_lshlrev_b32 v22, 16, v22
    v_mul_f32 v21, v21, v22
    v_cvt_pk_bf16_f32 v21, v21, v21
    v_lshlrev_b32 v21, 16, v21
    v_add_f32 v24, v21, v80
    v_and_b32 v20, s62, v40
    v_sub_f32 v20, v20, v8
    v_cvt_pk_bf16_f32 v20, v20, v20
    v_lshlrev_b32 v20, 16, v20
    v_mul_f32 v21, v20, v13
    v_fma_f32 v22, -v21, v12, v20
    v_fma_f32 v21, v22, v13, v21

    v_cvt_pk_bf16_f32 v21, v21, v21
    v_lshlrev_b32 v21, 16, v21
    v_add_f32 v22, 1.0, v153
    v_cvt_pk_bf16_f32 v22, v22, v22
    v_lshlrev_b32 v22, 16, v22
    v_mul_f32 v21, v21, v22
    v_cvt_pk_bf16_f32 v21, v21, v21
    v_lshlrev_b32 v21, 16, v21
    v_add_f32 v25, v21, v81
    v_lshlrev_b32 v20, 16, v41
    v_sub_f32 v20, v20, v8
    v_cvt_pk_bf16_f32 v20, v20, v20
    v_lshlrev_b32 v20, 16, v20
    v_mul_f32 v21, v20, v13
    v_fma_f32 v22, -v21, v12, v20
    v_fma_f32 v21, v22, v13, v21

    v_cvt_pk_bf16_f32 v21, v21, v21
    v_lshlrev_b32 v21, 16, v21
    v_add_f32 v22, 1.0, v154
    v_cvt_pk_bf16_f32 v22, v22, v22
    v_lshlrev_b32 v22, 16, v22
    v_mul_f32 v21, v21, v22
    v_cvt_pk_bf16_f32 v21, v21, v21
    v_lshlrev_b32 v21, 16, v21
    v_add_f32 v26, v21, v82
    v_and_b32 v20, s62, v41
    v_sub_f32 v20, v20, v8
    v_cvt_pk_bf16_f32 v20, v20, v20
    v_lshlrev_b32 v20, 16, v20
    v_mul_f32 v21, v20, v13
    v_fma_f32 v22, -v21, v12, v20
    v_fma_f32 v21, v22, v13, v21

    v_cvt_pk_bf16_f32 v21, v21, v21
    v_lshlrev_b32 v21, 16, v21
    v_add_f32 v22, 1.0, v155
    v_cvt_pk_bf16_f32 v22, v22, v22
    v_lshlrev_b32 v22, 16, v22
    v_mul_f32 v21, v21, v22
    v_cvt_pk_bf16_f32 v21, v21, v21
    v_lshlrev_b32 v21, 16, v21
    v_add_f32 v27, v21, v83
    v_lshlrev_b32 v20, 16, v42
    v_sub_f32 v20, v20, v8
    v_cvt_pk_bf16_f32 v20, v20, v20
    v_lshlrev_b32 v20, 16, v20
    v_mul_f32 v21, v20, v13
    v_fma_f32 v22, -v21, v12, v20
    v_fma_f32 v21, v22, v13, v21

    v_cvt_pk_bf16_f32 v21, v21, v21
    v_lshlrev_b32 v21, 16, v21
    v_add_f32 v22, 1.0, v156
    v_cvt_pk_bf16_f32 v22, v22, v22
    v_lshlrev_b32 v22, 16, v22
    v_mul_f32 v21, v21, v22
    v_cvt_pk_bf16_f32 v21, v21, v21
    v_lshlrev_b32 v21, 16, v21
    v_add_f32 v28, v21, v84
    v_and_b32 v20, s62, v42
    v_sub_f32 v20, v20, v8
    v_cvt_pk_bf16_f32 v20, v20, v20
    v_lshlrev_b32 v20, 16, v20
    v_mul_f32 v21, v20, v13
    v_fma_f32 v22, -v21, v12, v20
    v_fma_f32 v21, v22, v13, v21

    v_cvt_pk_bf16_f32 v21, v21, v21
    v_lshlrev_b32 v21, 16, v21
    v_add_f32 v22, 1.0, v157
    v_cvt_pk_bf16_f32 v22, v22, v22
    v_lshlrev_b32 v22, 16, v22
    v_mul_f32 v21, v21, v22
    v_cvt_pk_bf16_f32 v21, v21, v21
    v_lshlrev_b32 v21, 16, v21
    v_add_f32 v29, v21, v85
    v_lshlrev_b32 v20, 16, v43
    v_sub_f32 v20, v20, v8
    v_cvt_pk_bf16_f32 v20, v20, v20
    v_lshlrev_b32 v20, 16, v20
    v_mul_f32 v21, v20, v13
    v_fma_f32 v22, -v21, v12, v20
    v_fma_f32 v21, v22, v13, v21

    v_cvt_pk_bf16_f32 v21, v21, v21
    v_lshlrev_b32 v21, 16, v21
    v_add_f32 v22, 1.0, v158
    v_cvt_pk_bf16_f32 v22, v22, v22
    v_lshlrev_b32 v22, 16, v22
    v_mul_f32 v21, v21, v22
    v_cvt_pk_bf16_f32 v21, v21, v21
    v_lshlrev_b32 v21, 16, v21
    v_add_f32 v30, v21, v86
    v_and_b32 v20, s62, v43
    v_sub_f32 v20, v20, v8
    v_cvt_pk_bf16_f32 v20, v20, v20
    v_lshlrev_b32 v20, 16, v20
    v_mul_f32 v21, v20, v13
    v_fma_f32 v22, -v21, v12, v20
    v_fma_f32 v21, v22, v13, v21

    v_cvt_pk_bf16_f32 v21, v21, v21
    v_lshlrev_b32 v21, 16, v21
    v_add_f32 v22, 1.0, v159
    v_cvt_pk_bf16_f32 v22, v22, v22
    v_lshlrev_b32 v22, 16, v22
    v_mul_f32 v21, v21, v22
    v_cvt_pk_bf16_f32 v21, v21, v21
    v_lshlrev_b32 v21, 16, v21
    v_add_f32 v31, v21, v87
    v_cvt_pk_bf16_f32 v32, v24, v25
    v_cvt_pk_bf16_f32 v33, v26, v27
    v_cvt_pk_bf16_f32 v34, v28, v29
    v_cvt_pk_bf16_f32 v35, v30, v31
    v_lshl_add_u32 v23, v19, 4, v18
    v_add_u32 v23, 0, v23
    buffer_store_dwordx4 v[32:35], v23, s[16:19], 0 offen
    v_add_u32 v23, 0, v15
    buffer_store_dwordx4 v[40:43], v23, s[20:23], 0 offen

    v_lshlrev_b32 v20, 16, v44
    v_sub_f32 v20, v20, v8
    v_cvt_pk_bf16_f32 v20, v20, v20
    v_lshlrev_b32 v20, 16, v20
    v_mul_f32 v21, v20, v13
    v_fma_f32 v22, -v21, v12, v20
    v_fma_f32 v21, v22, v13, v21

    v_cvt_pk_bf16_f32 v21, v21, v21
    v_lshlrev_b32 v21, 16, v21
    v_add_f32 v22, 1.0, v160
    v_cvt_pk_bf16_f32 v22, v22, v22
    v_lshlrev_b32 v22, 16, v22
    v_mul_f32 v21, v21, v22
    v_cvt_pk_bf16_f32 v21, v21, v21
    v_lshlrev_b32 v21, 16, v21
    v_add_f32 v24, v21, v88
    v_and_b32 v20, s62, v44
    v_sub_f32 v20, v20, v8
    v_cvt_pk_bf16_f32 v20, v20, v20
    v_lshlrev_b32 v20, 16, v20
    v_mul_f32 v21, v20, v13
    v_fma_f32 v22, -v21, v12, v20
    v_fma_f32 v21, v22, v13, v21

    v_cvt_pk_bf16_f32 v21, v21, v21
    v_lshlrev_b32 v21, 16, v21
    v_add_f32 v22, 1.0, v161
    v_cvt_pk_bf16_f32 v22, v22, v22
    v_lshlrev_b32 v22, 16, v22
    v_mul_f32 v21, v21, v22
    v_cvt_pk_bf16_f32 v21, v21, v21
    v_lshlrev_b32 v21, 16, v21
    v_add_f32 v25, v21, v89
    v_lshlrev_b32 v20, 16, v45
    v_sub_f32 v20, v20, v8
    v_cvt_pk_bf16_f32 v20, v20, v20
    v_lshlrev_b32 v20, 16, v20
    v_mul_f32 v21, v20, v13
    v_fma_f32 v22, -v21, v12, v20
    v_fma_f32 v21, v22, v13, v21

    v_cvt_pk_bf16_f32 v21, v21, v21
    v_lshlrev_b32 v21, 16, v21
    v_add_f32 v22, 1.0, v162
    v_cvt_pk_bf16_f32 v22, v22, v22
    v_lshlrev_b32 v22, 16, v22
    v_mul_f32 v21, v21, v22
    v_cvt_pk_bf16_f32 v21, v21, v21
    v_lshlrev_b32 v21, 16, v21
    v_add_f32 v26, v21, v90
    v_and_b32 v20, s62, v45
    v_sub_f32 v20, v20, v8
    v_cvt_pk_bf16_f32 v20, v20, v20
    v_lshlrev_b32 v20, 16, v20
    v_mul_f32 v21, v20, v13
    v_fma_f32 v22, -v21, v12, v20
    v_fma_f32 v21, v22, v13, v21

    v_cvt_pk_bf16_f32 v21, v21, v21
    v_lshlrev_b32 v21, 16, v21
    v_add_f32 v22, 1.0, v163
    v_cvt_pk_bf16_f32 v22, v22, v22
    v_lshlrev_b32 v22, 16, v22
    v_mul_f32 v21, v21, v22
    v_cvt_pk_bf16_f32 v21, v21, v21
    v_lshlrev_b32 v21, 16, v21
    v_add_f32 v27, v21, v91
    v_lshlrev_b32 v20, 16, v46
    v_sub_f32 v20, v20, v8
    v_cvt_pk_bf16_f32 v20, v20, v20
    v_lshlrev_b32 v20, 16, v20
    v_mul_f32 v21, v20, v13
    v_fma_f32 v22, -v21, v12, v20
    v_fma_f32 v21, v22, v13, v21

    v_cvt_pk_bf16_f32 v21, v21, v21
    v_lshlrev_b32 v21, 16, v21
    v_add_f32 v22, 1.0, v164
    v_cvt_pk_bf16_f32 v22, v22, v22
    v_lshlrev_b32 v22, 16, v22
    v_mul_f32 v21, v21, v22
    v_cvt_pk_bf16_f32 v21, v21, v21
    v_lshlrev_b32 v21, 16, v21
    v_add_f32 v28, v21, v92
    v_and_b32 v20, s62, v46
    v_sub_f32 v20, v20, v8
    v_cvt_pk_bf16_f32 v20, v20, v20
    v_lshlrev_b32 v20, 16, v20
    v_mul_f32 v21, v20, v13
    v_fma_f32 v22, -v21, v12, v20
    v_fma_f32 v21, v22, v13, v21

    v_cvt_pk_bf16_f32 v21, v21, v21
    v_lshlrev_b32 v21, 16, v21
    v_add_f32 v22, 1.0, v165
    v_cvt_pk_bf16_f32 v22, v22, v22
    v_lshlrev_b32 v22, 16, v22
    v_mul_f32 v21, v21, v22
    v_cvt_pk_bf16_f32 v21, v21, v21
    v_lshlrev_b32 v21, 16, v21
    v_add_f32 v29, v21, v93
    v_lshlrev_b32 v20, 16, v47
    v_sub_f32 v20, v20, v8
    v_cvt_pk_bf16_f32 v20, v20, v20
    v_lshlrev_b32 v20, 16, v20
    v_mul_f32 v21, v20, v13
    v_fma_f32 v22, -v21, v12, v20
    v_fma_f32 v21, v22, v13, v21

    v_cvt_pk_bf16_f32 v21, v21, v21
    v_lshlrev_b32 v21, 16, v21
    v_add_f32 v22, 1.0, v166
    v_cvt_pk_bf16_f32 v22, v22, v22
    v_lshlrev_b32 v22, 16, v22
    v_mul_f32 v21, v21, v22
    v_cvt_pk_bf16_f32 v21, v21, v21
    v_lshlrev_b32 v21, 16, v21
    v_add_f32 v30, v21, v94
    v_and_b32 v20, s62, v47
    v_sub_f32 v20, v20, v8
    v_cvt_pk_bf16_f32 v20, v20, v20
    v_lshlrev_b32 v20, 16, v20
    v_mul_f32 v21, v20, v13
    v_fma_f32 v22, -v21, v12, v20
    v_fma_f32 v21, v22, v13, v21

    v_cvt_pk_bf16_f32 v21, v21, v21
    v_lshlrev_b32 v21, 16, v21
    v_add_f32 v22, 1.0, v167
    v_cvt_pk_bf16_f32 v22, v22, v22
    v_lshlrev_b32 v22, 16, v22
    v_mul_f32 v21, v21, v22
    v_cvt_pk_bf16_f32 v21, v21, v21
    v_lshlrev_b32 v21, 16, v21
    v_add_f32 v31, v21, v95
    v_cvt_pk_bf16_f32 v32, v24, v25
    v_cvt_pk_bf16_f32 v33, v26, v27
    v_cvt_pk_bf16_f32 v34, v28, v29
    v_cvt_pk_bf16_f32 v35, v30, v31
    v_lshl_add_u32 v23, v19, 4, v18
    v_add_u32 v23, 16384, v23
    buffer_store_dwordx4 v[32:35], v23, s[16:19], 0 offen
    v_add_u32 v23, 128, v15
    buffer_store_dwordx4 v[44:47], v23, s[20:23], 0 offen

    v_lshlrev_b32 v20, 16, v48
    v_sub_f32 v20, v20, v8
    v_cvt_pk_bf16_f32 v20, v20, v20
    v_lshlrev_b32 v20, 16, v20
    v_mul_f32 v21, v20, v13
    v_fma_f32 v22, -v21, v12, v20
    v_fma_f32 v21, v22, v13, v21

    v_cvt_pk_bf16_f32 v21, v21, v21
    v_lshlrev_b32 v21, 16, v21
    v_add_f32 v22, 1.0, v168
    v_cvt_pk_bf16_f32 v22, v22, v22
    v_lshlrev_b32 v22, 16, v22
    v_mul_f32 v21, v21, v22
    v_cvt_pk_bf16_f32 v21, v21, v21
    v_lshlrev_b32 v21, 16, v21
    v_add_f32 v24, v21, v96
    v_and_b32 v20, s62, v48
    v_sub_f32 v20, v20, v8
    v_cvt_pk_bf16_f32 v20, v20, v20
    v_lshlrev_b32 v20, 16, v20
    v_mul_f32 v21, v20, v13
    v_fma_f32 v22, -v21, v12, v20
    v_fma_f32 v21, v22, v13, v21

    v_cvt_pk_bf16_f32 v21, v21, v21
    v_lshlrev_b32 v21, 16, v21
    v_add_f32 v22, 1.0, v169
    v_cvt_pk_bf16_f32 v22, v22, v22
    v_lshlrev_b32 v22, 16, v22
    v_mul_f32 v21, v21, v22
    v_cvt_pk_bf16_f32 v21, v21, v21
    v_lshlrev_b32 v21, 16, v21
    v_add_f32 v25, v21, v97
    v_lshlrev_b32 v20, 16, v49
    v_sub_f32 v20, v20, v8
    v_cvt_pk_bf16_f32 v20, v20, v20
    v_lshlrev_b32 v20, 16, v20
    v_mul_f32 v21, v20, v13
    v_fma_f32 v22, -v21, v12, v20
    v_fma_f32 v21, v22, v13, v21

    v_cvt_pk_bf16_f32 v21, v21, v21
    v_lshlrev_b32 v21, 16, v21
    v_add_f32 v22, 1.0, v170
    v_cvt_pk_bf16_f32 v22, v22, v22
    v_lshlrev_b32 v22, 16, v22
    v_mul_f32 v21, v21, v22
    v_cvt_pk_bf16_f32 v21, v21, v21
    v_lshlrev_b32 v21, 16, v21
    v_add_f32 v26, v21, v98
    v_and_b32 v20, s62, v49
    v_sub_f32 v20, v20, v8
    v_cvt_pk_bf16_f32 v20, v20, v20
    v_lshlrev_b32 v20, 16, v20
    v_mul_f32 v21, v20, v13
    v_fma_f32 v22, -v21, v12, v20
    v_fma_f32 v21, v22, v13, v21

    v_cvt_pk_bf16_f32 v21, v21, v21
    v_lshlrev_b32 v21, 16, v21
    v_add_f32 v22, 1.0, v171
    v_cvt_pk_bf16_f32 v22, v22, v22
    v_lshlrev_b32 v22, 16, v22
    v_mul_f32 v21, v21, v22
    v_cvt_pk_bf16_f32 v21, v21, v21
    v_lshlrev_b32 v21, 16, v21
    v_add_f32 v27, v21, v99
    v_lshlrev_b32 v20, 16, v50
    v_sub_f32 v20, v20, v8
    v_cvt_pk_bf16_f32 v20, v20, v20
    v_lshlrev_b32 v20, 16, v20
    v_mul_f32 v21, v20, v13
    v_fma_f32 v22, -v21, v12, v20
    v_fma_f32 v21, v22, v13, v21

    v_cvt_pk_bf16_f32 v21, v21, v21
    v_lshlrev_b32 v21, 16, v21
    v_add_f32 v22, 1.0, v172
    v_cvt_pk_bf16_f32 v22, v22, v22
    v_lshlrev_b32 v22, 16, v22
    v_mul_f32 v21, v21, v22
    v_cvt_pk_bf16_f32 v21, v21, v21
    v_lshlrev_b32 v21, 16, v21
    v_add_f32 v28, v21, v100
    v_and_b32 v20, s62, v50
    v_sub_f32 v20, v20, v8
    v_cvt_pk_bf16_f32 v20, v20, v20
    v_lshlrev_b32 v20, 16, v20
    v_mul_f32 v21, v20, v13
    v_fma_f32 v22, -v21, v12, v20
    v_fma_f32 v21, v22, v13, v21

    v_cvt_pk_bf16_f32 v21, v21, v21
    v_lshlrev_b32 v21, 16, v21
    v_add_f32 v22, 1.0, v173
    v_cvt_pk_bf16_f32 v22, v22, v22
    v_lshlrev_b32 v22, 16, v22
    v_mul_f32 v21, v21, v22
    v_cvt_pk_bf16_f32 v21, v21, v21
    v_lshlrev_b32 v21, 16, v21
    v_add_f32 v29, v21, v101
    v_lshlrev_b32 v20, 16, v51
    v_sub_f32 v20, v20, v8
    v_cvt_pk_bf16_f32 v20, v20, v20
    v_lshlrev_b32 v20, 16, v20
    v_mul_f32 v21, v20, v13
    v_fma_f32 v22, -v21, v12, v20
    v_fma_f32 v21, v22, v13, v21

    v_cvt_pk_bf16_f32 v21, v21, v21
    v_lshlrev_b32 v21, 16, v21
    v_add_f32 v22, 1.0, v174
    v_cvt_pk_bf16_f32 v22, v22, v22
    v_lshlrev_b32 v22, 16, v22
    v_mul_f32 v21, v21, v22
    v_cvt_pk_bf16_f32 v21, v21, v21
    v_lshlrev_b32 v21, 16, v21
    v_add_f32 v30, v21, v102
    v_and_b32 v20, s62, v51
    v_sub_f32 v20, v20, v8
    v_cvt_pk_bf16_f32 v20, v20, v20
    v_lshlrev_b32 v20, 16, v20
    v_mul_f32 v21, v20, v13
    v_fma_f32 v22, -v21, v12, v20
    v_fma_f32 v21, v22, v13, v21

    v_cvt_pk_bf16_f32 v21, v21, v21
    v_lshlrev_b32 v21, 16, v21
    v_add_f32 v22, 1.0, v175
    v_cvt_pk_bf16_f32 v22, v22, v22
    v_lshlrev_b32 v22, 16, v22
    v_mul_f32 v21, v21, v22
    v_cvt_pk_bf16_f32 v21, v21, v21
    v_lshlrev_b32 v21, 16, v21
    v_add_f32 v31, v21, v103
    v_cvt_pk_bf16_f32 v32, v24, v25
    v_cvt_pk_bf16_f32 v33, v26, v27
    v_cvt_pk_bf16_f32 v34, v28, v29
    v_cvt_pk_bf16_f32 v35, v30, v31
    v_lshl_add_u32 v23, v19, 4, v18
    v_add_u32 v23, 32768, v23
    buffer_store_dwordx4 v[32:35], v23, s[16:19], 0 offen
    v_add_u32 v23, 256, v15
    buffer_store_dwordx4 v[48:51], v23, s[20:23], 0 offen

    v_lshlrev_b32 v20, 16, v52
    v_sub_f32 v20, v20, v8
    v_cvt_pk_bf16_f32 v20, v20, v20
    v_lshlrev_b32 v20, 16, v20
    v_mul_f32 v21, v20, v13
    v_fma_f32 v22, -v21, v12, v20
    v_fma_f32 v21, v22, v13, v21

    v_cvt_pk_bf16_f32 v21, v21, v21
    v_lshlrev_b32 v21, 16, v21
    v_add_f32 v22, 1.0, v176
    v_cvt_pk_bf16_f32 v22, v22, v22
    v_lshlrev_b32 v22, 16, v22
    v_mul_f32 v21, v21, v22
    v_cvt_pk_bf16_f32 v21, v21, v21
    v_lshlrev_b32 v21, 16, v21
    v_add_f32 v24, v21, v104
    v_and_b32 v20, s62, v52
    v_sub_f32 v20, v20, v8
    v_cvt_pk_bf16_f32 v20, v20, v20
    v_lshlrev_b32 v20, 16, v20
    v_mul_f32 v21, v20, v13
    v_fma_f32 v22, -v21, v12, v20
    v_fma_f32 v21, v22, v13, v21

    v_cvt_pk_bf16_f32 v21, v21, v21
    v_lshlrev_b32 v21, 16, v21
    v_add_f32 v22, 1.0, v177
    v_cvt_pk_bf16_f32 v22, v22, v22
    v_lshlrev_b32 v22, 16, v22
    v_mul_f32 v21, v21, v22
    v_cvt_pk_bf16_f32 v21, v21, v21
    v_lshlrev_b32 v21, 16, v21
    v_add_f32 v25, v21, v105
    v_lshlrev_b32 v20, 16, v53
    v_sub_f32 v20, v20, v8
    v_cvt_pk_bf16_f32 v20, v20, v20
    v_lshlrev_b32 v20, 16, v20
    v_mul_f32 v21, v20, v13
    v_fma_f32 v22, -v21, v12, v20
    v_fma_f32 v21, v22, v13, v21

    v_cvt_pk_bf16_f32 v21, v21, v21
    v_lshlrev_b32 v21, 16, v21
    v_add_f32 v22, 1.0, v178
    v_cvt_pk_bf16_f32 v22, v22, v22
    v_lshlrev_b32 v22, 16, v22
    v_mul_f32 v21, v21, v22
    v_cvt_pk_bf16_f32 v21, v21, v21
    v_lshlrev_b32 v21, 16, v21
    v_add_f32 v26, v21, v106
    v_and_b32 v20, s62, v53
    v_sub_f32 v20, v20, v8
    v_cvt_pk_bf16_f32 v20, v20, v20
    v_lshlrev_b32 v20, 16, v20
    v_mul_f32 v21, v20, v13
    v_fma_f32 v22, -v21, v12, v20
    v_fma_f32 v21, v22, v13, v21

    v_cvt_pk_bf16_f32 v21, v21, v21
    v_lshlrev_b32 v21, 16, v21
    v_add_f32 v22, 1.0, v179
    v_cvt_pk_bf16_f32 v22, v22, v22
    v_lshlrev_b32 v22, 16, v22
    v_mul_f32 v21, v21, v22
    v_cvt_pk_bf16_f32 v21, v21, v21
    v_lshlrev_b32 v21, 16, v21
    v_add_f32 v27, v21, v107
    v_lshlrev_b32 v20, 16, v54
    v_sub_f32 v20, v20, v8
    v_cvt_pk_bf16_f32 v20, v20, v20
    v_lshlrev_b32 v20, 16, v20
    v_mul_f32 v21, v20, v13
    v_fma_f32 v22, -v21, v12, v20
    v_fma_f32 v21, v22, v13, v21

    v_cvt_pk_bf16_f32 v21, v21, v21
    v_lshlrev_b32 v21, 16, v21
    v_add_f32 v22, 1.0, v180
    v_cvt_pk_bf16_f32 v22, v22, v22
    v_lshlrev_b32 v22, 16, v22
    v_mul_f32 v21, v21, v22
    v_cvt_pk_bf16_f32 v21, v21, v21
    v_lshlrev_b32 v21, 16, v21
    v_add_f32 v28, v21, v108
    v_and_b32 v20, s62, v54
    v_sub_f32 v20, v20, v8
    v_cvt_pk_bf16_f32 v20, v20, v20
    v_lshlrev_b32 v20, 16, v20
    v_mul_f32 v21, v20, v13
    v_fma_f32 v22, -v21, v12, v20
    v_fma_f32 v21, v22, v13, v21

    v_cvt_pk_bf16_f32 v21, v21, v21
    v_lshlrev_b32 v21, 16, v21
    v_add_f32 v22, 1.0, v181
    v_cvt_pk_bf16_f32 v22, v22, v22
    v_lshlrev_b32 v22, 16, v22
    v_mul_f32 v21, v21, v22
    v_cvt_pk_bf16_f32 v21, v21, v21
    v_lshlrev_b32 v21, 16, v21
    v_add_f32 v29, v21, v109
    v_lshlrev_b32 v20, 16, v55
    v_sub_f32 v20, v20, v8
    v_cvt_pk_bf16_f32 v20, v20, v20
    v_lshlrev_b32 v20, 16, v20
    v_mul_f32 v21, v20, v13
    v_fma_f32 v22, -v21, v12, v20
    v_fma_f32 v21, v22, v13, v21

    v_cvt_pk_bf16_f32 v21, v21, v21
    v_lshlrev_b32 v21, 16, v21
    v_add_f32 v22, 1.0, v182
    v_cvt_pk_bf16_f32 v22, v22, v22
    v_lshlrev_b32 v22, 16, v22
    v_mul_f32 v21, v21, v22
    v_cvt_pk_bf16_f32 v21, v21, v21
    v_lshlrev_b32 v21, 16, v21
    v_add_f32 v30, v21, v110
    v_and_b32 v20, s62, v55
    v_sub_f32 v20, v20, v8
    v_cvt_pk_bf16_f32 v20, v20, v20
    v_lshlrev_b32 v20, 16, v20
    v_mul_f32 v21, v20, v13
    v_fma_f32 v22, -v21, v12, v20
    v_fma_f32 v21, v22, v13, v21

    v_cvt_pk_bf16_f32 v21, v21, v21
    v_lshlrev_b32 v21, 16, v21
    v_add_f32 v22, 1.0, v183
    v_cvt_pk_bf16_f32 v22, v22, v22
    v_lshlrev_b32 v22, 16, v22
    v_mul_f32 v21, v21, v22
    v_cvt_pk_bf16_f32 v21, v21, v21
    v_lshlrev_b32 v21, 16, v21
    v_add_f32 v31, v21, v111
    v_cvt_pk_bf16_f32 v32, v24, v25
    v_cvt_pk_bf16_f32 v33, v26, v27
    v_cvt_pk_bf16_f32 v34, v28, v29
    v_cvt_pk_bf16_f32 v35, v30, v31
    v_lshl_add_u32 v23, v19, 4, v18
    v_add_u32 v23, 49152, v23
    buffer_store_dwordx4 v[32:35], v23, s[16:19], 0 offen
    v_add_u32 v23, 384, v15
    buffer_store_dwordx4 v[52:55], v23, s[20:23], 0 offen

    v_lshlrev_b32 v20, 16, v56
    v_sub_f32 v20, v20, v8
    v_cvt_pk_bf16_f32 v20, v20, v20
    v_lshlrev_b32 v20, 16, v20
    v_mul_f32 v21, v20, v13
    v_fma_f32 v22, -v21, v12, v20
    v_fma_f32 v21, v22, v13, v21

    v_cvt_pk_bf16_f32 v21, v21, v21
    v_lshlrev_b32 v21, 16, v21
    v_add_f32 v22, 1.0, v184
    v_cvt_pk_bf16_f32 v22, v22, v22
    v_lshlrev_b32 v22, 16, v22
    v_mul_f32 v21, v21, v22
    v_cvt_pk_bf16_f32 v21, v21, v21
    v_lshlrev_b32 v21, 16, v21
    v_add_f32 v24, v21, v112
    v_and_b32 v20, s62, v56
    v_sub_f32 v20, v20, v8
    v_cvt_pk_bf16_f32 v20, v20, v20
    v_lshlrev_b32 v20, 16, v20
    v_mul_f32 v21, v20, v13
    v_fma_f32 v22, -v21, v12, v20
    v_fma_f32 v21, v22, v13, v21

    v_cvt_pk_bf16_f32 v21, v21, v21
    v_lshlrev_b32 v21, 16, v21
    v_add_f32 v22, 1.0, v185
    v_cvt_pk_bf16_f32 v22, v22, v22
    v_lshlrev_b32 v22, 16, v22
    v_mul_f32 v21, v21, v22
    v_cvt_pk_bf16_f32 v21, v21, v21
    v_lshlrev_b32 v21, 16, v21
    v_add_f32 v25, v21, v113
    v_lshlrev_b32 v20, 16, v57
    v_sub_f32 v20, v20, v8
    v_cvt_pk_bf16_f32 v20, v20, v20
    v_lshlrev_b32 v20, 16, v20
    v_mul_f32 v21, v20, v13
    v_fma_f32 v22, -v21, v12, v20
    v_fma_f32 v21, v22, v13, v21

    v_cvt_pk_bf16_f32 v21, v21, v21
    v_lshlrev_b32 v21, 16, v21
    v_add_f32 v22, 1.0, v186
    v_cvt_pk_bf16_f32 v22, v22, v22
    v_lshlrev_b32 v22, 16, v22
    v_mul_f32 v21, v21, v22
    v_cvt_pk_bf16_f32 v21, v21, v21
    v_lshlrev_b32 v21, 16, v21
    v_add_f32 v26, v21, v114
    v_and_b32 v20, s62, v57
    v_sub_f32 v20, v20, v8
    v_cvt_pk_bf16_f32 v20, v20, v20
    v_lshlrev_b32 v20, 16, v20
    v_mul_f32 v21, v20, v13
    v_fma_f32 v22, -v21, v12, v20
    v_fma_f32 v21, v22, v13, v21

    v_cvt_pk_bf16_f32 v21, v21, v21
    v_lshlrev_b32 v21, 16, v21
    v_add_f32 v22, 1.0, v187
    v_cvt_pk_bf16_f32 v22, v22, v22
    v_lshlrev_b32 v22, 16, v22
    v_mul_f32 v21, v21, v22
    v_cvt_pk_bf16_f32 v21, v21, v21
    v_lshlrev_b32 v21, 16, v21
    v_add_f32 v27, v21, v115
    v_lshlrev_b32 v20, 16, v58
    v_sub_f32 v20, v20, v8
    v_cvt_pk_bf16_f32 v20, v20, v20
    v_lshlrev_b32 v20, 16, v20
    v_mul_f32 v21, v20, v13
    v_fma_f32 v22, -v21, v12, v20
    v_fma_f32 v21, v22, v13, v21

    v_cvt_pk_bf16_f32 v21, v21, v21
    v_lshlrev_b32 v21, 16, v21
    v_add_f32 v22, 1.0, v188
    v_cvt_pk_bf16_f32 v22, v22, v22
    v_lshlrev_b32 v22, 16, v22
    v_mul_f32 v21, v21, v22
    v_cvt_pk_bf16_f32 v21, v21, v21
    v_lshlrev_b32 v21, 16, v21
    v_add_f32 v28, v21, v116
    v_and_b32 v20, s62, v58
    v_sub_f32 v20, v20, v8
    v_cvt_pk_bf16_f32 v20, v20, v20
    v_lshlrev_b32 v20, 16, v20
    v_mul_f32 v21, v20, v13
    v_fma_f32 v22, -v21, v12, v20
    v_fma_f32 v21, v22, v13, v21

    v_cvt_pk_bf16_f32 v21, v21, v21
    v_lshlrev_b32 v21, 16, v21
    v_add_f32 v22, 1.0, v189
    v_cvt_pk_bf16_f32 v22, v22, v22
    v_lshlrev_b32 v22, 16, v22
    v_mul_f32 v21, v21, v22
    v_cvt_pk_bf16_f32 v21, v21, v21
    v_lshlrev_b32 v21, 16, v21
    v_add_f32 v29, v21, v117
    v_lshlrev_b32 v20, 16, v59
    v_sub_f32 v20, v20, v8
    v_cvt_pk_bf16_f32 v20, v20, v20
    v_lshlrev_b32 v20, 16, v20
    v_mul_f32 v21, v20, v13
    v_fma_f32 v22, -v21, v12, v20
    v_fma_f32 v21, v22, v13, v21

    v_cvt_pk_bf16_f32 v21, v21, v21
    v_lshlrev_b32 v21, 16, v21
    v_add_f32 v22, 1.0, v190
    v_cvt_pk_bf16_f32 v22, v22, v22
    v_lshlrev_b32 v22, 16, v22
    v_mul_f32 v21, v21, v22
    v_cvt_pk_bf16_f32 v21, v21, v21
    v_lshlrev_b32 v21, 16, v21
    v_add_f32 v30, v21, v118
    v_and_b32 v20, s62, v59
    v_sub_f32 v20, v20, v8
    v_cvt_pk_bf16_f32 v20, v20, v20
    v_lshlrev_b32 v20, 16, v20
    v_mul_f32 v21, v20, v13
    v_fma_f32 v22, -v21, v12, v20
    v_fma_f32 v21, v22, v13, v21

    v_cvt_pk_bf16_f32 v21, v21, v21
    v_lshlrev_b32 v21, 16, v21
    v_add_f32 v22, 1.0, v191
    v_cvt_pk_bf16_f32 v22, v22, v22
    v_lshlrev_b32 v22, 16, v22
    v_mul_f32 v21, v21, v22
    v_cvt_pk_bf16_f32 v21, v21, v21
    v_lshlrev_b32 v21, 16, v21
    v_add_f32 v31, v21, v119
    v_cvt_pk_bf16_f32 v32, v24, v25
    v_cvt_pk_bf16_f32 v33, v26, v27
    v_cvt_pk_bf16_f32 v34, v28, v29
    v_cvt_pk_bf16_f32 v35, v30, v31
    v_lshl_add_u32 v23, v19, 4, v18
    v_add_u32 v23, 65536, v23
    buffer_store_dwordx4 v[32:35], v23, s[16:19], 0 offen
    v_add_u32 v23, 512, v15
    buffer_store_dwordx4 v[56:59], v23, s[20:23], 0 offen

    v_lshlrev_b32 v20, 16, v60
    v_sub_f32 v20, v20, v8
    v_cvt_pk_bf16_f32 v20, v20, v20
    v_lshlrev_b32 v20, 16, v20
    v_mul_f32 v21, v20, v13
    v_fma_f32 v22, -v21, v12, v20
    v_fma_f32 v21, v22, v13, v21

    v_cvt_pk_bf16_f32 v21, v21, v21
    v_lshlrev_b32 v21, 16, v21
    v_add_f32 v22, 1.0, v192
    v_cvt_pk_bf16_f32 v22, v22, v22
    v_lshlrev_b32 v22, 16, v22
    v_mul_f32 v21, v21, v22
    v_cvt_pk_bf16_f32 v21, v21, v21
    v_lshlrev_b32 v21, 16, v21
    v_add_f32 v24, v21, v120
    v_and_b32 v20, s62, v60
    v_sub_f32 v20, v20, v8
    v_cvt_pk_bf16_f32 v20, v20, v20
    v_lshlrev_b32 v20, 16, v20
    v_mul_f32 v21, v20, v13
    v_fma_f32 v22, -v21, v12, v20
    v_fma_f32 v21, v22, v13, v21

    v_cvt_pk_bf16_f32 v21, v21, v21
    v_lshlrev_b32 v21, 16, v21
    v_add_f32 v22, 1.0, v193
    v_cvt_pk_bf16_f32 v22, v22, v22
    v_lshlrev_b32 v22, 16, v22
    v_mul_f32 v21, v21, v22
    v_cvt_pk_bf16_f32 v21, v21, v21
    v_lshlrev_b32 v21, 16, v21
    v_add_f32 v25, v21, v121
    v_lshlrev_b32 v20, 16, v61
    v_sub_f32 v20, v20, v8
    v_cvt_pk_bf16_f32 v20, v20, v20
    v_lshlrev_b32 v20, 16, v20
    v_mul_f32 v21, v20, v13
    v_fma_f32 v22, -v21, v12, v20
    v_fma_f32 v21, v22, v13, v21

    v_cvt_pk_bf16_f32 v21, v21, v21
    v_lshlrev_b32 v21, 16, v21
    v_add_f32 v22, 1.0, v194
    v_cvt_pk_bf16_f32 v22, v22, v22
    v_lshlrev_b32 v22, 16, v22
    v_mul_f32 v21, v21, v22
    v_cvt_pk_bf16_f32 v21, v21, v21
    v_lshlrev_b32 v21, 16, v21
    v_add_f32 v26, v21, v122
    v_and_b32 v20, s62, v61
    v_sub_f32 v20, v20, v8
    v_cvt_pk_bf16_f32 v20, v20, v20
    v_lshlrev_b32 v20, 16, v20
    v_mul_f32 v21, v20, v13
    v_fma_f32 v22, -v21, v12, v20
    v_fma_f32 v21, v22, v13, v21

    v_cvt_pk_bf16_f32 v21, v21, v21
    v_lshlrev_b32 v21, 16, v21
    v_add_f32 v22, 1.0, v195
    v_cvt_pk_bf16_f32 v22, v22, v22
    v_lshlrev_b32 v22, 16, v22
    v_mul_f32 v21, v21, v22
    v_cvt_pk_bf16_f32 v21, v21, v21
    v_lshlrev_b32 v21, 16, v21
    v_add_f32 v27, v21, v123
    v_lshlrev_b32 v20, 16, v62
    v_sub_f32 v20, v20, v8
    v_cvt_pk_bf16_f32 v20, v20, v20
    v_lshlrev_b32 v20, 16, v20
    v_mul_f32 v21, v20, v13
    v_fma_f32 v22, -v21, v12, v20
    v_fma_f32 v21, v22, v13, v21

    v_cvt_pk_bf16_f32 v21, v21, v21
    v_lshlrev_b32 v21, 16, v21
    v_add_f32 v22, 1.0, v196
    v_cvt_pk_bf16_f32 v22, v22, v22
    v_lshlrev_b32 v22, 16, v22
    v_mul_f32 v21, v21, v22
    v_cvt_pk_bf16_f32 v21, v21, v21
    v_lshlrev_b32 v21, 16, v21
    v_add_f32 v28, v21, v124
    v_and_b32 v20, s62, v62
    v_sub_f32 v20, v20, v8
    v_cvt_pk_bf16_f32 v20, v20, v20
    v_lshlrev_b32 v20, 16, v20
    v_mul_f32 v21, v20, v13
    v_fma_f32 v22, -v21, v12, v20
    v_fma_f32 v21, v22, v13, v21

    v_cvt_pk_bf16_f32 v21, v21, v21
    v_lshlrev_b32 v21, 16, v21
    v_add_f32 v22, 1.0, v197
    v_cvt_pk_bf16_f32 v22, v22, v22
    v_lshlrev_b32 v22, 16, v22
    v_mul_f32 v21, v21, v22
    v_cvt_pk_bf16_f32 v21, v21, v21
    v_lshlrev_b32 v21, 16, v21
    v_add_f32 v29, v21, v125
    v_lshlrev_b32 v20, 16, v63
    v_sub_f32 v20, v20, v8
    v_cvt_pk_bf16_f32 v20, v20, v20
    v_lshlrev_b32 v20, 16, v20
    v_mul_f32 v21, v20, v13
    v_fma_f32 v22, -v21, v12, v20
    v_fma_f32 v21, v22, v13, v21

    v_cvt_pk_bf16_f32 v21, v21, v21
    v_lshlrev_b32 v21, 16, v21
    v_add_f32 v22, 1.0, v198
    v_cvt_pk_bf16_f32 v22, v22, v22
    v_lshlrev_b32 v22, 16, v22
    v_mul_f32 v21, v21, v22
    v_cvt_pk_bf16_f32 v21, v21, v21
    v_lshlrev_b32 v21, 16, v21
    v_add_f32 v30, v21, v126
    v_and_b32 v20, s62, v63
    v_sub_f32 v20, v20, v8
    v_cvt_pk_bf16_f32 v20, v20, v20
    v_lshlrev_b32 v20, 16, v20
    v_mul_f32 v21, v20, v13
    v_fma_f32 v22, -v21, v12, v20
    v_fma_f32 v21, v22, v13, v21

    v_cvt_pk_bf16_f32 v21, v21, v21
    v_lshlrev_b32 v21, 16, v21
    v_add_f32 v22, 1.0, v199
    v_cvt_pk_bf16_f32 v22, v22, v22
    v_lshlrev_b32 v22, 16, v22
    v_mul_f32 v21, v21, v22
    v_cvt_pk_bf16_f32 v21, v21, v21
    v_lshlrev_b32 v21, 16, v21
    v_add_f32 v31, v21, v127
    v_cvt_pk_bf16_f32 v32, v24, v25
    v_cvt_pk_bf16_f32 v33, v26, v27
    v_cvt_pk_bf16_f32 v34, v28, v29
    v_cvt_pk_bf16_f32 v35, v30, v31
    v_lshl_add_u32 v23, v19, 4, v18
    v_add_u32 v23, 81920, v23
    buffer_store_dwordx4 v[32:35], v23, s[16:19], 0 offen
    v_add_u32 v23, 640, v15
    buffer_store_dwordx4 v[60:63], v23, s[20:23], 0 offen

    v_lshlrev_b32 v20, 16, v64
    v_sub_f32 v20, v20, v8
    v_cvt_pk_bf16_f32 v20, v20, v20
    v_lshlrev_b32 v20, 16, v20
    v_mul_f32 v21, v20, v13
    v_fma_f32 v22, -v21, v12, v20
    v_fma_f32 v21, v22, v13, v21

    v_cvt_pk_bf16_f32 v21, v21, v21
    v_lshlrev_b32 v21, 16, v21
    v_add_f32 v22, 1.0, v200
    v_cvt_pk_bf16_f32 v22, v22, v22
    v_lshlrev_b32 v22, 16, v22
    v_mul_f32 v21, v21, v22
    v_cvt_pk_bf16_f32 v21, v21, v21
    v_lshlrev_b32 v21, 16, v21
    v_add_f32 v24, v21, v128
    v_and_b32 v20, s62, v64
    v_sub_f32 v20, v20, v8
    v_cvt_pk_bf16_f32 v20, v20, v20
    v_lshlrev_b32 v20, 16, v20
    v_mul_f32 v21, v20, v13
    v_fma_f32 v22, -v21, v12, v20
    v_fma_f32 v21, v22, v13, v21

    v_cvt_pk_bf16_f32 v21, v21, v21
    v_lshlrev_b32 v21, 16, v21
    v_add_f32 v22, 1.0, v201
    v_cvt_pk_bf16_f32 v22, v22, v22
    v_lshlrev_b32 v22, 16, v22
    v_mul_f32 v21, v21, v22
    v_cvt_pk_bf16_f32 v21, v21, v21
    v_lshlrev_b32 v21, 16, v21
    v_add_f32 v25, v21, v129
    v_lshlrev_b32 v20, 16, v65
    v_sub_f32 v20, v20, v8
    v_cvt_pk_bf16_f32 v20, v20, v20
    v_lshlrev_b32 v20, 16, v20
    v_mul_f32 v21, v20, v13
    v_fma_f32 v22, -v21, v12, v20
    v_fma_f32 v21, v22, v13, v21

    v_cvt_pk_bf16_f32 v21, v21, v21
    v_lshlrev_b32 v21, 16, v21
    v_add_f32 v22, 1.0, v202
    v_cvt_pk_bf16_f32 v22, v22, v22
    v_lshlrev_b32 v22, 16, v22
    v_mul_f32 v21, v21, v22
    v_cvt_pk_bf16_f32 v21, v21, v21
    v_lshlrev_b32 v21, 16, v21
    v_add_f32 v26, v21, v130
    v_and_b32 v20, s62, v65
    v_sub_f32 v20, v20, v8
    v_cvt_pk_bf16_f32 v20, v20, v20
    v_lshlrev_b32 v20, 16, v20
    v_mul_f32 v21, v20, v13
    v_fma_f32 v22, -v21, v12, v20
    v_fma_f32 v21, v22, v13, v21

    v_cvt_pk_bf16_f32 v21, v21, v21
    v_lshlrev_b32 v21, 16, v21
    v_add_f32 v22, 1.0, v203
    v_cvt_pk_bf16_f32 v22, v22, v22
    v_lshlrev_b32 v22, 16, v22
    v_mul_f32 v21, v21, v22
    v_cvt_pk_bf16_f32 v21, v21, v21
    v_lshlrev_b32 v21, 16, v21
    v_add_f32 v27, v21, v131
    v_lshlrev_b32 v20, 16, v66
    v_sub_f32 v20, v20, v8
    v_cvt_pk_bf16_f32 v20, v20, v20
    v_lshlrev_b32 v20, 16, v20
    v_mul_f32 v21, v20, v13
    v_fma_f32 v22, -v21, v12, v20
    v_fma_f32 v21, v22, v13, v21

    v_cvt_pk_bf16_f32 v21, v21, v21
    v_lshlrev_b32 v21, 16, v21
    v_add_f32 v22, 1.0, v204
    v_cvt_pk_bf16_f32 v22, v22, v22
    v_lshlrev_b32 v22, 16, v22
    v_mul_f32 v21, v21, v22
    v_cvt_pk_bf16_f32 v21, v21, v21
    v_lshlrev_b32 v21, 16, v21
    v_add_f32 v28, v21, v132
    v_and_b32 v20, s62, v66
    v_sub_f32 v20, v20, v8
    v_cvt_pk_bf16_f32 v20, v20, v20
    v_lshlrev_b32 v20, 16, v20
    v_mul_f32 v21, v20, v13
    v_fma_f32 v22, -v21, v12, v20
    v_fma_f32 v21, v22, v13, v21

    v_cvt_pk_bf16_f32 v21, v21, v21
    v_lshlrev_b32 v21, 16, v21
    v_add_f32 v22, 1.0, v205
    v_cvt_pk_bf16_f32 v22, v22, v22
    v_lshlrev_b32 v22, 16, v22
    v_mul_f32 v21, v21, v22
    v_cvt_pk_bf16_f32 v21, v21, v21
    v_lshlrev_b32 v21, 16, v21
    v_add_f32 v29, v21, v133
    v_lshlrev_b32 v20, 16, v67
    v_sub_f32 v20, v20, v8
    v_cvt_pk_bf16_f32 v20, v20, v20
    v_lshlrev_b32 v20, 16, v20
    v_mul_f32 v21, v20, v13
    v_fma_f32 v22, -v21, v12, v20
    v_fma_f32 v21, v22, v13, v21

    v_cvt_pk_bf16_f32 v21, v21, v21
    v_lshlrev_b32 v21, 16, v21
    v_add_f32 v22, 1.0, v206
    v_cvt_pk_bf16_f32 v22, v22, v22
    v_lshlrev_b32 v22, 16, v22
    v_mul_f32 v21, v21, v22
    v_cvt_pk_bf16_f32 v21, v21, v21
    v_lshlrev_b32 v21, 16, v21
    v_add_f32 v30, v21, v134
    v_and_b32 v20, s62, v67
    v_sub_f32 v20, v20, v8
    v_cvt_pk_bf16_f32 v20, v20, v20
    v_lshlrev_b32 v20, 16, v20
    v_mul_f32 v21, v20, v13
    v_fma_f32 v22, -v21, v12, v20
    v_fma_f32 v21, v22, v13, v21

    v_cvt_pk_bf16_f32 v21, v21, v21
    v_lshlrev_b32 v21, 16, v21
    v_add_f32 v22, 1.0, v207
    v_cvt_pk_bf16_f32 v22, v22, v22
    v_lshlrev_b32 v22, 16, v22
    v_mul_f32 v21, v21, v22
    v_cvt_pk_bf16_f32 v21, v21, v21
    v_lshlrev_b32 v21, 16, v21
    v_add_f32 v31, v21, v135
    v_cvt_pk_bf16_f32 v32, v24, v25
    v_cvt_pk_bf16_f32 v33, v26, v27
    v_cvt_pk_bf16_f32 v34, v28, v29
    v_cvt_pk_bf16_f32 v35, v30, v31
    v_lshl_add_u32 v23, v19, 4, v18
    v_add_u32 v23, 98304, v23
    buffer_store_dwordx4 v[32:35], v23, s[16:19], 0 offen
    v_add_u32 v23, 768, v15
    buffer_store_dwordx4 v[64:67], v23, s[20:23], 0 offen

    v_lshlrev_b32 v20, 16, v68
    v_sub_f32 v20, v20, v8
    v_cvt_pk_bf16_f32 v20, v20, v20
    v_lshlrev_b32 v20, 16, v20
    v_mul_f32 v21, v20, v13
    v_fma_f32 v22, -v21, v12, v20
    v_fma_f32 v21, v22, v13, v21

    v_cvt_pk_bf16_f32 v21, v21, v21
    v_lshlrev_b32 v21, 16, v21
    v_add_f32 v22, 1.0, v208
    v_cvt_pk_bf16_f32 v22, v22, v22
    v_lshlrev_b32 v22, 16, v22
    v_mul_f32 v21, v21, v22
    v_cvt_pk_bf16_f32 v21, v21, v21
    v_lshlrev_b32 v21, 16, v21
    v_add_f32 v24, v21, v136
    v_and_b32 v20, s62, v68
    v_sub_f32 v20, v20, v8
    v_cvt_pk_bf16_f32 v20, v20, v20
    v_lshlrev_b32 v20, 16, v20
    v_mul_f32 v21, v20, v13
    v_fma_f32 v22, -v21, v12, v20
    v_fma_f32 v21, v22, v13, v21

    v_cvt_pk_bf16_f32 v21, v21, v21
    v_lshlrev_b32 v21, 16, v21
    v_add_f32 v22, 1.0, v209
    v_cvt_pk_bf16_f32 v22, v22, v22
    v_lshlrev_b32 v22, 16, v22
    v_mul_f32 v21, v21, v22
    v_cvt_pk_bf16_f32 v21, v21, v21
    v_lshlrev_b32 v21, 16, v21
    v_add_f32 v25, v21, v137
    v_lshlrev_b32 v20, 16, v69
    v_sub_f32 v20, v20, v8
    v_cvt_pk_bf16_f32 v20, v20, v20
    v_lshlrev_b32 v20, 16, v20
    v_mul_f32 v21, v20, v13
    v_fma_f32 v22, -v21, v12, v20
    v_fma_f32 v21, v22, v13, v21

    v_cvt_pk_bf16_f32 v21, v21, v21
    v_lshlrev_b32 v21, 16, v21
    v_add_f32 v22, 1.0, v210
    v_cvt_pk_bf16_f32 v22, v22, v22
    v_lshlrev_b32 v22, 16, v22
    v_mul_f32 v21, v21, v22
    v_cvt_pk_bf16_f32 v21, v21, v21
    v_lshlrev_b32 v21, 16, v21
    v_add_f32 v26, v21, v138
    v_and_b32 v20, s62, v69
    v_sub_f32 v20, v20, v8
    v_cvt_pk_bf16_f32 v20, v20, v20
    v_lshlrev_b32 v20, 16, v20
    v_mul_f32 v21, v20, v13
    v_fma_f32 v22, -v21, v12, v20
    v_fma_f32 v21, v22, v13, v21

    v_cvt_pk_bf16_f32 v21, v21, v21
    v_lshlrev_b32 v21, 16, v21
    v_add_f32 v22, 1.0, v211
    v_cvt_pk_bf16_f32 v22, v22, v22
    v_lshlrev_b32 v22, 16, v22
    v_mul_f32 v21, v21, v22
    v_cvt_pk_bf16_f32 v21, v21, v21
    v_lshlrev_b32 v21, 16, v21
    v_add_f32 v27, v21, v139
    v_lshlrev_b32 v20, 16, v70
    v_sub_f32 v20, v20, v8
    v_cvt_pk_bf16_f32 v20, v20, v20
    v_lshlrev_b32 v20, 16, v20
    v_mul_f32 v21, v20, v13
    v_fma_f32 v22, -v21, v12, v20
    v_fma_f32 v21, v22, v13, v21

    v_cvt_pk_bf16_f32 v21, v21, v21
    v_lshlrev_b32 v21, 16, v21
    v_add_f32 v22, 1.0, v212
    v_cvt_pk_bf16_f32 v22, v22, v22
    v_lshlrev_b32 v22, 16, v22
    v_mul_f32 v21, v21, v22
    v_cvt_pk_bf16_f32 v21, v21, v21
    v_lshlrev_b32 v21, 16, v21
    v_add_f32 v28, v21, v140
    v_and_b32 v20, s62, v70
    v_sub_f32 v20, v20, v8
    v_cvt_pk_bf16_f32 v20, v20, v20
    v_lshlrev_b32 v20, 16, v20
    v_mul_f32 v21, v20, v13
    v_fma_f32 v22, -v21, v12, v20
    v_fma_f32 v21, v22, v13, v21

    v_cvt_pk_bf16_f32 v21, v21, v21
    v_lshlrev_b32 v21, 16, v21
    v_add_f32 v22, 1.0, v213
    v_cvt_pk_bf16_f32 v22, v22, v22
    v_lshlrev_b32 v22, 16, v22
    v_mul_f32 v21, v21, v22
    v_cvt_pk_bf16_f32 v21, v21, v21
    v_lshlrev_b32 v21, 16, v21
    v_add_f32 v29, v21, v141
    v_lshlrev_b32 v20, 16, v71
    v_sub_f32 v20, v20, v8
    v_cvt_pk_bf16_f32 v20, v20, v20
    v_lshlrev_b32 v20, 16, v20
    v_mul_f32 v21, v20, v13
    v_fma_f32 v22, -v21, v12, v20
    v_fma_f32 v21, v22, v13, v21

    v_cvt_pk_bf16_f32 v21, v21, v21
    v_lshlrev_b32 v21, 16, v21
    v_add_f32 v22, 1.0, v214
    v_cvt_pk_bf16_f32 v22, v22, v22
    v_lshlrev_b32 v22, 16, v22
    v_mul_f32 v21, v21, v22
    v_cvt_pk_bf16_f32 v21, v21, v21
    v_lshlrev_b32 v21, 16, v21
    v_add_f32 v30, v21, v142
    v_and_b32 v20, s62, v71
    v_sub_f32 v20, v20, v8
    v_cvt_pk_bf16_f32 v20, v20, v20
    v_lshlrev_b32 v20, 16, v20
    v_mul_f32 v21, v20, v13
    v_fma_f32 v22, -v21, v12, v20
    v_fma_f32 v21, v22, v13, v21

    v_cvt_pk_bf16_f32 v21, v21, v21
    v_lshlrev_b32 v21, 16, v21
    v_add_f32 v22, 1.0, v215
    v_cvt_pk_bf16_f32 v22, v22, v22
    v_lshlrev_b32 v22, 16, v22
    v_mul_f32 v21, v21, v22
    v_cvt_pk_bf16_f32 v21, v21, v21
    v_lshlrev_b32 v21, 16, v21
    v_add_f32 v31, v21, v143
    v_cvt_pk_bf16_f32 v32, v24, v25
    v_cvt_pk_bf16_f32 v33, v26, v27
    v_cvt_pk_bf16_f32 v34, v28, v29
    v_cvt_pk_bf16_f32 v35, v30, v31
    v_lshl_add_u32 v23, v19, 4, v18
    v_add_u32 v23, 114688, v23
    buffer_store_dwordx4 v[32:35], v23, s[16:19], 0 offen
    v_add_u32 v23, 896, v15
    buffer_store_dwordx4 v[68:71], v23, s[20:23], 0 offen

    v_lshlrev_b32 v20, 16, v72
    v_sub_f32 v20, v20, v8
    v_cvt_pk_bf16_f32 v20, v20, v20
    v_lshlrev_b32 v20, 16, v20
    v_mul_f32 v21, v20, v13
    v_fma_f32 v22, -v21, v12, v20
    v_fma_f32 v21, v22, v13, v21

    v_cvt_pk_bf16_f32 v21, v21, v21
    v_lshlrev_b32 v21, 16, v21
    v_add_f32 v22, 1.0, v216
    v_cvt_pk_bf16_f32 v22, v22, v22
    v_lshlrev_b32 v22, 16, v22
    v_mul_f32 v21, v21, v22
    v_cvt_pk_bf16_f32 v21, v21, v21
    v_lshlrev_b32 v21, 16, v21
    v_add_f32 v24, v21, v144
    v_and_b32 v20, s62, v72
    v_sub_f32 v20, v20, v8
    v_cvt_pk_bf16_f32 v20, v20, v20
    v_lshlrev_b32 v20, 16, v20
    v_mul_f32 v21, v20, v13
    v_fma_f32 v22, -v21, v12, v20
    v_fma_f32 v21, v22, v13, v21

    v_cvt_pk_bf16_f32 v21, v21, v21
    v_lshlrev_b32 v21, 16, v21
    v_add_f32 v22, 1.0, v217
    v_cvt_pk_bf16_f32 v22, v22, v22
    v_lshlrev_b32 v22, 16, v22
    v_mul_f32 v21, v21, v22
    v_cvt_pk_bf16_f32 v21, v21, v21
    v_lshlrev_b32 v21, 16, v21
    v_add_f32 v25, v21, v145
    v_lshlrev_b32 v20, 16, v73
    v_sub_f32 v20, v20, v8
    v_cvt_pk_bf16_f32 v20, v20, v20
    v_lshlrev_b32 v20, 16, v20
    v_mul_f32 v21, v20, v13
    v_fma_f32 v22, -v21, v12, v20
    v_fma_f32 v21, v22, v13, v21

    v_cvt_pk_bf16_f32 v21, v21, v21
    v_lshlrev_b32 v21, 16, v21
    v_add_f32 v22, 1.0, v218
    v_cvt_pk_bf16_f32 v22, v22, v22
    v_lshlrev_b32 v22, 16, v22
    v_mul_f32 v21, v21, v22
    v_cvt_pk_bf16_f32 v21, v21, v21
    v_lshlrev_b32 v21, 16, v21
    v_add_f32 v26, v21, v146
    v_and_b32 v20, s62, v73
    v_sub_f32 v20, v20, v8
    v_cvt_pk_bf16_f32 v20, v20, v20
    v_lshlrev_b32 v20, 16, v20
    v_mul_f32 v21, v20, v13
    v_fma_f32 v22, -v21, v12, v20
    v_fma_f32 v21, v22, v13, v21

    v_cvt_pk_bf16_f32 v21, v21, v21
    v_lshlrev_b32 v21, 16, v21
    v_add_f32 v22, 1.0, v219
    v_cvt_pk_bf16_f32 v22, v22, v22
    v_lshlrev_b32 v22, 16, v22
    v_mul_f32 v21, v21, v22
    v_cvt_pk_bf16_f32 v21, v21, v21
    v_lshlrev_b32 v21, 16, v21
    v_add_f32 v27, v21, v147
    v_lshlrev_b32 v20, 16, v74
    v_sub_f32 v20, v20, v8
    v_cvt_pk_bf16_f32 v20, v20, v20
    v_lshlrev_b32 v20, 16, v20
    v_mul_f32 v21, v20, v13
    v_fma_f32 v22, -v21, v12, v20
    v_fma_f32 v21, v22, v13, v21

    v_cvt_pk_bf16_f32 v21, v21, v21
    v_lshlrev_b32 v21, 16, v21
    v_add_f32 v22, 1.0, v220
    v_cvt_pk_bf16_f32 v22, v22, v22
    v_lshlrev_b32 v22, 16, v22
    v_mul_f32 v21, v21, v22
    v_cvt_pk_bf16_f32 v21, v21, v21
    v_lshlrev_b32 v21, 16, v21
    v_add_f32 v28, v21, v148
    v_and_b32 v20, s62, v74
    v_sub_f32 v20, v20, v8
    v_cvt_pk_bf16_f32 v20, v20, v20
    v_lshlrev_b32 v20, 16, v20
    v_mul_f32 v21, v20, v13
    v_fma_f32 v22, -v21, v12, v20
    v_fma_f32 v21, v22, v13, v21

    v_cvt_pk_bf16_f32 v21, v21, v21
    v_lshlrev_b32 v21, 16, v21
    v_add_f32 v22, 1.0, v221
    v_cvt_pk_bf16_f32 v22, v22, v22
    v_lshlrev_b32 v22, 16, v22
    v_mul_f32 v21, v21, v22
    v_cvt_pk_bf16_f32 v21, v21, v21
    v_lshlrev_b32 v21, 16, v21
    v_add_f32 v29, v21, v149
    v_lshlrev_b32 v20, 16, v75
    v_sub_f32 v20, v20, v8
    v_cvt_pk_bf16_f32 v20, v20, v20
    v_lshlrev_b32 v20, 16, v20
    v_mul_f32 v21, v20, v13
    v_fma_f32 v22, -v21, v12, v20
    v_fma_f32 v21, v22, v13, v21

    v_cvt_pk_bf16_f32 v21, v21, v21
    v_lshlrev_b32 v21, 16, v21
    v_add_f32 v22, 1.0, v222
    v_cvt_pk_bf16_f32 v22, v22, v22
    v_lshlrev_b32 v22, 16, v22
    v_mul_f32 v21, v21, v22
    v_cvt_pk_bf16_f32 v21, v21, v21
    v_lshlrev_b32 v21, 16, v21
    v_add_f32 v30, v21, v150
    v_and_b32 v20, s62, v75
    v_sub_f32 v20, v20, v8
    v_cvt_pk_bf16_f32 v20, v20, v20
    v_lshlrev_b32 v20, 16, v20
    v_mul_f32 v21, v20, v13
    v_fma_f32 v22, -v21, v12, v20
    v_fma_f32 v21, v22, v13, v21

    v_cvt_pk_bf16_f32 v21, v21, v21
    v_lshlrev_b32 v21, 16, v21
    v_add_f32 v22, 1.0, v223
    v_cvt_pk_bf16_f32 v22, v22, v22
    v_lshlrev_b32 v22, 16, v22
    v_mul_f32 v21, v21, v22
    v_cvt_pk_bf16_f32 v21, v21, v21
    v_lshlrev_b32 v21, 16, v21
    v_add_f32 v31, v21, v151
    v_cvt_pk_bf16_f32 v32, v24, v25
    v_cvt_pk_bf16_f32 v33, v26, v27
    v_cvt_pk_bf16_f32 v34, v28, v29
    v_cvt_pk_bf16_f32 v35, v30, v31
    v_lshl_add_u32 v23, v19, 4, v18
    v_add_u32 v23, 131072, v23
    buffer_store_dwordx4 v[32:35], v23, s[16:19], 0 offen
    v_add_u32 v23, 1024, v15
    buffer_store_dwordx4 v[72:75], v23, s[20:23], 0 offen

L_ln2_end:
    s_endpgm

.globl gemm1_kernel
.p2align 8
.type gemm1_kernel,@function
gemm1_kernel:
    s_cmp_ge_u32 s2, 256
    s_cbranch_scc1 L_g1_end
    s_load_dwordx2 s[4:5], s[0:1], 128
    s_waitcnt lgkmcnt(0)

    s_mov_b32 s8, s4
    s_mov_b32 s9, s5
    s_mov_b32 s10, 268435456
    s_mov_b32 s11, 0x00020000
    v_lshrrev_b32 v1, 6, v0
    s_nop 1
    v_readfirstlane_b32 s12, v1
    s_and_b32 s13, s2, 15
    s_lshr_b32 s14, s2, 4

    s_mul_i32 s15, s13, 147456
    s_add_u32 s15, s15, 22593536
    s_mul_i32 s16, s14, 331776
    s_add_u32 s16, s16, 7258112
    s_mul_i32 s19, s12, 13
    s_add_u32 s20, s19, 0
    s_lshl_b32 s21, s20, 10
    s_add_u32 s22, s15, s21
    s_sub_u32 s23, s21, 16384
    s_add_u32 s23, s16, s23
    s_cmp_lt_u32 s20, 16
    s_cselect_b32 s40, s22, s23
    s_mov_b32 s34, 16384
    s_cselect_b32 s56, s34, 36864
    s_cmp_lt_u32 s20, 52
    s_cselect_b32 s72, s21, 159744
    s_cselect_b32 s40, s40, s15
    s_cselect_b32 s56, s56, 0

    s_add_u32 s20, s19, 1
    s_lshl_b32 s21, s20, 10
    s_add_u32 s22, s15, s21
    s_sub_u32 s23, s21, 16384
    s_add_u32 s23, s16, s23
    s_cmp_lt_u32 s20, 16
    s_cselect_b32 s41, s22, s23
    s_mov_b32 s34, 16384
    s_cselect_b32 s57, s34, 36864
    s_cmp_lt_u32 s20, 52
    s_cselect_b32 s73, s21, 159744
    s_cselect_b32 s41, s41, s15
    s_cselect_b32 s57, s57, 0

    s_add_u32 s20, s19, 2
    s_lshl_b32 s21, s20, 10
    s_add_u32 s22, s15, s21
    s_sub_u32 s23, s21, 16384
    s_add_u32 s23, s16, s23
    s_cmp_lt_u32 s20, 16
    s_cselect_b32 s42, s22, s23
    s_mov_b32 s34, 16384
    s_cselect_b32 s58, s34, 36864
    s_cmp_lt_u32 s20, 52
    s_cselect_b32 s74, s21, 159744
    s_cselect_b32 s42, s42, s15
    s_cselect_b32 s58, s58, 0

    s_add_u32 s20, s19, 3
    s_lshl_b32 s21, s20, 10
    s_add_u32 s22, s15, s21
    s_sub_u32 s23, s21, 16384
    s_add_u32 s23, s16, s23
    s_cmp_lt_u32 s20, 16
    s_cselect_b32 s43, s22, s23
    s_mov_b32 s34, 16384
    s_cselect_b32 s59, s34, 36864
    s_cmp_lt_u32 s20, 52
    s_cselect_b32 s75, s21, 159744
    s_cselect_b32 s43, s43, s15
    s_cselect_b32 s59, s59, 0

    s_add_u32 s20, s19, 4
    s_lshl_b32 s21, s20, 10
    s_add_u32 s22, s15, s21
    s_sub_u32 s23, s21, 16384
    s_add_u32 s23, s16, s23
    s_cmp_lt_u32 s20, 16
    s_cselect_b32 s44, s22, s23
    s_mov_b32 s34, 16384
    s_cselect_b32 s60, s34, 36864
    s_cmp_lt_u32 s20, 52
    s_cselect_b32 s76, s21, 159744
    s_cselect_b32 s44, s44, s15
    s_cselect_b32 s60, s60, 0

    s_add_u32 s20, s19, 5
    s_lshl_b32 s21, s20, 10
    s_add_u32 s22, s15, s21
    s_sub_u32 s23, s21, 16384
    s_add_u32 s23, s16, s23
    s_cmp_lt_u32 s20, 16
    s_cselect_b32 s45, s22, s23
    s_mov_b32 s34, 16384
    s_cselect_b32 s61, s34, 36864
    s_cmp_lt_u32 s20, 52
    s_cselect_b32 s77, s21, 159744
    s_cselect_b32 s45, s45, s15
    s_cselect_b32 s61, s61, 0

    s_add_u32 s20, s19, 6
    s_lshl_b32 s21, s20, 10
    s_add_u32 s22, s15, s21
    s_sub_u32 s23, s21, 16384
    s_add_u32 s23, s16, s23
    s_cmp_lt_u32 s20, 16
    s_cselect_b32 s46, s22, s23
    s_mov_b32 s34, 16384
    s_cselect_b32 s62, s34, 36864
    s_cmp_lt_u32 s20, 52
    s_cselect_b32 s78, s21, 159744
    s_cselect_b32 s46, s46, s15
    s_cselect_b32 s62, s62, 0

    s_add_u32 s20, s19, 7
    s_lshl_b32 s21, s20, 10
    s_add_u32 s22, s15, s21
    s_sub_u32 s23, s21, 16384
    s_add_u32 s23, s16, s23
    s_cmp_lt_u32 s20, 16
    s_cselect_b32 s47, s22, s23
    s_mov_b32 s34, 16384
    s_cselect_b32 s63, s34, 36864
    s_cmp_lt_u32 s20, 52
    s_cselect_b32 s79, s21, 159744
    s_cselect_b32 s47, s47, s15
    s_cselect_b32 s63, s63, 0

    s_add_u32 s20, s19, 8
    s_lshl_b32 s21, s20, 10
    s_add_u32 s22, s15, s21
    s_sub_u32 s23, s21, 16384
    s_add_u32 s23, s16, s23
    s_cmp_lt_u32 s20, 16
    s_cselect_b32 s48, s22, s23
    s_mov_b32 s34, 16384
    s_cselect_b32 s64, s34, 36864
    s_cmp_lt_u32 s20, 52
    s_cselect_b32 s80, s21, 159744
    s_cselect_b32 s48, s48, s15
    s_cselect_b32 s64, s64, 0

    s_add_u32 s20, s19, 9
    s_lshl_b32 s21, s20, 10
    s_add_u32 s22, s15, s21
    s_sub_u32 s23, s21, 16384
    s_add_u32 s23, s16, s23
    s_cmp_lt_u32 s20, 16
    s_cselect_b32 s49, s22, s23
    s_mov_b32 s34, 16384
    s_cselect_b32 s65, s34, 36864
    s_cmp_lt_u32 s20, 52
    s_cselect_b32 s81, s21, 159744
    s_cselect_b32 s49, s49, s15
    s_cselect_b32 s65, s65, 0

    s_add_u32 s20, s19, 10
    s_lshl_b32 s21, s20, 10
    s_add_u32 s22, s15, s21
    s_sub_u32 s23, s21, 16384
    s_add_u32 s23, s16, s23
    s_cmp_lt_u32 s20, 16
    s_cselect_b32 s50, s22, s23
    s_mov_b32 s34, 16384
    s_cselect_b32 s66, s34, 36864
    s_cmp_lt_u32 s20, 52
    s_cselect_b32 s82, s21, 159744
    s_cselect_b32 s50, s50, s15
    s_cselect_b32 s66, s66, 0

    s_add_u32 s20, s19, 11
    s_lshl_b32 s21, s20, 10
    s_add_u32 s22, s15, s21
    s_sub_u32 s23, s21, 16384
    s_add_u32 s23, s16, s23
    s_cmp_lt_u32 s20, 16
    s_cselect_b32 s51, s22, s23
    s_mov_b32 s34, 16384
    s_cselect_b32 s67, s34, 36864
    s_cmp_lt_u32 s20, 52
    s_cselect_b32 s83, s21, 159744
    s_cselect_b32 s51, s51, s15
    s_cselect_b32 s67, s67, 0

    s_add_u32 s20, s19, 12
    s_lshl_b32 s21, s20, 10
    s_add_u32 s22, s15, s21
    s_sub_u32 s23, s21, 16384
    s_add_u32 s23, s16, s23
    s_cmp_lt_u32 s20, 16
    s_cselect_b32 s52, s22, s23
    s_mov_b32 s34, 16384
    s_cselect_b32 s68, s34, 36864
    s_cmp_lt_u32 s20, 52
    s_cselect_b32 s84, s21, 159744
    s_cselect_b32 s52, s52, s15
    s_cselect_b32 s68, s68, 0

    v_and_b32 v2, 63, v0
    v_lshlrev_b32 v2, 4, v2
    v_and_b32 v3, 15, v0
    v_bfe_u32 v4, v0, 4, 2
    v_lshrrev_b32 v5, 1, v3
    v_xor_b32 v6, v4, v5
    v_lshlrev_b32 v6, 4, v6
    v_lshl_add_u32 v6, v3, 7, v6

    s_and_b32 s24, s12, 1
    s_lshr_b32 s25, s12, 1
    s_mul_i32 s26, s24, 8192
    s_mul_i32 s27, s25, 18432
    s_add_u32 s27, s27, 16384
    v_xor_b32 v10, 0, v6
    v_add_u32 v10, 0, v10
    v_add_u32 v11, s27, v10
    v_add_u32 v10, s26, v10
    v_xor_b32 v12, 64, v6
    v_add_u32 v12, 0, v12
    v_add_u32 v13, s27, v12
    v_add_u32 v12, s26, v12
    v_xor_b32 v14, 0, v6
    v_add_u32 v14, 53248, v14
    v_add_u32 v15, s27, v14
    v_add_u32 v14, s26, v14
    v_xor_b32 v16, 64, v6
    v_add_u32 v16, 53248, v16
    v_add_u32 v17, s27, v16
    v_add_u32 v16, s26, v16
    v_xor_b32 v18, 0, v6
    v_add_u32 v18, 106496, v18
    v_add_u32 v19, s27, v18
    v_add_u32 v18, s26, v18
    v_xor_b32 v20, 64, v6
    v_add_u32 v20, 106496, v20
    v_add_u32 v21, s27, v20
    v_add_u32 v20, s26, v20
    v_accvgpr_write_b32 a0, 0
    v_accvgpr_write_b32 a1, 0
    v_accvgpr_write_b32 a2, 0
    v_accvgpr_write_b32 a3, 0
    v_accvgpr_write_b32 a4, 0
    v_accvgpr_write_b32 a5, 0
    v_accvgpr_write_b32 a6, 0
    v_accvgpr_write_b32 a7, 0
    v_accvgpr_write_b32 a8, 0
    v_accvgpr_write_b32 a9, 0
    v_accvgpr_write_b32 a10, 0
    v_accvgpr_write_b32 a11, 0
    v_accvgpr_write_b32 a12, 0
    v_accvgpr_write_b32 a13, 0
    v_accvgpr_write_b32 a14, 0
    v_accvgpr_write_b32 a15, 0
    v_accvgpr_write_b32 a16, 0
    v_accvgpr_write_b32 a17, 0
    v_accvgpr_write_b32 a18, 0
    v_accvgpr_write_b32 a19, 0
    v_accvgpr_write_b32 a20, 0
    v_accvgpr_write_b32 a21, 0
    v_accvgpr_write_b32 a22, 0
    v_accvgpr_write_b32 a23, 0
    v_accvgpr_write_b32 a24, 0
    v_accvgpr_write_b32 a25, 0
    v_accvgpr_write_b32 a26, 0
    v_accvgpr_write_b32 a27, 0
    v_accvgpr_write_b32 a28, 0
    v_accvgpr_write_b32 a29, 0
    v_accvgpr_write_b32 a30, 0
    v_accvgpr_write_b32 a31, 0
    v_accvgpr_write_b32 a32, 0
    v_accvgpr_write_b32 a33, 0
    v_accvgpr_write_b32 a34, 0
    v_accvgpr_write_b32 a35, 0
    v_accvgpr_write_b32 a36, 0
    v_accvgpr_write_b32 a37, 0
    v_accvgpr_write_b32 a38, 0
    v_accvgpr_write_b32 a39, 0
    v_accvgpr_write_b32 a40, 0
    v_accvgpr_write_b32 a41, 0
    v_accvgpr_write_b32 a42, 0
    v_accvgpr_write_b32 a43, 0
    v_accvgpr_write_b32 a44, 0
    v_accvgpr_write_b32 a45, 0
    v_accvgpr_write_b32 a46, 0
    v_accvgpr_write_b32 a47, 0
    v_accvgpr_write_b32 a48, 0
    v_accvgpr_write_b32 a49, 0
    v_accvgpr_write_b32 a50, 0
    v_accvgpr_write_b32 a51, 0
    v_accvgpr_write_b32 a52, 0
    v_accvgpr_write_b32 a53, 0
    v_accvgpr_write_b32 a54, 0
    v_accvgpr_write_b32 a55, 0
    v_accvgpr_write_b32 a56, 0
    v_accvgpr_write_b32 a57, 0
    v_accvgpr_write_b32 a58, 0
    v_accvgpr_write_b32 a59, 0
    v_accvgpr_write_b32 a60, 0
    v_accvgpr_write_b32 a61, 0
    v_accvgpr_write_b32 a62, 0
    v_accvgpr_write_b32 a63, 0
    v_accvgpr_write_b32 a64, 0
    v_accvgpr_write_b32 a65, 0
    v_accvgpr_write_b32 a66, 0
    v_accvgpr_write_b32 a67, 0
    v_accvgpr_write_b32 a68, 0
    v_accvgpr_write_b32 a69, 0
    v_accvgpr_write_b32 a70, 0
    v_accvgpr_write_b32 a71, 0
    v_accvgpr_write_b32 a72, 0
    v_accvgpr_write_b32 a73, 0
    v_accvgpr_write_b32 a74, 0
    v_accvgpr_write_b32 a75, 0
    v_accvgpr_write_b32 a76, 0
    v_accvgpr_write_b32 a77, 0
    v_accvgpr_write_b32 a78, 0
    v_accvgpr_write_b32 a79, 0
    v_accvgpr_write_b32 a80, 0
    v_accvgpr_write_b32 a81, 0
    v_accvgpr_write_b32 a82, 0
    v_accvgpr_write_b32 a83, 0
    v_accvgpr_write_b32 a84, 0
    v_accvgpr_write_b32 a85, 0
    v_accvgpr_write_b32 a86, 0
    v_accvgpr_write_b32 a87, 0
    v_accvgpr_write_b32 a88, 0
    v_accvgpr_write_b32 a89, 0
    v_accvgpr_write_b32 a90, 0
    v_accvgpr_write_b32 a91, 0
    v_accvgpr_write_b32 a92, 0
    v_accvgpr_write_b32 a93, 0
    v_accvgpr_write_b32 a94, 0
    v_accvgpr_write_b32 a95, 0
    v_accvgpr_write_b32 a96, 0
    v_accvgpr_write_b32 a97, 0
    v_accvgpr_write_b32 a98, 0
    v_accvgpr_write_b32 a99, 0
    v_accvgpr_write_b32 a100, 0
    v_accvgpr_write_b32 a101, 0
    v_accvgpr_write_b32 a102, 0
    v_accvgpr_write_b32 a103, 0
    v_accvgpr_write_b32 a104, 0
    v_accvgpr_write_b32 a105, 0
    v_accvgpr_write_b32 a106, 0
    v_accvgpr_write_b32 a107, 0
    v_accvgpr_write_b32 a108, 0
    v_accvgpr_write_b32 a109, 0
    v_accvgpr_write_b32 a110, 0
    v_accvgpr_write_b32 a111, 0
    v_accvgpr_write_b32 a112, 0
    v_accvgpr_write_b32 a113, 0
    v_accvgpr_write_b32 a114, 0
    v_accvgpr_write_b32 a115, 0
    v_accvgpr_write_b32 a116, 0
    v_accvgpr_write_b32 a117, 0
    v_accvgpr_write_b32 a118, 0
    v_accvgpr_write_b32 a119, 0
    v_accvgpr_write_b32 a120, 0
    v_accvgpr_write_b32 a121, 0
    v_accvgpr_write_b32 a122, 0
    v_accvgpr_write_b32 a123, 0
    v_accvgpr_write_b32 a124, 0
    v_accvgpr_write_b32 a125, 0
    v_accvgpr_write_b32 a126, 0
    v_accvgpr_write_b32 a127, 0
    v_accvgpr_write_b32 a128, 0
    v_accvgpr_write_b32 a129, 0
    v_accvgpr_write_b32 a130, 0
    v_accvgpr_write_b32 a131, 0
    v_accvgpr_write_b32 a132, 0
    v_accvgpr_write_b32 a133, 0
    v_accvgpr_write_b32 a134, 0
    v_accvgpr_write_b32 a135, 0
    v_accvgpr_write_b32 a136, 0
    v_accvgpr_write_b32 a137, 0
    v_accvgpr_write_b32 a138, 0
    v_accvgpr_write_b32 a139, 0
    v_accvgpr_write_b32 a140, 0
    v_accvgpr_write_b32 a141, 0
    v_accvgpr_write_b32 a142, 0
    v_accvgpr_write_b32 a143, 0
    s_add_u32 m0, s72, 0
    s_nop 0
    buffer_load_dwordx4 v2, s[8:11], s40 offen lds
    s_add_u32 s40, s40, s56

    s_add_u32 m0, s73, 0
    s_nop 0
    buffer_load_dwordx4 v2, s[8:11], s41 offen lds
    s_add_u32 s41, s41, s57

    s_add_u32 m0, s74, 0
    s_nop 0
    buffer_load_dwordx4 v2, s[8:11], s42 offen lds
    s_add_u32 s42, s42, s58

    s_add_u32 m0, s75, 0
    s_nop 0
    buffer_load_dwordx4 v2, s[8:11], s43 offen lds
    s_add_u32 s43, s43, s59

    s_add_u32 m0, s76, 0
    s_nop 0
    buffer_load_dwordx4 v2, s[8:11], s44 offen lds
    s_add_u32 s44, s44, s60

    s_add_u32 m0, s77, 0
    s_nop 0
    buffer_load_dwordx4 v2, s[8:11], s45 offen lds
    s_add_u32 s45, s45, s61

    s_add_u32 m0, s78, 0
    s_nop 0
    buffer_load_dwordx4 v2, s[8:11], s46 offen lds
    s_add_u32 s46, s46, s62

    s_add_u32 m0, s79, 0
    s_nop 0
    buffer_load_dwordx4 v2, s[8:11], s47 offen lds
    s_add_u32 s47, s47, s63

    s_add_u32 m0, s80, 0
    s_nop 0
    buffer_load_dwordx4 v2, s[8:11], s48 offen lds
    s_add_u32 s48, s48, s64

    s_add_u32 m0, s81, 0
    s_nop 0
    buffer_load_dwordx4 v2, s[8:11], s49 offen lds
    s_add_u32 s49, s49, s65

    s_add_u32 m0, s82, 0
    s_nop 0
    buffer_load_dwordx4 v2, s[8:11], s50 offen lds
    s_add_u32 s50, s50, s66

    s_add_u32 m0, s83, 0
    s_nop 0
    buffer_load_dwordx4 v2, s[8:11], s51 offen lds
    s_add_u32 s51, s51, s67

    s_add_u32 m0, s84, 0
    s_nop 0
    buffer_load_dwordx4 v2, s[8:11], s52 offen lds
    s_add_u32 s52, s52, s68

    s_add_u32 m0, s72, 53248
    s_nop 0
    buffer_load_dwordx4 v2, s[8:11], s40 offen lds
    s_add_u32 s40, s40, s56

    s_add_u32 m0, s73, 53248
    s_nop 0
    buffer_load_dwordx4 v2, s[8:11], s41 offen lds
    s_add_u32 s41, s41, s57

    s_add_u32 m0, s74, 53248
    s_nop 0
    buffer_load_dwordx4 v2, s[8:11], s42 offen lds
    s_add_u32 s42, s42, s58

    s_add_u32 m0, s75, 53248
    s_nop 0
    buffer_load_dwordx4 v2, s[8:11], s43 offen lds
    s_add_u32 s43, s43, s59

    s_add_u32 m0, s76, 53248
    s_nop 0
    buffer_load_dwordx4 v2, s[8:11], s44 offen lds
    s_add_u32 s44, s44, s60

    s_add_u32 m0, s77, 53248
    s_nop 0
    buffer_load_dwordx4 v2, s[8:11], s45 offen lds
    s_add_u32 s45, s45, s61

    s_add_u32 m0, s78, 53248
    s_nop 0
    buffer_load_dwordx4 v2, s[8:11], s46 offen lds
    s_add_u32 s46, s46, s62

    s_add_u32 m0, s79, 53248
    s_nop 0
    buffer_load_dwordx4 v2, s[8:11], s47 offen lds
    s_add_u32 s47, s47, s63

    s_add_u32 m0, s80, 53248
    s_nop 0
    buffer_load_dwordx4 v2, s[8:11], s48 offen lds
    s_add_u32 s48, s48, s64

    s_add_u32 m0, s81, 53248
    s_nop 0
    buffer_load_dwordx4 v2, s[8:11], s49 offen lds
    s_add_u32 s49, s49, s65

    s_add_u32 m0, s82, 53248
    s_nop 0
    buffer_load_dwordx4 v2, s[8:11], s50 offen lds
    s_add_u32 s50, s50, s66

    s_add_u32 m0, s83, 53248
    s_nop 0
    buffer_load_dwordx4 v2, s[8:11], s51 offen lds
    s_add_u32 s51, s51, s67

    s_add_u32 m0, s84, 53248
    s_nop 0
    buffer_load_dwordx4 v2, s[8:11], s52 offen lds
    s_add_u32 s52, s52, s68

    s_waitcnt vmcnt(13)
    s_barrier
    s_add_u32 m0, s72, 106496
    s_nop 0
    buffer_load_dwordx4 v2, s[8:11], s40 offen lds
    s_add_u32 s40, s40, s56

    s_add_u32 m0, s73, 106496
    s_nop 0
    buffer_load_dwordx4 v2, s[8:11], s41 offen lds
    s_add_u32 s41, s41, s57

    s_add_u32 m0, s74, 106496
    s_nop 0
    buffer_load_dwordx4 v2, s[8:11], s42 offen lds
    s_add_u32 s42, s42, s58

    s_add_u32 m0, s75, 106496
    s_nop 0
    buffer_load_dwordx4 v2, s[8:11], s43 offen lds
    s_add_u32 s43, s43, s59

    s_add_u32 m0, s76, 106496
    s_nop 0
    buffer_load_dwordx4 v2, s[8:11], s44 offen lds
    s_add_u32 s44, s44, s60

    s_add_u32 m0, s77, 106496
    s_nop 0
    buffer_load_dwordx4 v2, s[8:11], s45 offen lds
    s_add_u32 s45, s45, s61

    s_add_u32 m0, s78, 106496
    s_nop 0
    buffer_load_dwordx4 v2, s[8:11], s46 offen lds
    s_add_u32 s46, s46, s62

    s_add_u32 m0, s79, 106496
    s_nop 0
    buffer_load_dwordx4 v2, s[8:11], s47 offen lds
    s_add_u32 s47, s47, s63

    s_add_u32 m0, s80, 106496
    s_nop 0
    buffer_load_dwordx4 v2, s[8:11], s48 offen lds
    s_add_u32 s48, s48, s64

    s_add_u32 m0, s81, 106496
    s_nop 0
    buffer_load_dwordx4 v2, s[8:11], s49 offen lds
    s_add_u32 s49, s49, s65

    s_add_u32 m0, s82, 106496
    s_nop 0
    buffer_load_dwordx4 v2, s[8:11], s50 offen lds
    s_add_u32 s50, s50, s66

    s_add_u32 m0, s83, 106496
    s_nop 0
    buffer_load_dwordx4 v2, s[8:11], s51 offen lds
    s_add_u32 s51, s51, s67

    s_add_u32 m0, s84, 106496
    s_nop 0
    buffer_load_dwordx4 v2, s[8:11], s52 offen lds
    s_add_u32 s52, s52, s68

    ds_read_b128 v[104:107], v10 offset:0
    ds_read_b128 v[108:111], v10 offset:2048
    ds_read_b128 v[112:115], v10 offset:4096
    ds_read_b128 v[116:119], v10 offset:6144
    ds_read_b128 v[32:35], v11 offset:0
    ds_read_b128 v[36:39], v11 offset:2048
    ds_read_b128 v[40:43], v11 offset:4096
    ds_read_b128 v[44:47], v11 offset:6144
    ds_read_b128 v[48:51], v11 offset:8192
    ds_read_b128 v[52:55], v11 offset:10240
    ds_read_b128 v[56:59], v11 offset:12288
    ds_read_b128 v[60:63], v11 offset:14336
    ds_read_b128 v[64:67], v11 offset:16384
    ds_read_b128 v[120:123], v12 offset:0
    ds_read_b128 v[124:127], v12 offset:2048
    ds_read_b128 v[128:131], v12 offset:4096
    ds_read_b128 v[132:135], v12 offset:6144
    ds_read_b128 v[68:71], v13 offset:0
    ds_read_b128 v[72:75], v13 offset:2048
    ds_read_b128 v[76:79], v13 offset:4096
    ds_read_b128 v[80:83], v13 offset:6144
    ds_read_b128 v[84:87], v13 offset:8192
    ds_read_b128 v[88:91], v13 offset:10240
    ds_read_b128 v[92:95], v13 offset:12288
    ds_read_b128 v[96:99], v13 offset:14336
    ds_read_b128 v[100:103], v13 offset:16384
    s_waitcnt lgkmcnt(13)
    v_mfma_f32_16x16x32_bf16 a[0:3], v[32:35], v[104:107], a[0:3]
    v_mfma_f32_16x16x32_bf16 a[4:7], v[32:35], v[108:111], a[4:7]
    v_mfma_f32_16x16x32_bf16 a[8:11], v[32:35], v[112:115], a[8:11]
    v_mfma_f32_16x16x32_bf16 a[12:15], v[32:35], v[116:119], a[12:15]
    v_mfma_f32_16x16x32_bf16 a[16:19], v[36:39], v[104:107], a[16:19]
    v_mfma_f32_16x16x32_bf16 a[20:23], v[36:39], v[108:111], a[20:23]
    v_mfma_f32_16x16x32_bf16 a[24:27], v[36:39], v[112:115], a[24:27]
    v_mfma_f32_16x16x32_bf16 a[28:31], v[36:39], v[116:119], a[28:31]
    v_mfma_f32_16x16x32_bf16 a[32:35], v[40:43], v[104:107], a[32:35]
    v_mfma_f32_16x16x32_bf16 a[36:39], v[40:43], v[108:111], a[36:39]
    v_mfma_f32_16x16x32_bf16 a[40:43], v[40:43], v[112:115], a[40:43]
    v_mfma_f32_16x16x32_bf16 a[44:47], v[40:43], v[116:119], a[44:47]
    v_mfma_f32_16x16x32_bf16 a[48:51], v[44:47], v[104:107], a[48:51]
    v_mfma_f32_16x16x32_bf16 a[52:55], v[44:47], v[108:111], a[52:55]
    v_mfma_f32_16x16x32_bf16 a[56:59], v[44:47], v[112:115], a[56:59]
    v_mfma_f32_16x16x32_bf16 a[60:63], v[44:47], v[116:119], a[60:63]
    v_mfma_f32_16x16x32_bf16 a[64:67], v[48:51], v[104:107], a[64:67]
    v_mfma_f32_16x16x32_bf16 a[68:71], v[48:51], v[108:111], a[68:71]
    v_mfma_f32_16x16x32_bf16 a[72:75], v[48:51], v[112:115], a[72:75]
    v_mfma_f32_16x16x32_bf16 a[76:79], v[48:51], v[116:119], a[76:79]
    v_mfma_f32_16x16x32_bf16 a[80:83], v[52:55], v[104:107], a[80:83]
    v_mfma_f32_16x16x32_bf16 a[84:87], v[52:55], v[108:111], a[84:87]
    v_mfma_f32_16x16x32_bf16 a[88:91], v[52:55], v[112:115], a[88:91]
    v_mfma_f32_16x16x32_bf16 a[92:95], v[52:55], v[116:119], a[92:95]
    v_mfma_f32_16x16x32_bf16 a[96:99], v[56:59], v[104:107], a[96:99]
    v_mfma_f32_16x16x32_bf16 a[100:103], v[56:59], v[108:111], a[100:103]
    v_mfma_f32_16x16x32_bf16 a[104:107], v[56:59], v[112:115], a[104:107]
    v_mfma_f32_16x16x32_bf16 a[108:111], v[56:59], v[116:119], a[108:111]
    v_mfma_f32_16x16x32_bf16 a[112:115], v[60:63], v[104:107], a[112:115]
    v_mfma_f32_16x16x32_bf16 a[116:119], v[60:63], v[108:111], a[116:119]
    v_mfma_f32_16x16x32_bf16 a[120:123], v[60:63], v[112:115], a[120:123]
    v_mfma_f32_16x16x32_bf16 a[124:127], v[60:63], v[116:119], a[124:127]
    v_mfma_f32_16x16x32_bf16 a[128:131], v[64:67], v[104:107], a[128:131]
    v_mfma_f32_16x16x32_bf16 a[132:135], v[64:67], v[108:111], a[132:135]
    v_mfma_f32_16x16x32_bf16 a[136:139], v[64:67], v[112:115], a[136:139]
    v_mfma_f32_16x16x32_bf16 a[140:143], v[64:67], v[116:119], a[140:143]
    s_waitcnt lgkmcnt(0)
    v_mfma_f32_16x16x32_bf16 a[0:3], v[68:71], v[120:123], a[0:3]
    v_mfma_f32_16x16x32_bf16 a[4:7], v[68:71], v[124:127], a[4:7]
    v_mfma_f32_16x16x32_bf16 a[8:11], v[68:71], v[128:131], a[8:11]
    v_mfma_f32_16x16x32_bf16 a[12:15], v[68:71], v[132:135], a[12:15]
    v_mfma_f32_16x16x32_bf16 a[16:19], v[72:75], v[120:123], a[16:19]
    v_mfma_f32_16x16x32_bf16 a[20:23], v[72:75], v[124:127], a[20:23]
    v_mfma_f32_16x16x32_bf16 a[24:27], v[72:75], v[128:131], a[24:27]
    v_mfma_f32_16x16x32_bf16 a[28:31], v[72:75], v[132:135], a[28:31]
    v_mfma_f32_16x16x32_bf16 a[32:35], v[76:79], v[120:123], a[32:35]
    v_mfma_f32_16x16x32_bf16 a[36:39], v[76:79], v[124:127], a[36:39]
    v_mfma_f32_16x16x32_bf16 a[40:43], v[76:79], v[128:131], a[40:43]
    v_mfma_f32_16x16x32_bf16 a[44:47], v[76:79], v[132:135], a[44:47]
    v_mfma_f32_16x16x32_bf16 a[48:51], v[80:83], v[120:123], a[48:51]
    v_mfma_f32_16x16x32_bf16 a[52:55], v[80:83], v[124:127], a[52:55]
    v_mfma_f32_16x16x32_bf16 a[56:59], v[80:83], v[128:131], a[56:59]
    v_mfma_f32_16x16x32_bf16 a[60:63], v[80:83], v[132:135], a[60:63]
    v_mfma_f32_16x16x32_bf16 a[64:67], v[84:87], v[120:123], a[64:67]
    v_mfma_f32_16x16x32_bf16 a[68:71], v[84:87], v[124:127], a[68:71]
    v_mfma_f32_16x16x32_bf16 a[72:75], v[84:87], v[128:131], a[72:75]
    v_mfma_f32_16x16x32_bf16 a[76:79], v[84:87], v[132:135], a[76:79]
    v_mfma_f32_16x16x32_bf16 a[80:83], v[88:91], v[120:123], a[80:83]
    v_mfma_f32_16x16x32_bf16 a[84:87], v[88:91], v[124:127], a[84:87]
    v_mfma_f32_16x16x32_bf16 a[88:91], v[88:91], v[128:131], a[88:91]
    v_mfma_f32_16x16x32_bf16 a[92:95], v[88:91], v[132:135], a[92:95]
    v_mfma_f32_16x16x32_bf16 a[96:99], v[92:95], v[120:123], a[96:99]
    v_mfma_f32_16x16x32_bf16 a[100:103], v[92:95], v[124:127], a[100:103]
    v_mfma_f32_16x16x32_bf16 a[104:107], v[92:95], v[128:131], a[104:107]
    v_mfma_f32_16x16x32_bf16 a[108:111], v[92:95], v[132:135], a[108:111]
    v_mfma_f32_16x16x32_bf16 a[112:115], v[96:99], v[120:123], a[112:115]
    v_mfma_f32_16x16x32_bf16 a[116:119], v[96:99], v[124:127], a[116:119]
    v_mfma_f32_16x16x32_bf16 a[120:123], v[96:99], v[128:131], a[120:123]
    v_mfma_f32_16x16x32_bf16 a[124:127], v[96:99], v[132:135], a[124:127]
    v_mfma_f32_16x16x32_bf16 a[128:131], v[100:103], v[120:123], a[128:131]
    v_mfma_f32_16x16x32_bf16 a[132:135], v[100:103], v[124:127], a[132:135]
    v_mfma_f32_16x16x32_bf16 a[136:139], v[100:103], v[128:131], a[136:139]
    v_mfma_f32_16x16x32_bf16 a[140:143], v[100:103], v[132:135], a[140:143]
    s_waitcnt vmcnt(13)
    s_barrier
    s_add_u32 m0, s72, 0
    s_nop 0
    buffer_load_dwordx4 v2, s[8:11], s40 offen lds
    s_add_u32 s40, s40, s56

    s_add_u32 m0, s73, 0
    s_nop 0
    buffer_load_dwordx4 v2, s[8:11], s41 offen lds
    s_add_u32 s41, s41, s57

    s_add_u32 m0, s74, 0
    s_nop 0
    buffer_load_dwordx4 v2, s[8:11], s42 offen lds
    s_add_u32 s42, s42, s58

    s_add_u32 m0, s75, 0
    s_nop 0
    buffer_load_dwordx4 v2, s[8:11], s43 offen lds
    s_add_u32 s43, s43, s59

    s_add_u32 m0, s76, 0
    s_nop 0
    buffer_load_dwordx4 v2, s[8:11], s44 offen lds
    s_add_u32 s44, s44, s60

    s_add_u32 m0, s77, 0
    s_nop 0
    buffer_load_dwordx4 v2, s[8:11], s45 offen lds
    s_add_u32 s45, s45, s61

    s_add_u32 m0, s78, 0
    s_nop 0
    buffer_load_dwordx4 v2, s[8:11], s46 offen lds
    s_add_u32 s46, s46, s62

    s_add_u32 m0, s79, 0
    s_nop 0
    buffer_load_dwordx4 v2, s[8:11], s47 offen lds
    s_add_u32 s47, s47, s63

    s_add_u32 m0, s80, 0
    s_nop 0
    buffer_load_dwordx4 v2, s[8:11], s48 offen lds
    s_add_u32 s48, s48, s64

    s_add_u32 m0, s81, 0
    s_nop 0
    buffer_load_dwordx4 v2, s[8:11], s49 offen lds
    s_add_u32 s49, s49, s65

    s_add_u32 m0, s82, 0
    s_nop 0
    buffer_load_dwordx4 v2, s[8:11], s50 offen lds
    s_add_u32 s50, s50, s66

    s_add_u32 m0, s83, 0
    s_nop 0
    buffer_load_dwordx4 v2, s[8:11], s51 offen lds
    s_add_u32 s51, s51, s67

    s_add_u32 m0, s84, 0
    s_nop 0
    buffer_load_dwordx4 v2, s[8:11], s52 offen lds
    s_add_u32 s52, s52, s68

    ds_read_b128 v[104:107], v14 offset:0
    ds_read_b128 v[108:111], v14 offset:2048
    ds_read_b128 v[112:115], v14 offset:4096
    ds_read_b128 v[116:119], v14 offset:6144
    ds_read_b128 v[32:35], v15 offset:0
    ds_read_b128 v[36:39], v15 offset:2048
    ds_read_b128 v[40:43], v15 offset:4096
    ds_read_b128 v[44:47], v15 offset:6144
    ds_read_b128 v[48:51], v15 offset:8192
    ds_read_b128 v[52:55], v15 offset:10240
    ds_read_b128 v[56:59], v15 offset:12288
    ds_read_b128 v[60:63], v15 offset:14336
    ds_read_b128 v[64:67], v15 offset:16384
    ds_read_b128 v[120:123], v16 offset:0
    ds_read_b128 v[124:127], v16 offset:2048
    ds_read_b128 v[128:131], v16 offset:4096
    ds_read_b128 v[132:135], v16 offset:6144
    ds_read_b128 v[68:71], v17 offset:0
    ds_read_b128 v[72:75], v17 offset:2048
    ds_read_b128 v[76:79], v17 offset:4096
    ds_read_b128 v[80:83], v17 offset:6144
    ds_read_b128 v[84:87], v17 offset:8192
    ds_read_b128 v[88:91], v17 offset:10240
    ds_read_b128 v[92:95], v17 offset:12288
    ds_read_b128 v[96:99], v17 offset:14336
    ds_read_b128 v[100:103], v17 offset:16384
    s_waitcnt lgkmcnt(13)
    v_mfma_f32_16x16x32_bf16 a[0:3], v[32:35], v[104:107], a[0:3]
    v_mfma_f32_16x16x32_bf16 a[4:7], v[32:35], v[108:111], a[4:7]
    v_mfma_f32_16x16x32_bf16 a[8:11], v[32:35], v[112:115], a[8:11]
    v_mfma_f32_16x16x32_bf16 a[12:15], v[32:35], v[116:119], a[12:15]
    v_mfma_f32_16x16x32_bf16 a[16:19], v[36:39], v[104:107], a[16:19]
    v_mfma_f32_16x16x32_bf16 a[20:23], v[36:39], v[108:111], a[20:23]
    v_mfma_f32_16x16x32_bf16 a[24:27], v[36:39], v[112:115], a[24:27]
    v_mfma_f32_16x16x32_bf16 a[28:31], v[36:39], v[116:119], a[28:31]
    v_mfma_f32_16x16x32_bf16 a[32:35], v[40:43], v[104:107], a[32:35]
    v_mfma_f32_16x16x32_bf16 a[36:39], v[40:43], v[108:111], a[36:39]
    v_mfma_f32_16x16x32_bf16 a[40:43], v[40:43], v[112:115], a[40:43]
    v_mfma_f32_16x16x32_bf16 a[44:47], v[40:43], v[116:119], a[44:47]
    v_mfma_f32_16x16x32_bf16 a[48:51], v[44:47], v[104:107], a[48:51]
    v_mfma_f32_16x16x32_bf16 a[52:55], v[44:47], v[108:111], a[52:55]
    v_mfma_f32_16x16x32_bf16 a[56:59], v[44:47], v[112:115], a[56:59]
    v_mfma_f32_16x16x32_bf16 a[60:63], v[44:47], v[116:119], a[60:63]
    v_mfma_f32_16x16x32_bf16 a[64:67], v[48:51], v[104:107], a[64:67]
    v_mfma_f32_16x16x32_bf16 a[68:71], v[48:51], v[108:111], a[68:71]
    v_mfma_f32_16x16x32_bf16 a[72:75], v[48:51], v[112:115], a[72:75]
    v_mfma_f32_16x16x32_bf16 a[76:79], v[48:51], v[116:119], a[76:79]
    v_mfma_f32_16x16x32_bf16 a[80:83], v[52:55], v[104:107], a[80:83]
    v_mfma_f32_16x16x32_bf16 a[84:87], v[52:55], v[108:111], a[84:87]
    v_mfma_f32_16x16x32_bf16 a[88:91], v[52:55], v[112:115], a[88:91]
    v_mfma_f32_16x16x32_bf16 a[92:95], v[52:55], v[116:119], a[92:95]
    v_mfma_f32_16x16x32_bf16 a[96:99], v[56:59], v[104:107], a[96:99]
    v_mfma_f32_16x16x32_bf16 a[100:103], v[56:59], v[108:111], a[100:103]
    v_mfma_f32_16x16x32_bf16 a[104:107], v[56:59], v[112:115], a[104:107]
    v_mfma_f32_16x16x32_bf16 a[108:111], v[56:59], v[116:119], a[108:111]
    v_mfma_f32_16x16x32_bf16 a[112:115], v[60:63], v[104:107], a[112:115]
    v_mfma_f32_16x16x32_bf16 a[116:119], v[60:63], v[108:111], a[116:119]
    v_mfma_f32_16x16x32_bf16 a[120:123], v[60:63], v[112:115], a[120:123]
    v_mfma_f32_16x16x32_bf16 a[124:127], v[60:63], v[116:119], a[124:127]
    v_mfma_f32_16x16x32_bf16 a[128:131], v[64:67], v[104:107], a[128:131]
    v_mfma_f32_16x16x32_bf16 a[132:135], v[64:67], v[108:111], a[132:135]
    v_mfma_f32_16x16x32_bf16 a[136:139], v[64:67], v[112:115], a[136:139]
    v_mfma_f32_16x16x32_bf16 a[140:143], v[64:67], v[116:119], a[140:143]
    s_waitcnt lgkmcnt(0)
    v_mfma_f32_16x16x32_bf16 a[0:3], v[68:71], v[120:123], a[0:3]
    v_mfma_f32_16x16x32_bf16 a[4:7], v[68:71], v[124:127], a[4:7]
    v_mfma_f32_16x16x32_bf16 a[8:11], v[68:71], v[128:131], a[8:11]
    v_mfma_f32_16x16x32_bf16 a[12:15], v[68:71], v[132:135], a[12:15]
    v_mfma_f32_16x16x32_bf16 a[16:19], v[72:75], v[120:123], a[16:19]
    v_mfma_f32_16x16x32_bf16 a[20:23], v[72:75], v[124:127], a[20:23]
    v_mfma_f32_16x16x32_bf16 a[24:27], v[72:75], v[128:131], a[24:27]
    v_mfma_f32_16x16x32_bf16 a[28:31], v[72:75], v[132:135], a[28:31]
    v_mfma_f32_16x16x32_bf16 a[32:35], v[76:79], v[120:123], a[32:35]
    v_mfma_f32_16x16x32_bf16 a[36:39], v[76:79], v[124:127], a[36:39]
    v_mfma_f32_16x16x32_bf16 a[40:43], v[76:79], v[128:131], a[40:43]
    v_mfma_f32_16x16x32_bf16 a[44:47], v[76:79], v[132:135], a[44:47]
    v_mfma_f32_16x16x32_bf16 a[48:51], v[80:83], v[120:123], a[48:51]
    v_mfma_f32_16x16x32_bf16 a[52:55], v[80:83], v[124:127], a[52:55]
    v_mfma_f32_16x16x32_bf16 a[56:59], v[80:83], v[128:131], a[56:59]
    v_mfma_f32_16x16x32_bf16 a[60:63], v[80:83], v[132:135], a[60:63]
    v_mfma_f32_16x16x32_bf16 a[64:67], v[84:87], v[120:123], a[64:67]
    v_mfma_f32_16x16x32_bf16 a[68:71], v[84:87], v[124:127], a[68:71]
    v_mfma_f32_16x16x32_bf16 a[72:75], v[84:87], v[128:131], a[72:75]
    v_mfma_f32_16x16x32_bf16 a[76:79], v[84:87], v[132:135], a[76:79]
    v_mfma_f32_16x16x32_bf16 a[80:83], v[88:91], v[120:123], a[80:83]
    v_mfma_f32_16x16x32_bf16 a[84:87], v[88:91], v[124:127], a[84:87]
    v_mfma_f32_16x16x32_bf16 a[88:91], v[88:91], v[128:131], a[88:91]
    v_mfma_f32_16x16x32_bf16 a[92:95], v[88:91], v[132:135], a[92:95]
    v_mfma_f32_16x16x32_bf16 a[96:99], v[92:95], v[120:123], a[96:99]
    v_mfma_f32_16x16x32_bf16 a[100:103], v[92:95], v[124:127], a[100:103]
    v_mfma_f32_16x16x32_bf16 a[104:107], v[92:95], v[128:131], a[104:107]
    v_mfma_f32_16x16x32_bf16 a[108:111], v[92:95], v[132:135], a[108:111]
    v_mfma_f32_16x16x32_bf16 a[112:115], v[96:99], v[120:123], a[112:115]
    v_mfma_f32_16x16x32_bf16 a[116:119], v[96:99], v[124:127], a[116:119]
    v_mfma_f32_16x16x32_bf16 a[120:123], v[96:99], v[128:131], a[120:123]
    v_mfma_f32_16x16x32_bf16 a[124:127], v[96:99], v[132:135], a[124:127]
    v_mfma_f32_16x16x32_bf16 a[128:131], v[100:103], v[120:123], a[128:131]
    v_mfma_f32_16x16x32_bf16 a[132:135], v[100:103], v[124:127], a[132:135]
    v_mfma_f32_16x16x32_bf16 a[136:139], v[100:103], v[128:131], a[136:139]
    v_mfma_f32_16x16x32_bf16 a[140:143], v[100:103], v[132:135], a[140:143]
    s_waitcnt vmcnt(13)
    s_barrier
    s_add_u32 m0, s72, 53248
    s_nop 0
    buffer_load_dwordx4 v2, s[8:11], s40 offen lds
    s_add_u32 s40, s40, s56

    s_add_u32 m0, s73, 53248
    s_nop 0
    buffer_load_dwordx4 v2, s[8:11], s41 offen lds
    s_add_u32 s41, s41, s57

    s_add_u32 m0, s74, 53248
    s_nop 0
    buffer_load_dwordx4 v2, s[8:11], s42 offen lds
    s_add_u32 s42, s42, s58

    s_add_u32 m0, s75, 53248
    s_nop 0
    buffer_load_dwordx4 v2, s[8:11], s43 offen lds
    s_add_u32 s43, s43, s59

    s_add_u32 m0, s76, 53248
    s_nop 0
    buffer_load_dwordx4 v2, s[8:11], s44 offen lds
    s_add_u32 s44, s44, s60

    s_add_u32 m0, s77, 53248
    s_nop 0
    buffer_load_dwordx4 v2, s[8:11], s45 offen lds
    s_add_u32 s45, s45, s61

    s_add_u32 m0, s78, 53248
    s_nop 0
    buffer_load_dwordx4 v2, s[8:11], s46 offen lds
    s_add_u32 s46, s46, s62

    s_add_u32 m0, s79, 53248
    s_nop 0
    buffer_load_dwordx4 v2, s[8:11], s47 offen lds
    s_add_u32 s47, s47, s63

    s_add_u32 m0, s80, 53248
    s_nop 0
    buffer_load_dwordx4 v2, s[8:11], s48 offen lds
    s_add_u32 s48, s48, s64

    s_add_u32 m0, s81, 53248
    s_nop 0
    buffer_load_dwordx4 v2, s[8:11], s49 offen lds
    s_add_u32 s49, s49, s65

    s_add_u32 m0, s82, 53248
    s_nop 0
    buffer_load_dwordx4 v2, s[8:11], s50 offen lds
    s_add_u32 s50, s50, s66

    s_add_u32 m0, s83, 53248
    s_nop 0
    buffer_load_dwordx4 v2, s[8:11], s51 offen lds
    s_add_u32 s51, s51, s67

    s_add_u32 m0, s84, 53248
    s_nop 0
    buffer_load_dwordx4 v2, s[8:11], s52 offen lds
    s_add_u32 s52, s52, s68

    ds_read_b128 v[104:107], v18 offset:0
    ds_read_b128 v[108:111], v18 offset:2048
    ds_read_b128 v[112:115], v18 offset:4096
    ds_read_b128 v[116:119], v18 offset:6144
    ds_read_b128 v[32:35], v19 offset:0
    ds_read_b128 v[36:39], v19 offset:2048
    ds_read_b128 v[40:43], v19 offset:4096
    ds_read_b128 v[44:47], v19 offset:6144
    ds_read_b128 v[48:51], v19 offset:8192
    ds_read_b128 v[52:55], v19 offset:10240
    ds_read_b128 v[56:59], v19 offset:12288
    ds_read_b128 v[60:63], v19 offset:14336
    ds_read_b128 v[64:67], v19 offset:16384
    ds_read_b128 v[120:123], v20 offset:0
    ds_read_b128 v[124:127], v20 offset:2048
    ds_read_b128 v[128:131], v20 offset:4096
    ds_read_b128 v[132:135], v20 offset:6144
    ds_read_b128 v[68:71], v21 offset:0
    ds_read_b128 v[72:75], v21 offset:2048
    ds_read_b128 v[76:79], v21 offset:4096
    ds_read_b128 v[80:83], v21 offset:6144
    ds_read_b128 v[84:87], v21 offset:8192
    ds_read_b128 v[88:91], v21 offset:10240
    ds_read_b128 v[92:95], v21 offset:12288
    ds_read_b128 v[96:99], v21 offset:14336
    ds_read_b128 v[100:103], v21 offset:16384
    s_waitcnt lgkmcnt(13)
    v_mfma_f32_16x16x32_bf16 a[0:3], v[32:35], v[104:107], a[0:3]
    v_mfma_f32_16x16x32_bf16 a[4:7], v[32:35], v[108:111], a[4:7]
    v_mfma_f32_16x16x32_bf16 a[8:11], v[32:35], v[112:115], a[8:11]
    v_mfma_f32_16x16x32_bf16 a[12:15], v[32:35], v[116:119], a[12:15]
    v_mfma_f32_16x16x32_bf16 a[16:19], v[36:39], v[104:107], a[16:19]
    v_mfma_f32_16x16x32_bf16 a[20:23], v[36:39], v[108:111], a[20:23]
    v_mfma_f32_16x16x32_bf16 a[24:27], v[36:39], v[112:115], a[24:27]
    v_mfma_f32_16x16x32_bf16 a[28:31], v[36:39], v[116:119], a[28:31]
    v_mfma_f32_16x16x32_bf16 a[32:35], v[40:43], v[104:107], a[32:35]
    v_mfma_f32_16x16x32_bf16 a[36:39], v[40:43], v[108:111], a[36:39]
    v_mfma_f32_16x16x32_bf16 a[40:43], v[40:43], v[112:115], a[40:43]
    v_mfma_f32_16x16x32_bf16 a[44:47], v[40:43], v[116:119], a[44:47]
    v_mfma_f32_16x16x32_bf16 a[48:51], v[44:47], v[104:107], a[48:51]
    v_mfma_f32_16x16x32_bf16 a[52:55], v[44:47], v[108:111], a[52:55]
    v_mfma_f32_16x16x32_bf16 a[56:59], v[44:47], v[112:115], a[56:59]
    v_mfma_f32_16x16x32_bf16 a[60:63], v[44:47], v[116:119], a[60:63]
    v_mfma_f32_16x16x32_bf16 a[64:67], v[48:51], v[104:107], a[64:67]
    v_mfma_f32_16x16x32_bf16 a[68:71], v[48:51], v[108:111], a[68:71]
    v_mfma_f32_16x16x32_bf16 a[72:75], v[48:51], v[112:115], a[72:75]
    v_mfma_f32_16x16x32_bf16 a[76:79], v[48:51], v[116:119], a[76:79]
    v_mfma_f32_16x16x32_bf16 a[80:83], v[52:55], v[104:107], a[80:83]
    v_mfma_f32_16x16x32_bf16 a[84:87], v[52:55], v[108:111], a[84:87]
    v_mfma_f32_16x16x32_bf16 a[88:91], v[52:55], v[112:115], a[88:91]
    v_mfma_f32_16x16x32_bf16 a[92:95], v[52:55], v[116:119], a[92:95]
    v_mfma_f32_16x16x32_bf16 a[96:99], v[56:59], v[104:107], a[96:99]
    v_mfma_f32_16x16x32_bf16 a[100:103], v[56:59], v[108:111], a[100:103]
    v_mfma_f32_16x16x32_bf16 a[104:107], v[56:59], v[112:115], a[104:107]
    v_mfma_f32_16x16x32_bf16 a[108:111], v[56:59], v[116:119], a[108:111]
    v_mfma_f32_16x16x32_bf16 a[112:115], v[60:63], v[104:107], a[112:115]
    v_mfma_f32_16x16x32_bf16 a[116:119], v[60:63], v[108:111], a[116:119]
    v_mfma_f32_16x16x32_bf16 a[120:123], v[60:63], v[112:115], a[120:123]
    v_mfma_f32_16x16x32_bf16 a[124:127], v[60:63], v[116:119], a[124:127]
    v_mfma_f32_16x16x32_bf16 a[128:131], v[64:67], v[104:107], a[128:131]
    v_mfma_f32_16x16x32_bf16 a[132:135], v[64:67], v[108:111], a[132:135]
    v_mfma_f32_16x16x32_bf16 a[136:139], v[64:67], v[112:115], a[136:139]
    v_mfma_f32_16x16x32_bf16 a[140:143], v[64:67], v[116:119], a[140:143]
    s_waitcnt lgkmcnt(0)
    v_mfma_f32_16x16x32_bf16 a[0:3], v[68:71], v[120:123], a[0:3]
    v_mfma_f32_16x16x32_bf16 a[4:7], v[68:71], v[124:127], a[4:7]
    v_mfma_f32_16x16x32_bf16 a[8:11], v[68:71], v[128:131], a[8:11]
    v_mfma_f32_16x16x32_bf16 a[12:15], v[68:71], v[132:135], a[12:15]
    v_mfma_f32_16x16x32_bf16 a[16:19], v[72:75], v[120:123], a[16:19]
    v_mfma_f32_16x16x32_bf16 a[20:23], v[72:75], v[124:127], a[20:23]
    v_mfma_f32_16x16x32_bf16 a[24:27], v[72:75], v[128:131], a[24:27]
    v_mfma_f32_16x16x32_bf16 a[28:31], v[72:75], v[132:135], a[28:31]
    v_mfma_f32_16x16x32_bf16 a[32:35], v[76:79], v[120:123], a[32:35]
    v_mfma_f32_16x16x32_bf16 a[36:39], v[76:79], v[124:127], a[36:39]
    v_mfma_f32_16x16x32_bf16 a[40:43], v[76:79], v[128:131], a[40:43]
    v_mfma_f32_16x16x32_bf16 a[44:47], v[76:79], v[132:135], a[44:47]
    v_mfma_f32_16x16x32_bf16 a[48:51], v[80:83], v[120:123], a[48:51]
    v_mfma_f32_16x16x32_bf16 a[52:55], v[80:83], v[124:127], a[52:55]
    v_mfma_f32_16x16x32_bf16 a[56:59], v[80:83], v[128:131], a[56:59]
    v_mfma_f32_16x16x32_bf16 a[60:63], v[80:83], v[132:135], a[60:63]
    v_mfma_f32_16x16x32_bf16 a[64:67], v[84:87], v[120:123], a[64:67]
    v_mfma_f32_16x16x32_bf16 a[68:71], v[84:87], v[124:127], a[68:71]
    v_mfma_f32_16x16x32_bf16 a[72:75], v[84:87], v[128:131], a[72:75]
    v_mfma_f32_16x16x32_bf16 a[76:79], v[84:87], v[132:135], a[76:79]
    v_mfma_f32_16x16x32_bf16 a[80:83], v[88:91], v[120:123], a[80:83]
    v_mfma_f32_16x16x32_bf16 a[84:87], v[88:91], v[124:127], a[84:87]
    v_mfma_f32_16x16x32_bf16 a[88:91], v[88:91], v[128:131], a[88:91]
    v_mfma_f32_16x16x32_bf16 a[92:95], v[88:91], v[132:135], a[92:95]
    v_mfma_f32_16x16x32_bf16 a[96:99], v[92:95], v[120:123], a[96:99]
    v_mfma_f32_16x16x32_bf16 a[100:103], v[92:95], v[124:127], a[100:103]
    v_mfma_f32_16x16x32_bf16 a[104:107], v[92:95], v[128:131], a[104:107]
    v_mfma_f32_16x16x32_bf16 a[108:111], v[92:95], v[132:135], a[108:111]
    v_mfma_f32_16x16x32_bf16 a[112:115], v[96:99], v[120:123], a[112:115]
    v_mfma_f32_16x16x32_bf16 a[116:119], v[96:99], v[124:127], a[116:119]
    v_mfma_f32_16x16x32_bf16 a[120:123], v[96:99], v[128:131], a[120:123]
    v_mfma_f32_16x16x32_bf16 a[124:127], v[96:99], v[132:135], a[124:127]
    v_mfma_f32_16x16x32_bf16 a[128:131], v[100:103], v[120:123], a[128:131]
    v_mfma_f32_16x16x32_bf16 a[132:135], v[100:103], v[124:127], a[132:135]
    v_mfma_f32_16x16x32_bf16 a[136:139], v[100:103], v[128:131], a[136:139]
    v_mfma_f32_16x16x32_bf16 a[140:143], v[100:103], v[132:135], a[140:143]
    s_waitcnt vmcnt(13)
    s_barrier
    s_add_u32 m0, s72, 106496
    s_nop 0
    buffer_load_dwordx4 v2, s[8:11], s40 offen lds
    s_add_u32 s40, s40, s56

    s_add_u32 m0, s73, 106496
    s_nop 0
    buffer_load_dwordx4 v2, s[8:11], s41 offen lds
    s_add_u32 s41, s41, s57

    s_add_u32 m0, s74, 106496
    s_nop 0
    buffer_load_dwordx4 v2, s[8:11], s42 offen lds
    s_add_u32 s42, s42, s58

    s_add_u32 m0, s75, 106496
    s_nop 0
    buffer_load_dwordx4 v2, s[8:11], s43 offen lds
    s_add_u32 s43, s43, s59

    s_add_u32 m0, s76, 106496
    s_nop 0
    buffer_load_dwordx4 v2, s[8:11], s44 offen lds
    s_add_u32 s44, s44, s60

    s_add_u32 m0, s77, 106496
    s_nop 0
    buffer_load_dwordx4 v2, s[8:11], s45 offen lds
    s_add_u32 s45, s45, s61

    s_add_u32 m0, s78, 106496
    s_nop 0
    buffer_load_dwordx4 v2, s[8:11], s46 offen lds
    s_add_u32 s46, s46, s62

    s_add_u32 m0, s79, 106496
    s_nop 0
    buffer_load_dwordx4 v2, s[8:11], s47 offen lds
    s_add_u32 s47, s47, s63

    s_add_u32 m0, s80, 106496
    s_nop 0
    buffer_load_dwordx4 v2, s[8:11], s48 offen lds
    s_add_u32 s48, s48, s64

    s_add_u32 m0, s81, 106496
    s_nop 0
    buffer_load_dwordx4 v2, s[8:11], s49 offen lds
    s_add_u32 s49, s49, s65

    s_add_u32 m0, s82, 106496
    s_nop 0
    buffer_load_dwordx4 v2, s[8:11], s50 offen lds
    s_add_u32 s50, s50, s66

    s_add_u32 m0, s83, 106496
    s_nop 0
    buffer_load_dwordx4 v2, s[8:11], s51 offen lds
    s_add_u32 s51, s51, s67

    s_add_u32 m0, s84, 106496
    s_nop 0
    buffer_load_dwordx4 v2, s[8:11], s52 offen lds
    s_add_u32 s52, s52, s68

    ds_read_b128 v[104:107], v10 offset:0
    ds_read_b128 v[108:111], v10 offset:2048
    ds_read_b128 v[112:115], v10 offset:4096
    ds_read_b128 v[116:119], v10 offset:6144
    ds_read_b128 v[32:35], v11 offset:0
    ds_read_b128 v[36:39], v11 offset:2048
    ds_read_b128 v[40:43], v11 offset:4096
    ds_read_b128 v[44:47], v11 offset:6144
    ds_read_b128 v[48:51], v11 offset:8192
    ds_read_b128 v[52:55], v11 offset:10240
    ds_read_b128 v[56:59], v11 offset:12288
    ds_read_b128 v[60:63], v11 offset:14336
    ds_read_b128 v[64:67], v11 offset:16384
    ds_read_b128 v[120:123], v12 offset:0
    ds_read_b128 v[124:127], v12 offset:2048
    ds_read_b128 v[128:131], v12 offset:4096
    ds_read_b128 v[132:135], v12 offset:6144
    ds_read_b128 v[68:71], v13 offset:0
    ds_read_b128 v[72:75], v13 offset:2048
    ds_read_b128 v[76:79], v13 offset:4096
    ds_read_b128 v[80:83], v13 offset:6144
    ds_read_b128 v[84:87], v13 offset:8192
    ds_read_b128 v[88:91], v13 offset:10240
    ds_read_b128 v[92:95], v13 offset:12288
    ds_read_b128 v[96:99], v13 offset:14336
    ds_read_b128 v[100:103], v13 offset:16384
    s_waitcnt lgkmcnt(13)
    v_mfma_f32_16x16x32_bf16 a[0:3], v[32:35], v[104:107], a[0:3]
    v_mfma_f32_16x16x32_bf16 a[4:7], v[32:35], v[108:111], a[4:7]
    v_mfma_f32_16x16x32_bf16 a[8:11], v[32:35], v[112:115], a[8:11]
    v_mfma_f32_16x16x32_bf16 a[12:15], v[32:35], v[116:119], a[12:15]
    v_mfma_f32_16x16x32_bf16 a[16:19], v[36:39], v[104:107], a[16:19]
    v_mfma_f32_16x16x32_bf16 a[20:23], v[36:39], v[108:111], a[20:23]
    v_mfma_f32_16x16x32_bf16 a[24:27], v[36:39], v[112:115], a[24:27]
    v_mfma_f32_16x16x32_bf16 a[28:31], v[36:39], v[116:119], a[28:31]
    v_mfma_f32_16x16x32_bf16 a[32:35], v[40:43], v[104:107], a[32:35]
    v_mfma_f32_16x16x32_bf16 a[36:39], v[40:43], v[108:111], a[36:39]
    v_mfma_f32_16x16x32_bf16 a[40:43], v[40:43], v[112:115], a[40:43]
    v_mfma_f32_16x16x32_bf16 a[44:47], v[40:43], v[116:119], a[44:47]
    v_mfma_f32_16x16x32_bf16 a[48:51], v[44:47], v[104:107], a[48:51]
    v_mfma_f32_16x16x32_bf16 a[52:55], v[44:47], v[108:111], a[52:55]
    v_mfma_f32_16x16x32_bf16 a[56:59], v[44:47], v[112:115], a[56:59]
    v_mfma_f32_16x16x32_bf16 a[60:63], v[44:47], v[116:119], a[60:63]
    v_mfma_f32_16x16x32_bf16 a[64:67], v[48:51], v[104:107], a[64:67]
    v_mfma_f32_16x16x32_bf16 a[68:71], v[48:51], v[108:111], a[68:71]
    v_mfma_f32_16x16x32_bf16 a[72:75], v[48:51], v[112:115], a[72:75]
    v_mfma_f32_16x16x32_bf16 a[76:79], v[48:51], v[116:119], a[76:79]
    v_mfma_f32_16x16x32_bf16 a[80:83], v[52:55], v[104:107], a[80:83]
    v_mfma_f32_16x16x32_bf16 a[84:87], v[52:55], v[108:111], a[84:87]
    v_mfma_f32_16x16x32_bf16 a[88:91], v[52:55], v[112:115], a[88:91]
    v_mfma_f32_16x16x32_bf16 a[92:95], v[52:55], v[116:119], a[92:95]
    v_mfma_f32_16x16x32_bf16 a[96:99], v[56:59], v[104:107], a[96:99]
    v_mfma_f32_16x16x32_bf16 a[100:103], v[56:59], v[108:111], a[100:103]
    v_mfma_f32_16x16x32_bf16 a[104:107], v[56:59], v[112:115], a[104:107]
    v_mfma_f32_16x16x32_bf16 a[108:111], v[56:59], v[116:119], a[108:111]
    v_mfma_f32_16x16x32_bf16 a[112:115], v[60:63], v[104:107], a[112:115]
    v_mfma_f32_16x16x32_bf16 a[116:119], v[60:63], v[108:111], a[116:119]
    v_mfma_f32_16x16x32_bf16 a[120:123], v[60:63], v[112:115], a[120:123]
    v_mfma_f32_16x16x32_bf16 a[124:127], v[60:63], v[116:119], a[124:127]
    v_mfma_f32_16x16x32_bf16 a[128:131], v[64:67], v[104:107], a[128:131]
    v_mfma_f32_16x16x32_bf16 a[132:135], v[64:67], v[108:111], a[132:135]
    v_mfma_f32_16x16x32_bf16 a[136:139], v[64:67], v[112:115], a[136:139]
    v_mfma_f32_16x16x32_bf16 a[140:143], v[64:67], v[116:119], a[140:143]
    s_waitcnt lgkmcnt(0)
    v_mfma_f32_16x16x32_bf16 a[0:3], v[68:71], v[120:123], a[0:3]
    v_mfma_f32_16x16x32_bf16 a[4:7], v[68:71], v[124:127], a[4:7]
    v_mfma_f32_16x16x32_bf16 a[8:11], v[68:71], v[128:131], a[8:11]
    v_mfma_f32_16x16x32_bf16 a[12:15], v[68:71], v[132:135], a[12:15]
    v_mfma_f32_16x16x32_bf16 a[16:19], v[72:75], v[120:123], a[16:19]
    v_mfma_f32_16x16x32_bf16 a[20:23], v[72:75], v[124:127], a[20:23]
    v_mfma_f32_16x16x32_bf16 a[24:27], v[72:75], v[128:131], a[24:27]
    v_mfma_f32_16x16x32_bf16 a[28:31], v[72:75], v[132:135], a[28:31]
    v_mfma_f32_16x16x32_bf16 a[32:35], v[76:79], v[120:123], a[32:35]
    v_mfma_f32_16x16x32_bf16 a[36:39], v[76:79], v[124:127], a[36:39]
    v_mfma_f32_16x16x32_bf16 a[40:43], v[76:79], v[128:131], a[40:43]
    v_mfma_f32_16x16x32_bf16 a[44:47], v[76:79], v[132:135], a[44:47]
    v_mfma_f32_16x16x32_bf16 a[48:51], v[80:83], v[120:123], a[48:51]
    v_mfma_f32_16x16x32_bf16 a[52:55], v[80:83], v[124:127], a[52:55]
    v_mfma_f32_16x16x32_bf16 a[56:59], v[80:83], v[128:131], a[56:59]
    v_mfma_f32_16x16x32_bf16 a[60:63], v[80:83], v[132:135], a[60:63]
    v_mfma_f32_16x16x32_bf16 a[64:67], v[84:87], v[120:123], a[64:67]
    v_mfma_f32_16x16x32_bf16 a[68:71], v[84:87], v[124:127], a[68:71]
    v_mfma_f32_16x16x32_bf16 a[72:75], v[84:87], v[128:131], a[72:75]
    v_mfma_f32_16x16x32_bf16 a[76:79], v[84:87], v[132:135], a[76:79]
    v_mfma_f32_16x16x32_bf16 a[80:83], v[88:91], v[120:123], a[80:83]
    v_mfma_f32_16x16x32_bf16 a[84:87], v[88:91], v[124:127], a[84:87]
    v_mfma_f32_16x16x32_bf16 a[88:91], v[88:91], v[128:131], a[88:91]
    v_mfma_f32_16x16x32_bf16 a[92:95], v[88:91], v[132:135], a[92:95]
    v_mfma_f32_16x16x32_bf16 a[96:99], v[92:95], v[120:123], a[96:99]
    v_mfma_f32_16x16x32_bf16 a[100:103], v[92:95], v[124:127], a[100:103]
    v_mfma_f32_16x16x32_bf16 a[104:107], v[92:95], v[128:131], a[104:107]
    v_mfma_f32_16x16x32_bf16 a[108:111], v[92:95], v[132:135], a[108:111]
    v_mfma_f32_16x16x32_bf16 a[112:115], v[96:99], v[120:123], a[112:115]
    v_mfma_f32_16x16x32_bf16 a[116:119], v[96:99], v[124:127], a[116:119]
    v_mfma_f32_16x16x32_bf16 a[120:123], v[96:99], v[128:131], a[120:123]
    v_mfma_f32_16x16x32_bf16 a[124:127], v[96:99], v[132:135], a[124:127]
    v_mfma_f32_16x16x32_bf16 a[128:131], v[100:103], v[120:123], a[128:131]
    v_mfma_f32_16x16x32_bf16 a[132:135], v[100:103], v[124:127], a[132:135]
    v_mfma_f32_16x16x32_bf16 a[136:139], v[100:103], v[128:131], a[136:139]
    v_mfma_f32_16x16x32_bf16 a[140:143], v[100:103], v[132:135], a[140:143]
    s_waitcnt vmcnt(13)
    s_barrier
    s_add_u32 m0, s72, 0
    s_nop 0
    buffer_load_dwordx4 v2, s[8:11], s40 offen lds
    s_add_u32 s40, s40, s56

    s_add_u32 m0, s73, 0
    s_nop 0
    buffer_load_dwordx4 v2, s[8:11], s41 offen lds
    s_add_u32 s41, s41, s57

    s_add_u32 m0, s74, 0
    s_nop 0
    buffer_load_dwordx4 v2, s[8:11], s42 offen lds
    s_add_u32 s42, s42, s58

    s_add_u32 m0, s75, 0
    s_nop 0
    buffer_load_dwordx4 v2, s[8:11], s43 offen lds
    s_add_u32 s43, s43, s59

    s_add_u32 m0, s76, 0
    s_nop 0
    buffer_load_dwordx4 v2, s[8:11], s44 offen lds
    s_add_u32 s44, s44, s60

    s_add_u32 m0, s77, 0
    s_nop 0
    buffer_load_dwordx4 v2, s[8:11], s45 offen lds
    s_add_u32 s45, s45, s61

    s_add_u32 m0, s78, 0
    s_nop 0
    buffer_load_dwordx4 v2, s[8:11], s46 offen lds
    s_add_u32 s46, s46, s62

    s_add_u32 m0, s79, 0
    s_nop 0
    buffer_load_dwordx4 v2, s[8:11], s47 offen lds
    s_add_u32 s47, s47, s63

    s_add_u32 m0, s80, 0
    s_nop 0
    buffer_load_dwordx4 v2, s[8:11], s48 offen lds
    s_add_u32 s48, s48, s64

    s_add_u32 m0, s81, 0
    s_nop 0
    buffer_load_dwordx4 v2, s[8:11], s49 offen lds
    s_add_u32 s49, s49, s65

    s_add_u32 m0, s82, 0
    s_nop 0
    buffer_load_dwordx4 v2, s[8:11], s50 offen lds
    s_add_u32 s50, s50, s66

    s_add_u32 m0, s83, 0
    s_nop 0
    buffer_load_dwordx4 v2, s[8:11], s51 offen lds
    s_add_u32 s51, s51, s67

    s_add_u32 m0, s84, 0
    s_nop 0
    buffer_load_dwordx4 v2, s[8:11], s52 offen lds
    s_add_u32 s52, s52, s68

    ds_read_b128 v[104:107], v14 offset:0
    ds_read_b128 v[108:111], v14 offset:2048
    ds_read_b128 v[112:115], v14 offset:4096
    ds_read_b128 v[116:119], v14 offset:6144
    ds_read_b128 v[32:35], v15 offset:0
    ds_read_b128 v[36:39], v15 offset:2048
    ds_read_b128 v[40:43], v15 offset:4096
    ds_read_b128 v[44:47], v15 offset:6144
    ds_read_b128 v[48:51], v15 offset:8192
    ds_read_b128 v[52:55], v15 offset:10240
    ds_read_b128 v[56:59], v15 offset:12288
    ds_read_b128 v[60:63], v15 offset:14336
    ds_read_b128 v[64:67], v15 offset:16384
    ds_read_b128 v[120:123], v16 offset:0
    ds_read_b128 v[124:127], v16 offset:2048
    ds_read_b128 v[128:131], v16 offset:4096
    ds_read_b128 v[132:135], v16 offset:6144
    ds_read_b128 v[68:71], v17 offset:0
    ds_read_b128 v[72:75], v17 offset:2048
    ds_read_b128 v[76:79], v17 offset:4096
    ds_read_b128 v[80:83], v17 offset:6144
    ds_read_b128 v[84:87], v17 offset:8192
    ds_read_b128 v[88:91], v17 offset:10240
    ds_read_b128 v[92:95], v17 offset:12288
    ds_read_b128 v[96:99], v17 offset:14336
    ds_read_b128 v[100:103], v17 offset:16384
    s_waitcnt lgkmcnt(13)
    v_mfma_f32_16x16x32_bf16 a[0:3], v[32:35], v[104:107], a[0:3]
    v_mfma_f32_16x16x32_bf16 a[4:7], v[32:35], v[108:111], a[4:7]
    v_mfma_f32_16x16x32_bf16 a[8:11], v[32:35], v[112:115], a[8:11]
    v_mfma_f32_16x16x32_bf16 a[12:15], v[32:35], v[116:119], a[12:15]
    v_mfma_f32_16x16x32_bf16 a[16:19], v[36:39], v[104:107], a[16:19]
    v_mfma_f32_16x16x32_bf16 a[20:23], v[36:39], v[108:111], a[20:23]
    v_mfma_f32_16x16x32_bf16 a[24:27], v[36:39], v[112:115], a[24:27]
    v_mfma_f32_16x16x32_bf16 a[28:31], v[36:39], v[116:119], a[28:31]
    v_mfma_f32_16x16x32_bf16 a[32:35], v[40:43], v[104:107], a[32:35]
    v_mfma_f32_16x16x32_bf16 a[36:39], v[40:43], v[108:111], a[36:39]
    v_mfma_f32_16x16x32_bf16 a[40:43], v[40:43], v[112:115], a[40:43]
    v_mfma_f32_16x16x32_bf16 a[44:47], v[40:43], v[116:119], a[44:47]
    v_mfma_f32_16x16x32_bf16 a[48:51], v[44:47], v[104:107], a[48:51]
    v_mfma_f32_16x16x32_bf16 a[52:55], v[44:47], v[108:111], a[52:55]
    v_mfma_f32_16x16x32_bf16 a[56:59], v[44:47], v[112:115], a[56:59]
    v_mfma_f32_16x16x32_bf16 a[60:63], v[44:47], v[116:119], a[60:63]
    v_mfma_f32_16x16x32_bf16 a[64:67], v[48:51], v[104:107], a[64:67]
    v_mfma_f32_16x16x32_bf16 a[68:71], v[48:51], v[108:111], a[68:71]
    v_mfma_f32_16x16x32_bf16 a[72:75], v[48:51], v[112:115], a[72:75]
    v_mfma_f32_16x16x32_bf16 a[76:79], v[48:51], v[116:119], a[76:79]
    v_mfma_f32_16x16x32_bf16 a[80:83], v[52:55], v[104:107], a[80:83]
    v_mfma_f32_16x16x32_bf16 a[84:87], v[52:55], v[108:111], a[84:87]
    v_mfma_f32_16x16x32_bf16 a[88:91], v[52:55], v[112:115], a[88:91]
    v_mfma_f32_16x16x32_bf16 a[92:95], v[52:55], v[116:119], a[92:95]
    v_mfma_f32_16x16x32_bf16 a[96:99], v[56:59], v[104:107], a[96:99]
    v_mfma_f32_16x16x32_bf16 a[100:103], v[56:59], v[108:111], a[100:103]
    v_mfma_f32_16x16x32_bf16 a[104:107], v[56:59], v[112:115], a[104:107]
    v_mfma_f32_16x16x32_bf16 a[108:111], v[56:59], v[116:119], a[108:111]
    v_mfma_f32_16x16x32_bf16 a[112:115], v[60:63], v[104:107], a[112:115]
    v_mfma_f32_16x16x32_bf16 a[116:119], v[60:63], v[108:111], a[116:119]
    v_mfma_f32_16x16x32_bf16 a[120:123], v[60:63], v[112:115], a[120:123]
    v_mfma_f32_16x16x32_bf16 a[124:127], v[60:63], v[116:119], a[124:127]
    v_mfma_f32_16x16x32_bf16 a[128:131], v[64:67], v[104:107], a[128:131]
    v_mfma_f32_16x16x32_bf16 a[132:135], v[64:67], v[108:111], a[132:135]
    v_mfma_f32_16x16x32_bf16 a[136:139], v[64:67], v[112:115], a[136:139]
    v_mfma_f32_16x16x32_bf16 a[140:143], v[64:67], v[116:119], a[140:143]
    s_waitcnt lgkmcnt(0)
    v_mfma_f32_16x16x32_bf16 a[0:3], v[68:71], v[120:123], a[0:3]
    v_mfma_f32_16x16x32_bf16 a[4:7], v[68:71], v[124:127], a[4:7]
    v_mfma_f32_16x16x32_bf16 a[8:11], v[68:71], v[128:131], a[8:11]
    v_mfma_f32_16x16x32_bf16 a[12:15], v[68:71], v[132:135], a[12:15]
    v_mfma_f32_16x16x32_bf16 a[16:19], v[72:75], v[120:123], a[16:19]
    v_mfma_f32_16x16x32_bf16 a[20:23], v[72:75], v[124:127], a[20:23]
    v_mfma_f32_16x16x32_bf16 a[24:27], v[72:75], v[128:131], a[24:27]
    v_mfma_f32_16x16x32_bf16 a[28:31], v[72:75], v[132:135], a[28:31]
    v_mfma_f32_16x16x32_bf16 a[32:35], v[76:79], v[120:123], a[32:35]
    v_mfma_f32_16x16x32_bf16 a[36:39], v[76:79], v[124:127], a[36:39]
    v_mfma_f32_16x16x32_bf16 a[40:43], v[76:79], v[128:131], a[40:43]
    v_mfma_f32_16x16x32_bf16 a[44:47], v[76:79], v[132:135], a[44:47]
    v_mfma_f32_16x16x32_bf16 a[48:51], v[80:83], v[120:123], a[48:51]
    v_mfma_f32_16x16x32_bf16 a[52:55], v[80:83], v[124:127], a[52:55]
    v_mfma_f32_16x16x32_bf16 a[56:59], v[80:83], v[128:131], a[56:59]
    v_mfma_f32_16x16x32_bf16 a[60:63], v[80:83], v[132:135], a[60:63]
    v_mfma_f32_16x16x32_bf16 a[64:67], v[84:87], v[120:123], a[64:67]
    v_mfma_f32_16x16x32_bf16 a[68:71], v[84:87], v[124:127], a[68:71]
    v_mfma_f32_16x16x32_bf16 a[72:75], v[84:87], v[128:131], a[72:75]
    v_mfma_f32_16x16x32_bf16 a[76:79], v[84:87], v[132:135], a[76:79]
    v_mfma_f32_16x16x32_bf16 a[80:83], v[88:91], v[120:123], a[80:83]
    v_mfma_f32_16x16x32_bf16 a[84:87], v[88:91], v[124:127], a[84:87]
    v_mfma_f32_16x16x32_bf16 a[88:91], v[88:91], v[128:131], a[88:91]
    v_mfma_f32_16x16x32_bf16 a[92:95], v[88:91], v[132:135], a[92:95]
    v_mfma_f32_16x16x32_bf16 a[96:99], v[92:95], v[120:123], a[96:99]
    v_mfma_f32_16x16x32_bf16 a[100:103], v[92:95], v[124:127], a[100:103]
    v_mfma_f32_16x16x32_bf16 a[104:107], v[92:95], v[128:131], a[104:107]
    v_mfma_f32_16x16x32_bf16 a[108:111], v[92:95], v[132:135], a[108:111]
    v_mfma_f32_16x16x32_bf16 a[112:115], v[96:99], v[120:123], a[112:115]
    v_mfma_f32_16x16x32_bf16 a[116:119], v[96:99], v[124:127], a[116:119]
    v_mfma_f32_16x16x32_bf16 a[120:123], v[96:99], v[128:131], a[120:123]
    v_mfma_f32_16x16x32_bf16 a[124:127], v[96:99], v[132:135], a[124:127]
    v_mfma_f32_16x16x32_bf16 a[128:131], v[100:103], v[120:123], a[128:131]
    v_mfma_f32_16x16x32_bf16 a[132:135], v[100:103], v[124:127], a[132:135]
    v_mfma_f32_16x16x32_bf16 a[136:139], v[100:103], v[128:131], a[136:139]
    v_mfma_f32_16x16x32_bf16 a[140:143], v[100:103], v[132:135], a[140:143]
    s_waitcnt vmcnt(13)
    s_barrier
    s_add_u32 m0, s72, 53248
    s_nop 0
    buffer_load_dwordx4 v2, s[8:11], s40 offen lds
    s_add_u32 s40, s40, s56

    s_add_u32 m0, s73, 53248
    s_nop 0
    buffer_load_dwordx4 v2, s[8:11], s41 offen lds
    s_add_u32 s41, s41, s57

    s_add_u32 m0, s74, 53248
    s_nop 0
    buffer_load_dwordx4 v2, s[8:11], s42 offen lds
    s_add_u32 s42, s42, s58

    s_add_u32 m0, s75, 53248
    s_nop 0
    buffer_load_dwordx4 v2, s[8:11], s43 offen lds
    s_add_u32 s43, s43, s59

    s_add_u32 m0, s76, 53248
    s_nop 0
    buffer_load_dwordx4 v2, s[8:11], s44 offen lds
    s_add_u32 s44, s44, s60

    s_add_u32 m0, s77, 53248
    s_nop 0
    buffer_load_dwordx4 v2, s[8:11], s45 offen lds
    s_add_u32 s45, s45, s61

    s_add_u32 m0, s78, 53248
    s_nop 0
    buffer_load_dwordx4 v2, s[8:11], s46 offen lds
    s_add_u32 s46, s46, s62

    s_add_u32 m0, s79, 53248
    s_nop 0
    buffer_load_dwordx4 v2, s[8:11], s47 offen lds
    s_add_u32 s47, s47, s63

    s_add_u32 m0, s80, 53248
    s_nop 0
    buffer_load_dwordx4 v2, s[8:11], s48 offen lds
    s_add_u32 s48, s48, s64

    s_add_u32 m0, s81, 53248
    s_nop 0
    buffer_load_dwordx4 v2, s[8:11], s49 offen lds
    s_add_u32 s49, s49, s65

    s_add_u32 m0, s82, 53248
    s_nop 0
    buffer_load_dwordx4 v2, s[8:11], s50 offen lds
    s_add_u32 s50, s50, s66

    s_add_u32 m0, s83, 53248
    s_nop 0
    buffer_load_dwordx4 v2, s[8:11], s51 offen lds
    s_add_u32 s51, s51, s67

    s_add_u32 m0, s84, 53248
    s_nop 0
    buffer_load_dwordx4 v2, s[8:11], s52 offen lds
    s_add_u32 s52, s52, s68

    ds_read_b128 v[104:107], v18 offset:0
    ds_read_b128 v[108:111], v18 offset:2048
    ds_read_b128 v[112:115], v18 offset:4096
    ds_read_b128 v[116:119], v18 offset:6144
    ds_read_b128 v[32:35], v19 offset:0
    ds_read_b128 v[36:39], v19 offset:2048
    ds_read_b128 v[40:43], v19 offset:4096
    ds_read_b128 v[44:47], v19 offset:6144
    ds_read_b128 v[48:51], v19 offset:8192
    ds_read_b128 v[52:55], v19 offset:10240
    ds_read_b128 v[56:59], v19 offset:12288
    ds_read_b128 v[60:63], v19 offset:14336
    ds_read_b128 v[64:67], v19 offset:16384
    ds_read_b128 v[120:123], v20 offset:0
    ds_read_b128 v[124:127], v20 offset:2048
    ds_read_b128 v[128:131], v20 offset:4096
    ds_read_b128 v[132:135], v20 offset:6144
    ds_read_b128 v[68:71], v21 offset:0
    ds_read_b128 v[72:75], v21 offset:2048
    ds_read_b128 v[76:79], v21 offset:4096
    ds_read_b128 v[80:83], v21 offset:6144
    ds_read_b128 v[84:87], v21 offset:8192
    ds_read_b128 v[88:91], v21 offset:10240
    ds_read_b128 v[92:95], v21 offset:12288
    ds_read_b128 v[96:99], v21 offset:14336
    ds_read_b128 v[100:103], v21 offset:16384
    s_waitcnt lgkmcnt(13)
    v_mfma_f32_16x16x32_bf16 a[0:3], v[32:35], v[104:107], a[0:3]
    v_mfma_f32_16x16x32_bf16 a[4:7], v[32:35], v[108:111], a[4:7]
    v_mfma_f32_16x16x32_bf16 a[8:11], v[32:35], v[112:115], a[8:11]
    v_mfma_f32_16x16x32_bf16 a[12:15], v[32:35], v[116:119], a[12:15]
    v_mfma_f32_16x16x32_bf16 a[16:19], v[36:39], v[104:107], a[16:19]
    v_mfma_f32_16x16x32_bf16 a[20:23], v[36:39], v[108:111], a[20:23]
    v_mfma_f32_16x16x32_bf16 a[24:27], v[36:39], v[112:115], a[24:27]
    v_mfma_f32_16x16x32_bf16 a[28:31], v[36:39], v[116:119], a[28:31]
    v_mfma_f32_16x16x32_bf16 a[32:35], v[40:43], v[104:107], a[32:35]
    v_mfma_f32_16x16x32_bf16 a[36:39], v[40:43], v[108:111], a[36:39]
    v_mfma_f32_16x16x32_bf16 a[40:43], v[40:43], v[112:115], a[40:43]
    v_mfma_f32_16x16x32_bf16 a[44:47], v[40:43], v[116:119], a[44:47]
    v_mfma_f32_16x16x32_bf16 a[48:51], v[44:47], v[104:107], a[48:51]
    v_mfma_f32_16x16x32_bf16 a[52:55], v[44:47], v[108:111], a[52:55]
    v_mfma_f32_16x16x32_bf16 a[56:59], v[44:47], v[112:115], a[56:59]
    v_mfma_f32_16x16x32_bf16 a[60:63], v[44:47], v[116:119], a[60:63]
    v_mfma_f32_16x16x32_bf16 a[64:67], v[48:51], v[104:107], a[64:67]
    v_mfma_f32_16x16x32_bf16 a[68:71], v[48:51], v[108:111], a[68:71]
    v_mfma_f32_16x16x32_bf16 a[72:75], v[48:51], v[112:115], a[72:75]
    v_mfma_f32_16x16x32_bf16 a[76:79], v[48:51], v[116:119], a[76:79]
    v_mfma_f32_16x16x32_bf16 a[80:83], v[52:55], v[104:107], a[80:83]
    v_mfma_f32_16x16x32_bf16 a[84:87], v[52:55], v[108:111], a[84:87]
    v_mfma_f32_16x16x32_bf16 a[88:91], v[52:55], v[112:115], a[88:91]
    v_mfma_f32_16x16x32_bf16 a[92:95], v[52:55], v[116:119], a[92:95]
    v_mfma_f32_16x16x32_bf16 a[96:99], v[56:59], v[104:107], a[96:99]
    v_mfma_f32_16x16x32_bf16 a[100:103], v[56:59], v[108:111], a[100:103]
    v_mfma_f32_16x16x32_bf16 a[104:107], v[56:59], v[112:115], a[104:107]
    v_mfma_f32_16x16x32_bf16 a[108:111], v[56:59], v[116:119], a[108:111]
    v_mfma_f32_16x16x32_bf16 a[112:115], v[60:63], v[104:107], a[112:115]
    v_mfma_f32_16x16x32_bf16 a[116:119], v[60:63], v[108:111], a[116:119]
    v_mfma_f32_16x16x32_bf16 a[120:123], v[60:63], v[112:115], a[120:123]
    v_mfma_f32_16x16x32_bf16 a[124:127], v[60:63], v[116:119], a[124:127]
    v_mfma_f32_16x16x32_bf16 a[128:131], v[64:67], v[104:107], a[128:131]
    v_mfma_f32_16x16x32_bf16 a[132:135], v[64:67], v[108:111], a[132:135]
    v_mfma_f32_16x16x32_bf16 a[136:139], v[64:67], v[112:115], a[136:139]
    v_mfma_f32_16x16x32_bf16 a[140:143], v[64:67], v[116:119], a[140:143]
    s_waitcnt lgkmcnt(0)
    v_mfma_f32_16x16x32_bf16 a[0:3], v[68:71], v[120:123], a[0:3]
    v_mfma_f32_16x16x32_bf16 a[4:7], v[68:71], v[124:127], a[4:7]
    v_mfma_f32_16x16x32_bf16 a[8:11], v[68:71], v[128:131], a[8:11]
    v_mfma_f32_16x16x32_bf16 a[12:15], v[68:71], v[132:135], a[12:15]
    v_mfma_f32_16x16x32_bf16 a[16:19], v[72:75], v[120:123], a[16:19]
    v_mfma_f32_16x16x32_bf16 a[20:23], v[72:75], v[124:127], a[20:23]
    v_mfma_f32_16x16x32_bf16 a[24:27], v[72:75], v[128:131], a[24:27]
    v_mfma_f32_16x16x32_bf16 a[28:31], v[72:75], v[132:135], a[28:31]
    v_mfma_f32_16x16x32_bf16 a[32:35], v[76:79], v[120:123], a[32:35]
    v_mfma_f32_16x16x32_bf16 a[36:39], v[76:79], v[124:127], a[36:39]
    v_mfma_f32_16x16x32_bf16 a[40:43], v[76:79], v[128:131], a[40:43]
    v_mfma_f32_16x16x32_bf16 a[44:47], v[76:79], v[132:135], a[44:47]
    v_mfma_f32_16x16x32_bf16 a[48:51], v[80:83], v[120:123], a[48:51]
    v_mfma_f32_16x16x32_bf16 a[52:55], v[80:83], v[124:127], a[52:55]
    v_mfma_f32_16x16x32_bf16 a[56:59], v[80:83], v[128:131], a[56:59]
    v_mfma_f32_16x16x32_bf16 a[60:63], v[80:83], v[132:135], a[60:63]
    v_mfma_f32_16x16x32_bf16 a[64:67], v[84:87], v[120:123], a[64:67]
    v_mfma_f32_16x16x32_bf16 a[68:71], v[84:87], v[124:127], a[68:71]
    v_mfma_f32_16x16x32_bf16 a[72:75], v[84:87], v[128:131], a[72:75]
    v_mfma_f32_16x16x32_bf16 a[76:79], v[84:87], v[132:135], a[76:79]
    v_mfma_f32_16x16x32_bf16 a[80:83], v[88:91], v[120:123], a[80:83]
    v_mfma_f32_16x16x32_bf16 a[84:87], v[88:91], v[124:127], a[84:87]
    v_mfma_f32_16x16x32_bf16 a[88:91], v[88:91], v[128:131], a[88:91]
    v_mfma_f32_16x16x32_bf16 a[92:95], v[88:91], v[132:135], a[92:95]
    v_mfma_f32_16x16x32_bf16 a[96:99], v[92:95], v[120:123], a[96:99]
    v_mfma_f32_16x16x32_bf16 a[100:103], v[92:95], v[124:127], a[100:103]
    v_mfma_f32_16x16x32_bf16 a[104:107], v[92:95], v[128:131], a[104:107]
    v_mfma_f32_16x16x32_bf16 a[108:111], v[92:95], v[132:135], a[108:111]
    v_mfma_f32_16x16x32_bf16 a[112:115], v[96:99], v[120:123], a[112:115]
    v_mfma_f32_16x16x32_bf16 a[116:119], v[96:99], v[124:127], a[116:119]
    v_mfma_f32_16x16x32_bf16 a[120:123], v[96:99], v[128:131], a[120:123]
    v_mfma_f32_16x16x32_bf16 a[124:127], v[96:99], v[132:135], a[124:127]
    v_mfma_f32_16x16x32_bf16 a[128:131], v[100:103], v[120:123], a[128:131]
    v_mfma_f32_16x16x32_bf16 a[132:135], v[100:103], v[124:127], a[132:135]
    v_mfma_f32_16x16x32_bf16 a[136:139], v[100:103], v[128:131], a[136:139]
    v_mfma_f32_16x16x32_bf16 a[140:143], v[100:103], v[132:135], a[140:143]
    s_waitcnt vmcnt(13)
    s_barrier
    s_add_u32 m0, s72, 106496
    s_nop 0
    buffer_load_dwordx4 v2, s[8:11], s40 offen lds
    s_add_u32 s40, s40, s56

    s_add_u32 m0, s73, 106496
    s_nop 0
    buffer_load_dwordx4 v2, s[8:11], s41 offen lds
    s_add_u32 s41, s41, s57

    s_add_u32 m0, s74, 106496
    s_nop 0
    buffer_load_dwordx4 v2, s[8:11], s42 offen lds
    s_add_u32 s42, s42, s58

    s_add_u32 m0, s75, 106496
    s_nop 0
    buffer_load_dwordx4 v2, s[8:11], s43 offen lds
    s_add_u32 s43, s43, s59

    s_add_u32 m0, s76, 106496
    s_nop 0
    buffer_load_dwordx4 v2, s[8:11], s44 offen lds
    s_add_u32 s44, s44, s60

    s_add_u32 m0, s77, 106496
    s_nop 0
    buffer_load_dwordx4 v2, s[8:11], s45 offen lds
    s_add_u32 s45, s45, s61

    s_add_u32 m0, s78, 106496
    s_nop 0
    buffer_load_dwordx4 v2, s[8:11], s46 offen lds
    s_add_u32 s46, s46, s62

    s_add_u32 m0, s79, 106496
    s_nop 0
    buffer_load_dwordx4 v2, s[8:11], s47 offen lds
    s_add_u32 s47, s47, s63

    s_add_u32 m0, s80, 106496
    s_nop 0
    buffer_load_dwordx4 v2, s[8:11], s48 offen lds
    s_add_u32 s48, s48, s64

    s_add_u32 m0, s81, 106496
    s_nop 0
    buffer_load_dwordx4 v2, s[8:11], s49 offen lds
    s_add_u32 s49, s49, s65

    s_add_u32 m0, s82, 106496
    s_nop 0
    buffer_load_dwordx4 v2, s[8:11], s50 offen lds
    s_add_u32 s50, s50, s66

    s_add_u32 m0, s83, 106496
    s_nop 0
    buffer_load_dwordx4 v2, s[8:11], s51 offen lds
    s_add_u32 s51, s51, s67

    s_add_u32 m0, s84, 106496
    s_nop 0
    buffer_load_dwordx4 v2, s[8:11], s52 offen lds
    s_add_u32 s52, s52, s68

    ds_read_b128 v[104:107], v10 offset:0
    ds_read_b128 v[108:111], v10 offset:2048
    ds_read_b128 v[112:115], v10 offset:4096
    ds_read_b128 v[116:119], v10 offset:6144
    ds_read_b128 v[32:35], v11 offset:0
    ds_read_b128 v[36:39], v11 offset:2048
    ds_read_b128 v[40:43], v11 offset:4096
    ds_read_b128 v[44:47], v11 offset:6144
    ds_read_b128 v[48:51], v11 offset:8192
    ds_read_b128 v[52:55], v11 offset:10240
    ds_read_b128 v[56:59], v11 offset:12288
    ds_read_b128 v[60:63], v11 offset:14336
    ds_read_b128 v[64:67], v11 offset:16384
    ds_read_b128 v[120:123], v12 offset:0
    ds_read_b128 v[124:127], v12 offset:2048
    ds_read_b128 v[128:131], v12 offset:4096
    ds_read_b128 v[132:135], v12 offset:6144
    ds_read_b128 v[68:71], v13 offset:0
    ds_read_b128 v[72:75], v13 offset:2048
    ds_read_b128 v[76:79], v13 offset:4096
    ds_read_b128 v[80:83], v13 offset:6144
    ds_read_b128 v[84:87], v13 offset:8192
    ds_read_b128 v[88:91], v13 offset:10240
    ds_read_b128 v[92:95], v13 offset:12288
    ds_read_b128 v[96:99], v13 offset:14336
    ds_read_b128 v[100:103], v13 offset:16384
    s_waitcnt lgkmcnt(13)
    v_mfma_f32_16x16x32_bf16 a[0:3], v[32:35], v[104:107], a[0:3]
    v_mfma_f32_16x16x32_bf16 a[4:7], v[32:35], v[108:111], a[4:7]
    v_mfma_f32_16x16x32_bf16 a[8:11], v[32:35], v[112:115], a[8:11]
    v_mfma_f32_16x16x32_bf16 a[12:15], v[32:35], v[116:119], a[12:15]
    v_mfma_f32_16x16x32_bf16 a[16:19], v[36:39], v[104:107], a[16:19]
    v_mfma_f32_16x16x32_bf16 a[20:23], v[36:39], v[108:111], a[20:23]
    v_mfma_f32_16x16x32_bf16 a[24:27], v[36:39], v[112:115], a[24:27]
    v_mfma_f32_16x16x32_bf16 a[28:31], v[36:39], v[116:119], a[28:31]
    v_mfma_f32_16x16x32_bf16 a[32:35], v[40:43], v[104:107], a[32:35]
    v_mfma_f32_16x16x32_bf16 a[36:39], v[40:43], v[108:111], a[36:39]
    v_mfma_f32_16x16x32_bf16 a[40:43], v[40:43], v[112:115], a[40:43]
    v_mfma_f32_16x16x32_bf16 a[44:47], v[40:43], v[116:119], a[44:47]
    v_mfma_f32_16x16x32_bf16 a[48:51], v[44:47], v[104:107], a[48:51]
    v_mfma_f32_16x16x32_bf16 a[52:55], v[44:47], v[108:111], a[52:55]
    v_mfma_f32_16x16x32_bf16 a[56:59], v[44:47], v[112:115], a[56:59]
    v_mfma_f32_16x16x32_bf16 a[60:63], v[44:47], v[116:119], a[60:63]
    v_mfma_f32_16x16x32_bf16 a[64:67], v[48:51], v[104:107], a[64:67]
    v_mfma_f32_16x16x32_bf16 a[68:71], v[48:51], v[108:111], a[68:71]
    v_mfma_f32_16x16x32_bf16 a[72:75], v[48:51], v[112:115], a[72:75]
    v_mfma_f32_16x16x32_bf16 a[76:79], v[48:51], v[116:119], a[76:79]
    v_mfma_f32_16x16x32_bf16 a[80:83], v[52:55], v[104:107], a[80:83]
    v_mfma_f32_16x16x32_bf16 a[84:87], v[52:55], v[108:111], a[84:87]
    v_mfma_f32_16x16x32_bf16 a[88:91], v[52:55], v[112:115], a[88:91]
    v_mfma_f32_16x16x32_bf16 a[92:95], v[52:55], v[116:119], a[92:95]
    v_mfma_f32_16x16x32_bf16 a[96:99], v[56:59], v[104:107], a[96:99]
    v_mfma_f32_16x16x32_bf16 a[100:103], v[56:59], v[108:111], a[100:103]
    v_mfma_f32_16x16x32_bf16 a[104:107], v[56:59], v[112:115], a[104:107]
    v_mfma_f32_16x16x32_bf16 a[108:111], v[56:59], v[116:119], a[108:111]
    v_mfma_f32_16x16x32_bf16 a[112:115], v[60:63], v[104:107], a[112:115]
    v_mfma_f32_16x16x32_bf16 a[116:119], v[60:63], v[108:111], a[116:119]
    v_mfma_f32_16x16x32_bf16 a[120:123], v[60:63], v[112:115], a[120:123]
    v_mfma_f32_16x16x32_bf16 a[124:127], v[60:63], v[116:119], a[124:127]
    v_mfma_f32_16x16x32_bf16 a[128:131], v[64:67], v[104:107], a[128:131]
    v_mfma_f32_16x16x32_bf16 a[132:135], v[64:67], v[108:111], a[132:135]
    v_mfma_f32_16x16x32_bf16 a[136:139], v[64:67], v[112:115], a[136:139]
    v_mfma_f32_16x16x32_bf16 a[140:143], v[64:67], v[116:119], a[140:143]
    s_waitcnt lgkmcnt(0)
    v_mfma_f32_16x16x32_bf16 a[0:3], v[68:71], v[120:123], a[0:3]
    v_mfma_f32_16x16x32_bf16 a[4:7], v[68:71], v[124:127], a[4:7]
    v_mfma_f32_16x16x32_bf16 a[8:11], v[68:71], v[128:131], a[8:11]
    v_mfma_f32_16x16x32_bf16 a[12:15], v[68:71], v[132:135], a[12:15]
    v_mfma_f32_16x16x32_bf16 a[16:19], v[72:75], v[120:123], a[16:19]
    v_mfma_f32_16x16x32_bf16 a[20:23], v[72:75], v[124:127], a[20:23]
    v_mfma_f32_16x16x32_bf16 a[24:27], v[72:75], v[128:131], a[24:27]
    v_mfma_f32_16x16x32_bf16 a[28:31], v[72:75], v[132:135], a[28:31]
    v_mfma_f32_16x16x32_bf16 a[32:35], v[76:79], v[120:123], a[32:35]
    v_mfma_f32_16x16x32_bf16 a[36:39], v[76:79], v[124:127], a[36:39]
    v_mfma_f32_16x16x32_bf16 a[40:43], v[76:79], v[128:131], a[40:43]
    v_mfma_f32_16x16x32_bf16 a[44:47], v[76:79], v[132:135], a[44:47]
    v_mfma_f32_16x16x32_bf16 a[48:51], v[80:83], v[120:123], a[48:51]
    v_mfma_f32_16x16x32_bf16 a[52:55], v[80:83], v[124:127], a[52:55]
    v_mfma_f32_16x16x32_bf16 a[56:59], v[80:83], v[128:131], a[56:59]
    v_mfma_f32_16x16x32_bf16 a[60:63], v[80:83], v[132:135], a[60:63]
    v_mfma_f32_16x16x32_bf16 a[64:67], v[84:87], v[120:123], a[64:67]
    v_mfma_f32_16x16x32_bf16 a[68:71], v[84:87], v[124:127], a[68:71]
    v_mfma_f32_16x16x32_bf16 a[72:75], v[84:87], v[128:131], a[72:75]
    v_mfma_f32_16x16x32_bf16 a[76:79], v[84:87], v[132:135], a[76:79]
    v_mfma_f32_16x16x32_bf16 a[80:83], v[88:91], v[120:123], a[80:83]
    v_mfma_f32_16x16x32_bf16 a[84:87], v[88:91], v[124:127], a[84:87]
    v_mfma_f32_16x16x32_bf16 a[88:91], v[88:91], v[128:131], a[88:91]
    v_mfma_f32_16x16x32_bf16 a[92:95], v[88:91], v[132:135], a[92:95]
    v_mfma_f32_16x16x32_bf16 a[96:99], v[92:95], v[120:123], a[96:99]
    v_mfma_f32_16x16x32_bf16 a[100:103], v[92:95], v[124:127], a[100:103]
    v_mfma_f32_16x16x32_bf16 a[104:107], v[92:95], v[128:131], a[104:107]
    v_mfma_f32_16x16x32_bf16 a[108:111], v[92:95], v[132:135], a[108:111]
    v_mfma_f32_16x16x32_bf16 a[112:115], v[96:99], v[120:123], a[112:115]
    v_mfma_f32_16x16x32_bf16 a[116:119], v[96:99], v[124:127], a[116:119]
    v_mfma_f32_16x16x32_bf16 a[120:123], v[96:99], v[128:131], a[120:123]
    v_mfma_f32_16x16x32_bf16 a[124:127], v[96:99], v[132:135], a[124:127]
    v_mfma_f32_16x16x32_bf16 a[128:131], v[100:103], v[120:123], a[128:131]
    v_mfma_f32_16x16x32_bf16 a[132:135], v[100:103], v[124:127], a[132:135]
    v_mfma_f32_16x16x32_bf16 a[136:139], v[100:103], v[128:131], a[136:139]
    v_mfma_f32_16x16x32_bf16 a[140:143], v[100:103], v[132:135], a[140:143]
    s_waitcnt vmcnt(13)
    s_barrier
    ds_read_b128 v[104:107], v14 offset:0
    ds_read_b128 v[108:111], v14 offset:2048
    ds_read_b128 v[112:115], v14 offset:4096
    ds_read_b128 v[116:119], v14 offset:6144
    ds_read_b128 v[32:35], v15 offset:0
    ds_read_b128 v[36:39], v15 offset:2048
    ds_read_b128 v[40:43], v15 offset:4096
    ds_read_b128 v[44:47], v15 offset:6144
    ds_read_b128 v[48:51], v15 offset:8192
    ds_read_b128 v[52:55], v15 offset:10240
    ds_read_b128 v[56:59], v15 offset:12288
    ds_read_b128 v[60:63], v15 offset:14336
    ds_read_b128 v[64:67], v15 offset:16384
    ds_read_b128 v[120:123], v16 offset:0
    ds_read_b128 v[124:127], v16 offset:2048
    ds_read_b128 v[128:131], v16 offset:4096
    ds_read_b128 v[132:135], v16 offset:6144
    ds_read_b128 v[68:71], v17 offset:0
    ds_read_b128 v[72:75], v17 offset:2048
    ds_read_b128 v[76:79], v17 offset:4096
    ds_read_b128 v[80:83], v17 offset:6144
    ds_read_b128 v[84:87], v17 offset:8192
    ds_read_b128 v[88:91], v17 offset:10240
    ds_read_b128 v[92:95], v17 offset:12288
    ds_read_b128 v[96:99], v17 offset:14336
    ds_read_b128 v[100:103], v17 offset:16384
    s_waitcnt lgkmcnt(13)
    v_mfma_f32_16x16x32_bf16 a[0:3], v[32:35], v[104:107], a[0:3]
    v_mfma_f32_16x16x32_bf16 a[4:7], v[32:35], v[108:111], a[4:7]
    v_mfma_f32_16x16x32_bf16 a[8:11], v[32:35], v[112:115], a[8:11]
    v_mfma_f32_16x16x32_bf16 a[12:15], v[32:35], v[116:119], a[12:15]
    v_mfma_f32_16x16x32_bf16 a[16:19], v[36:39], v[104:107], a[16:19]
    v_mfma_f32_16x16x32_bf16 a[20:23], v[36:39], v[108:111], a[20:23]
    v_mfma_f32_16x16x32_bf16 a[24:27], v[36:39], v[112:115], a[24:27]
    v_mfma_f32_16x16x32_bf16 a[28:31], v[36:39], v[116:119], a[28:31]
    v_mfma_f32_16x16x32_bf16 a[32:35], v[40:43], v[104:107], a[32:35]
    v_mfma_f32_16x16x32_bf16 a[36:39], v[40:43], v[108:111], a[36:39]
    v_mfma_f32_16x16x32_bf16 a[40:43], v[40:43], v[112:115], a[40:43]
    v_mfma_f32_16x16x32_bf16 a[44:47], v[40:43], v[116:119], a[44:47]
    v_mfma_f32_16x16x32_bf16 a[48:51], v[44:47], v[104:107], a[48:51]
    v_mfma_f32_16x16x32_bf16 a[52:55], v[44:47], v[108:111], a[52:55]
    v_mfma_f32_16x16x32_bf16 a[56:59], v[44:47], v[112:115], a[56:59]
    v_mfma_f32_16x16x32_bf16 a[60:63], v[44:47], v[116:119], a[60:63]
    v_mfma_f32_16x16x32_bf16 a[64:67], v[48:51], v[104:107], a[64:67]
    v_mfma_f32_16x16x32_bf16 a[68:71], v[48:51], v[108:111], a[68:71]
    v_mfma_f32_16x16x32_bf16 a[72:75], v[48:51], v[112:115], a[72:75]
    v_mfma_f32_16x16x32_bf16 a[76:79], v[48:51], v[116:119], a[76:79]
    v_mfma_f32_16x16x32_bf16 a[80:83], v[52:55], v[104:107], a[80:83]
    v_mfma_f32_16x16x32_bf16 a[84:87], v[52:55], v[108:111], a[84:87]
    v_mfma_f32_16x16x32_bf16 a[88:91], v[52:55], v[112:115], a[88:91]
    v_mfma_f32_16x16x32_bf16 a[92:95], v[52:55], v[116:119], a[92:95]
    v_mfma_f32_16x16x32_bf16 a[96:99], v[56:59], v[104:107], a[96:99]
    v_mfma_f32_16x16x32_bf16 a[100:103], v[56:59], v[108:111], a[100:103]
    v_mfma_f32_16x16x32_bf16 a[104:107], v[56:59], v[112:115], a[104:107]
    v_mfma_f32_16x16x32_bf16 a[108:111], v[56:59], v[116:119], a[108:111]
    v_mfma_f32_16x16x32_bf16 a[112:115], v[60:63], v[104:107], a[112:115]
    v_mfma_f32_16x16x32_bf16 a[116:119], v[60:63], v[108:111], a[116:119]
    v_mfma_f32_16x16x32_bf16 a[120:123], v[60:63], v[112:115], a[120:123]
    v_mfma_f32_16x16x32_bf16 a[124:127], v[60:63], v[116:119], a[124:127]
    v_mfma_f32_16x16x32_bf16 a[128:131], v[64:67], v[104:107], a[128:131]
    v_mfma_f32_16x16x32_bf16 a[132:135], v[64:67], v[108:111], a[132:135]
    v_mfma_f32_16x16x32_bf16 a[136:139], v[64:67], v[112:115], a[136:139]
    v_mfma_f32_16x16x32_bf16 a[140:143], v[64:67], v[116:119], a[140:143]
    s_waitcnt lgkmcnt(0)
    v_mfma_f32_16x16x32_bf16 a[0:3], v[68:71], v[120:123], a[0:3]
    v_mfma_f32_16x16x32_bf16 a[4:7], v[68:71], v[124:127], a[4:7]
    v_mfma_f32_16x16x32_bf16 a[8:11], v[68:71], v[128:131], a[8:11]
    v_mfma_f32_16x16x32_bf16 a[12:15], v[68:71], v[132:135], a[12:15]
    v_mfma_f32_16x16x32_bf16 a[16:19], v[72:75], v[120:123], a[16:19]
    v_mfma_f32_16x16x32_bf16 a[20:23], v[72:75], v[124:127], a[20:23]
    v_mfma_f32_16x16x32_bf16 a[24:27], v[72:75], v[128:131], a[24:27]
    v_mfma_f32_16x16x32_bf16 a[28:31], v[72:75], v[132:135], a[28:31]
    v_mfma_f32_16x16x32_bf16 a[32:35], v[76:79], v[120:123], a[32:35]
    v_mfma_f32_16x16x32_bf16 a[36:39], v[76:79], v[124:127], a[36:39]
    v_mfma_f32_16x16x32_bf16 a[40:43], v[76:79], v[128:131], a[40:43]
    v_mfma_f32_16x16x32_bf16 a[44:47], v[76:79], v[132:135], a[44:47]
    v_mfma_f32_16x16x32_bf16 a[48:51], v[80:83], v[120:123], a[48:51]
    v_mfma_f32_16x16x32_bf16 a[52:55], v[80:83], v[124:127], a[52:55]
    v_mfma_f32_16x16x32_bf16 a[56:59], v[80:83], v[128:131], a[56:59]
    v_mfma_f32_16x16x32_bf16 a[60:63], v[80:83], v[132:135], a[60:63]
    v_mfma_f32_16x16x32_bf16 a[64:67], v[84:87], v[120:123], a[64:67]
    v_mfma_f32_16x16x32_bf16 a[68:71], v[84:87], v[124:127], a[68:71]
    v_mfma_f32_16x16x32_bf16 a[72:75], v[84:87], v[128:131], a[72:75]
    v_mfma_f32_16x16x32_bf16 a[76:79], v[84:87], v[132:135], a[76:79]
    v_mfma_f32_16x16x32_bf16 a[80:83], v[88:91], v[120:123], a[80:83]
    v_mfma_f32_16x16x32_bf16 a[84:87], v[88:91], v[124:127], a[84:87]
    v_mfma_f32_16x16x32_bf16 a[88:91], v[88:91], v[128:131], a[88:91]
    v_mfma_f32_16x16x32_bf16 a[92:95], v[88:91], v[132:135], a[92:95]
    v_mfma_f32_16x16x32_bf16 a[96:99], v[92:95], v[120:123], a[96:99]
    v_mfma_f32_16x16x32_bf16 a[100:103], v[92:95], v[124:127], a[100:103]
    v_mfma_f32_16x16x32_bf16 a[104:107], v[92:95], v[128:131], a[104:107]
    v_mfma_f32_16x16x32_bf16 a[108:111], v[92:95], v[132:135], a[108:111]
    v_mfma_f32_16x16x32_bf16 a[112:115], v[96:99], v[120:123], a[112:115]
    v_mfma_f32_16x16x32_bf16 a[116:119], v[96:99], v[124:127], a[116:119]
    v_mfma_f32_16x16x32_bf16 a[120:123], v[96:99], v[128:131], a[120:123]
    v_mfma_f32_16x16x32_bf16 a[124:127], v[96:99], v[132:135], a[124:127]
    v_mfma_f32_16x16x32_bf16 a[128:131], v[100:103], v[120:123], a[128:131]
    v_mfma_f32_16x16x32_bf16 a[132:135], v[100:103], v[124:127], a[132:135]
    v_mfma_f32_16x16x32_bf16 a[136:139], v[100:103], v[128:131], a[136:139]
    v_mfma_f32_16x16x32_bf16 a[140:143], v[100:103], v[132:135], a[140:143]
    s_waitcnt vmcnt(0)
    s_barrier
    ds_read_b128 v[104:107], v18 offset:0
    ds_read_b128 v[108:111], v18 offset:2048
    ds_read_b128 v[112:115], v18 offset:4096
    ds_read_b128 v[116:119], v18 offset:6144
    ds_read_b128 v[32:35], v19 offset:0
    ds_read_b128 v[36:39], v19 offset:2048
    ds_read_b128 v[40:43], v19 offset:4096
    ds_read_b128 v[44:47], v19 offset:6144
    ds_read_b128 v[48:51], v19 offset:8192
    ds_read_b128 v[52:55], v19 offset:10240
    ds_read_b128 v[56:59], v19 offset:12288
    ds_read_b128 v[60:63], v19 offset:14336
    ds_read_b128 v[64:67], v19 offset:16384
    ds_read_b128 v[120:123], v20 offset:0
    ds_read_b128 v[124:127], v20 offset:2048
    ds_read_b128 v[128:131], v20 offset:4096
    ds_read_b128 v[132:135], v20 offset:6144
    ds_read_b128 v[68:71], v21 offset:0
    ds_read_b128 v[72:75], v21 offset:2048
    ds_read_b128 v[76:79], v21 offset:4096
    ds_read_b128 v[80:83], v21 offset:6144
    ds_read_b128 v[84:87], v21 offset:8192
    ds_read_b128 v[88:91], v21 offset:10240
    ds_read_b128 v[92:95], v21 offset:12288
    ds_read_b128 v[96:99], v21 offset:14336
    ds_read_b128 v[100:103], v21 offset:16384
    s_waitcnt lgkmcnt(13)
    v_mfma_f32_16x16x32_bf16 a[0:3], v[32:35], v[104:107], a[0:3]
    v_mfma_f32_16x16x32_bf16 a[4:7], v[32:35], v[108:111], a[4:7]
    v_mfma_f32_16x16x32_bf16 a[8:11], v[32:35], v[112:115], a[8:11]
    v_mfma_f32_16x16x32_bf16 a[12:15], v[32:35], v[116:119], a[12:15]
    v_mfma_f32_16x16x32_bf16 a[16:19], v[36:39], v[104:107], a[16:19]
    v_mfma_f32_16x16x32_bf16 a[20:23], v[36:39], v[108:111], a[20:23]
    v_mfma_f32_16x16x32_bf16 a[24:27], v[36:39], v[112:115], a[24:27]
    v_mfma_f32_16x16x32_bf16 a[28:31], v[36:39], v[116:119], a[28:31]
    v_mfma_f32_16x16x32_bf16 a[32:35], v[40:43], v[104:107], a[32:35]
    v_mfma_f32_16x16x32_bf16 a[36:39], v[40:43], v[108:111], a[36:39]
    v_mfma_f32_16x16x32_bf16 a[40:43], v[40:43], v[112:115], a[40:43]
    v_mfma_f32_16x16x32_bf16 a[44:47], v[40:43], v[116:119], a[44:47]
    v_mfma_f32_16x16x32_bf16 a[48:51], v[44:47], v[104:107], a[48:51]
    v_mfma_f32_16x16x32_bf16 a[52:55], v[44:47], v[108:111], a[52:55]
    v_mfma_f32_16x16x32_bf16 a[56:59], v[44:47], v[112:115], a[56:59]
    v_mfma_f32_16x16x32_bf16 a[60:63], v[44:47], v[116:119], a[60:63]
    v_mfma_f32_16x16x32_bf16 a[64:67], v[48:51], v[104:107], a[64:67]
    v_mfma_f32_16x16x32_bf16 a[68:71], v[48:51], v[108:111], a[68:71]
    v_mfma_f32_16x16x32_bf16 a[72:75], v[48:51], v[112:115], a[72:75]
    v_mfma_f32_16x16x32_bf16 a[76:79], v[48:51], v[116:119], a[76:79]
    v_mfma_f32_16x16x32_bf16 a[80:83], v[52:55], v[104:107], a[80:83]
    v_mfma_f32_16x16x32_bf16 a[84:87], v[52:55], v[108:111], a[84:87]
    v_mfma_f32_16x16x32_bf16 a[88:91], v[52:55], v[112:115], a[88:91]
    v_mfma_f32_16x16x32_bf16 a[92:95], v[52:55], v[116:119], a[92:95]
    v_mfma_f32_16x16x32_bf16 a[96:99], v[56:59], v[104:107], a[96:99]
    v_mfma_f32_16x16x32_bf16 a[100:103], v[56:59], v[108:111], a[100:103]
    v_mfma_f32_16x16x32_bf16 a[104:107], v[56:59], v[112:115], a[104:107]
    v_mfma_f32_16x16x32_bf16 a[108:111], v[56:59], v[116:119], a[108:111]
    v_mfma_f32_16x16x32_bf16 a[112:115], v[60:63], v[104:107], a[112:115]
    v_mfma_f32_16x16x32_bf16 a[116:119], v[60:63], v[108:111], a[116:119]
    v_mfma_f32_16x16x32_bf16 a[120:123], v[60:63], v[112:115], a[120:123]
    v_mfma_f32_16x16x32_bf16 a[124:127], v[60:63], v[116:119], a[124:127]
    v_mfma_f32_16x16x32_bf16 a[128:131], v[64:67], v[104:107], a[128:131]
    v_mfma_f32_16x16x32_bf16 a[132:135], v[64:67], v[108:111], a[132:135]
    v_mfma_f32_16x16x32_bf16 a[136:139], v[64:67], v[112:115], a[136:139]
    v_mfma_f32_16x16x32_bf16 a[140:143], v[64:67], v[116:119], a[140:143]
    s_waitcnt lgkmcnt(0)
    v_mfma_f32_16x16x32_bf16 a[0:3], v[68:71], v[120:123], a[0:3]
    v_mfma_f32_16x16x32_bf16 a[4:7], v[68:71], v[124:127], a[4:7]
    v_mfma_f32_16x16x32_bf16 a[8:11], v[68:71], v[128:131], a[8:11]
    v_mfma_f32_16x16x32_bf16 a[12:15], v[68:71], v[132:135], a[12:15]
    v_mfma_f32_16x16x32_bf16 a[16:19], v[72:75], v[120:123], a[16:19]
    v_mfma_f32_16x16x32_bf16 a[20:23], v[72:75], v[124:127], a[20:23]
    v_mfma_f32_16x16x32_bf16 a[24:27], v[72:75], v[128:131], a[24:27]
    v_mfma_f32_16x16x32_bf16 a[28:31], v[72:75], v[132:135], a[28:31]
    v_mfma_f32_16x16x32_bf16 a[32:35], v[76:79], v[120:123], a[32:35]
    v_mfma_f32_16x16x32_bf16 a[36:39], v[76:79], v[124:127], a[36:39]
    v_mfma_f32_16x16x32_bf16 a[40:43], v[76:79], v[128:131], a[40:43]
    v_mfma_f32_16x16x32_bf16 a[44:47], v[76:79], v[132:135], a[44:47]
    v_mfma_f32_16x16x32_bf16 a[48:51], v[80:83], v[120:123], a[48:51]
    v_mfma_f32_16x16x32_bf16 a[52:55], v[80:83], v[124:127], a[52:55]
    v_mfma_f32_16x16x32_bf16 a[56:59], v[80:83], v[128:131], a[56:59]
    v_mfma_f32_16x16x32_bf16 a[60:63], v[80:83], v[132:135], a[60:63]
    v_mfma_f32_16x16x32_bf16 a[64:67], v[84:87], v[120:123], a[64:67]
    v_mfma_f32_16x16x32_bf16 a[68:71], v[84:87], v[124:127], a[68:71]
    v_mfma_f32_16x16x32_bf16 a[72:75], v[84:87], v[128:131], a[72:75]
    v_mfma_f32_16x16x32_bf16 a[76:79], v[84:87], v[132:135], a[76:79]
    v_mfma_f32_16x16x32_bf16 a[80:83], v[88:91], v[120:123], a[80:83]
    v_mfma_f32_16x16x32_bf16 a[84:87], v[88:91], v[124:127], a[84:87]
    v_mfma_f32_16x16x32_bf16 a[88:91], v[88:91], v[128:131], a[88:91]
    v_mfma_f32_16x16x32_bf16 a[92:95], v[88:91], v[132:135], a[92:95]
    v_mfma_f32_16x16x32_bf16 a[96:99], v[92:95], v[120:123], a[96:99]
    v_mfma_f32_16x16x32_bf16 a[100:103], v[92:95], v[124:127], a[100:103]
    v_mfma_f32_16x16x32_bf16 a[104:107], v[92:95], v[128:131], a[104:107]
    v_mfma_f32_16x16x32_bf16 a[108:111], v[92:95], v[132:135], a[108:111]
    v_mfma_f32_16x16x32_bf16 a[112:115], v[96:99], v[120:123], a[112:115]
    v_mfma_f32_16x16x32_bf16 a[116:119], v[96:99], v[124:127], a[116:119]
    v_mfma_f32_16x16x32_bf16 a[120:123], v[96:99], v[128:131], a[120:123]
    v_mfma_f32_16x16x32_bf16 a[124:127], v[96:99], v[132:135], a[124:127]
    v_mfma_f32_16x16x32_bf16 a[128:131], v[100:103], v[120:123], a[128:131]
    v_mfma_f32_16x16x32_bf16 a[132:135], v[100:103], v[124:127], a[132:135]
    v_mfma_f32_16x16x32_bf16 a[136:139], v[100:103], v[128:131], a[136:139]
    v_mfma_f32_16x16x32_bf16 a[140:143], v[100:103], v[132:135], a[140:143]
    s_nop 7
    s_nop 3
    s_mov_b32 s28, 0x3fb8aa3b
    s_mul_i32 s29, s14, 288
    s_mul_i32 s30, s25, 144
    s_add_u32 s29, s29, s30
    s_lshl_b32 s30, s13, 7
    s_mul_i32 s30, s13, 1179648
    s_add_u32 s30, s30, 24952832
    s_lshl_b32 s31, s24, 13
    s_add_u32 s30, s30, s31
    v_lshrrev_b32 v7, 5, v0
    v_and_b32 v7, 1, v7
    v_xor_b32 v7, v7, v5
    v_lshlrev_b32 v7, 4, v7
    v_and_b32 v8, 1, v4
    v_lshlrev_b32 v8, 3, v8
    v_lshl_add_u32 v8, v3, 7, v8
    v_add_u32 v8, s30, v8

    s_add_u32 s31, s29, 0
    s_lshr_b32 s32, s31, 6
    s_lshl_b32 s32, s32, 14
    s_lshr_b32 s33, s31, 3
    s_and_b32 s33, s33, 7
    s_lshl_b32 s33, s33, 4
    v_xor_b32 v9, s33, v7
    v_add3_u32 v9, v9, v8, s32

    v_accvgpr_read_b32 v24, a0
    v_accvgpr_read_b32 v25, a1
    v_accvgpr_read_b32 v26, a2
    v_accvgpr_read_b32 v27, a3
    v_cvt_pk_bf16_f32 v24, v24, v24
    v_lshlrev_b32 v24, 16, v24
    v_mul_f32 v28, s28, v24
    v_sub_f32 v28, 0, v28
    v_exp_f32 v28, v28
    s_nop 0
    v_add_f32 v28, 1.0, v28
    v_rcp_f32 v28, v28
    s_nop 0
    v_mul_f32 v24, v24, v28

    v_cvt_pk_bf16_f32 v25, v25, v25
    v_lshlrev_b32 v25, 16, v25
    v_mul_f32 v28, s28, v25
    v_sub_f32 v28, 0, v28
    v_exp_f32 v28, v28
    s_nop 0
    v_add_f32 v28, 1.0, v28
    v_rcp_f32 v28, v28
    s_nop 0
    v_mul_f32 v25, v25, v28

    v_cvt_pk_bf16_f32 v26, v26, v26
    v_lshlrev_b32 v26, 16, v26
    v_mul_f32 v28, s28, v26
    v_sub_f32 v28, 0, v28
    v_exp_f32 v28, v28
    s_nop 0
    v_add_f32 v28, 1.0, v28
    v_rcp_f32 v28, v28
    s_nop 0
    v_mul_f32 v26, v26, v28

    v_cvt_pk_bf16_f32 v27, v27, v27
    v_lshlrev_b32 v27, 16, v27
    v_mul_f32 v28, s28, v27
    v_sub_f32 v28, 0, v28
    v_exp_f32 v28, v28
    s_nop 0
    v_add_f32 v28, 1.0, v28
    v_rcp_f32 v28, v28
    s_nop 0
    v_mul_f32 v27, v27, v28

    v_cvt_pk_bf16_f32 v30, v24, v25
    v_cvt_pk_bf16_f32 v31, v26, v27
    v_add_u32 v29, 0, v9
    buffer_store_dwordx2 v[30:31], v29, s[8:11], 0 offen

    v_accvgpr_read_b32 v24, a4
    v_accvgpr_read_b32 v25, a5
    v_accvgpr_read_b32 v26, a6
    v_accvgpr_read_b32 v27, a7
    v_cvt_pk_bf16_f32 v24, v24, v24
    v_lshlrev_b32 v24, 16, v24
    v_mul_f32 v28, s28, v24
    v_sub_f32 v28, 0, v28
    v_exp_f32 v28, v28
    s_nop 0
    v_add_f32 v28, 1.0, v28
    v_rcp_f32 v28, v28
    s_nop 0
    v_mul_f32 v24, v24, v28

    v_cvt_pk_bf16_f32 v25, v25, v25
    v_lshlrev_b32 v25, 16, v25
    v_mul_f32 v28, s28, v25
    v_sub_f32 v28, 0, v28
    v_exp_f32 v28, v28
    s_nop 0
    v_add_f32 v28, 1.0, v28
    v_rcp_f32 v28, v28
    s_nop 0
    v_mul_f32 v25, v25, v28

    v_cvt_pk_bf16_f32 v26, v26, v26
    v_lshlrev_b32 v26, 16, v26
    v_mul_f32 v28, s28, v26
    v_sub_f32 v28, 0, v28
    v_exp_f32 v28, v28
    s_nop 0
    v_add_f32 v28, 1.0, v28
    v_rcp_f32 v28, v28
    s_nop 0
    v_mul_f32 v26, v26, v28

    v_cvt_pk_bf16_f32 v27, v27, v27
    v_lshlrev_b32 v27, 16, v27
    v_mul_f32 v28, s28, v27
    v_sub_f32 v28, 0, v28
    v_exp_f32 v28, v28
    s_nop 0
    v_add_f32 v28, 1.0, v28
    v_rcp_f32 v28, v28
    s_nop 0
    v_mul_f32 v27, v27, v28

    v_cvt_pk_bf16_f32 v30, v24, v25
    v_cvt_pk_bf16_f32 v31, v26, v27
    v_add_u32 v29, 2048, v9
    buffer_store_dwordx2 v[30:31], v29, s[8:11], 0 offen

    v_accvgpr_read_b32 v24, a8
    v_accvgpr_read_b32 v25, a9
    v_accvgpr_read_b32 v26, a10
    v_accvgpr_read_b32 v27, a11
    v_cvt_pk_bf16_f32 v24, v24, v24
    v_lshlrev_b32 v24, 16, v24
    v_mul_f32 v28, s28, v24
    v_sub_f32 v28, 0, v28
    v_exp_f32 v28, v28
    s_nop 0
    v_add_f32 v28, 1.0, v28
    v_rcp_f32 v28, v28
    s_nop 0
    v_mul_f32 v24, v24, v28

    v_cvt_pk_bf16_f32 v25, v25, v25
    v_lshlrev_b32 v25, 16, v25
    v_mul_f32 v28, s28, v25
    v_sub_f32 v28, 0, v28
    v_exp_f32 v28, v28
    s_nop 0
    v_add_f32 v28, 1.0, v28
    v_rcp_f32 v28, v28
    s_nop 0
    v_mul_f32 v25, v25, v28

    v_cvt_pk_bf16_f32 v26, v26, v26
    v_lshlrev_b32 v26, 16, v26
    v_mul_f32 v28, s28, v26
    v_sub_f32 v28, 0, v28
    v_exp_f32 v28, v28
    s_nop 0
    v_add_f32 v28, 1.0, v28
    v_rcp_f32 v28, v28
    s_nop 0
    v_mul_f32 v26, v26, v28

    v_cvt_pk_bf16_f32 v27, v27, v27
    v_lshlrev_b32 v27, 16, v27
    v_mul_f32 v28, s28, v27
    v_sub_f32 v28, 0, v28
    v_exp_f32 v28, v28
    s_nop 0
    v_add_f32 v28, 1.0, v28
    v_rcp_f32 v28, v28
    s_nop 0
    v_mul_f32 v27, v27, v28

    v_cvt_pk_bf16_f32 v30, v24, v25
    v_cvt_pk_bf16_f32 v31, v26, v27
    v_add_u32 v29, 4096, v9
    buffer_store_dwordx2 v[30:31], v29, s[8:11], 0 offen

    v_accvgpr_read_b32 v24, a12
    v_accvgpr_read_b32 v25, a13
    v_accvgpr_read_b32 v26, a14
    v_accvgpr_read_b32 v27, a15
    v_cvt_pk_bf16_f32 v24, v24, v24
    v_lshlrev_b32 v24, 16, v24
    v_mul_f32 v28, s28, v24
    v_sub_f32 v28, 0, v28
    v_exp_f32 v28, v28
    s_nop 0
    v_add_f32 v28, 1.0, v28
    v_rcp_f32 v28, v28
    s_nop 0
    v_mul_f32 v24, v24, v28

    v_cvt_pk_bf16_f32 v25, v25, v25
    v_lshlrev_b32 v25, 16, v25
    v_mul_f32 v28, s28, v25
    v_sub_f32 v28, 0, v28
    v_exp_f32 v28, v28
    s_nop 0
    v_add_f32 v28, 1.0, v28
    v_rcp_f32 v28, v28
    s_nop 0
    v_mul_f32 v25, v25, v28

    v_cvt_pk_bf16_f32 v26, v26, v26
    v_lshlrev_b32 v26, 16, v26
    v_mul_f32 v28, s28, v26
    v_sub_f32 v28, 0, v28
    v_exp_f32 v28, v28
    s_nop 0
    v_add_f32 v28, 1.0, v28
    v_rcp_f32 v28, v28
    s_nop 0
    v_mul_f32 v26, v26, v28

    v_cvt_pk_bf16_f32 v27, v27, v27
    v_lshlrev_b32 v27, 16, v27
    v_mul_f32 v28, s28, v27
    v_sub_f32 v28, 0, v28
    v_exp_f32 v28, v28
    s_nop 0
    v_add_f32 v28, 1.0, v28
    v_rcp_f32 v28, v28
    s_nop 0
    v_mul_f32 v27, v27, v28

    v_cvt_pk_bf16_f32 v30, v24, v25
    v_cvt_pk_bf16_f32 v31, v26, v27
    v_add_u32 v29, 6144, v9
    buffer_store_dwordx2 v[30:31], v29, s[8:11], 0 offen

    s_add_u32 s31, s29, 16
    s_lshr_b32 s32, s31, 6
    s_lshl_b32 s32, s32, 14
    s_lshr_b32 s33, s31, 3
    s_and_b32 s33, s33, 7
    s_lshl_b32 s33, s33, 4
    v_xor_b32 v9, s33, v7
    v_add3_u32 v9, v9, v8, s32

    v_accvgpr_read_b32 v24, a16
    v_accvgpr_read_b32 v25, a17
    v_accvgpr_read_b32 v26, a18
    v_accvgpr_read_b32 v27, a19
    v_cvt_pk_bf16_f32 v24, v24, v24
    v_lshlrev_b32 v24, 16, v24
    v_mul_f32 v28, s28, v24
    v_sub_f32 v28, 0, v28
    v_exp_f32 v28, v28
    s_nop 0
    v_add_f32 v28, 1.0, v28
    v_rcp_f32 v28, v28
    s_nop 0
    v_mul_f32 v24, v24, v28

    v_cvt_pk_bf16_f32 v25, v25, v25
    v_lshlrev_b32 v25, 16, v25
    v_mul_f32 v28, s28, v25
    v_sub_f32 v28, 0, v28
    v_exp_f32 v28, v28
    s_nop 0
    v_add_f32 v28, 1.0, v28
    v_rcp_f32 v28, v28
    s_nop 0
    v_mul_f32 v25, v25, v28

    v_cvt_pk_bf16_f32 v26, v26, v26
    v_lshlrev_b32 v26, 16, v26
    v_mul_f32 v28, s28, v26
    v_sub_f32 v28, 0, v28
    v_exp_f32 v28, v28
    s_nop 0
    v_add_f32 v28, 1.0, v28
    v_rcp_f32 v28, v28
    s_nop 0
    v_mul_f32 v26, v26, v28

    v_cvt_pk_bf16_f32 v27, v27, v27
    v_lshlrev_b32 v27, 16, v27
    v_mul_f32 v28, s28, v27
    v_sub_f32 v28, 0, v28
    v_exp_f32 v28, v28
    s_nop 0
    v_add_f32 v28, 1.0, v28
    v_rcp_f32 v28, v28
    s_nop 0
    v_mul_f32 v27, v27, v28

    v_cvt_pk_bf16_f32 v30, v24, v25
    v_cvt_pk_bf16_f32 v31, v26, v27
    v_add_u32 v29, 0, v9
    buffer_store_dwordx2 v[30:31], v29, s[8:11], 0 offen

    v_accvgpr_read_b32 v24, a20
    v_accvgpr_read_b32 v25, a21
    v_accvgpr_read_b32 v26, a22
    v_accvgpr_read_b32 v27, a23
    v_cvt_pk_bf16_f32 v24, v24, v24
    v_lshlrev_b32 v24, 16, v24
    v_mul_f32 v28, s28, v24
    v_sub_f32 v28, 0, v28
    v_exp_f32 v28, v28
    s_nop 0
    v_add_f32 v28, 1.0, v28
    v_rcp_f32 v28, v28
    s_nop 0
    v_mul_f32 v24, v24, v28

    v_cvt_pk_bf16_f32 v25, v25, v25
    v_lshlrev_b32 v25, 16, v25
    v_mul_f32 v28, s28, v25
    v_sub_f32 v28, 0, v28
    v_exp_f32 v28, v28
    s_nop 0
    v_add_f32 v28, 1.0, v28
    v_rcp_f32 v28, v28
    s_nop 0
    v_mul_f32 v25, v25, v28

    v_cvt_pk_bf16_f32 v26, v26, v26
    v_lshlrev_b32 v26, 16, v26
    v_mul_f32 v28, s28, v26
    v_sub_f32 v28, 0, v28
    v_exp_f32 v28, v28
    s_nop 0
    v_add_f32 v28, 1.0, v28
    v_rcp_f32 v28, v28
    s_nop 0
    v_mul_f32 v26, v26, v28

    v_cvt_pk_bf16_f32 v27, v27, v27
    v_lshlrev_b32 v27, 16, v27
    v_mul_f32 v28, s28, v27
    v_sub_f32 v28, 0, v28
    v_exp_f32 v28, v28
    s_nop 0
    v_add_f32 v28, 1.0, v28
    v_rcp_f32 v28, v28
    s_nop 0
    v_mul_f32 v27, v27, v28

    v_cvt_pk_bf16_f32 v30, v24, v25
    v_cvt_pk_bf16_f32 v31, v26, v27
    v_add_u32 v29, 2048, v9
    buffer_store_dwordx2 v[30:31], v29, s[8:11], 0 offen

    v_accvgpr_read_b32 v24, a24
    v_accvgpr_read_b32 v25, a25
    v_accvgpr_read_b32 v26, a26
    v_accvgpr_read_b32 v27, a27
    v_cvt_pk_bf16_f32 v24, v24, v24
    v_lshlrev_b32 v24, 16, v24
    v_mul_f32 v28, s28, v24
    v_sub_f32 v28, 0, v28
    v_exp_f32 v28, v28
    s_nop 0
    v_add_f32 v28, 1.0, v28
    v_rcp_f32 v28, v28
    s_nop 0
    v_mul_f32 v24, v24, v28

    v_cvt_pk_bf16_f32 v25, v25, v25
    v_lshlrev_b32 v25, 16, v25
    v_mul_f32 v28, s28, v25
    v_sub_f32 v28, 0, v28
    v_exp_f32 v28, v28
    s_nop 0
    v_add_f32 v28, 1.0, v28
    v_rcp_f32 v28, v28
    s_nop 0
    v_mul_f32 v25, v25, v28

    v_cvt_pk_bf16_f32 v26, v26, v26
    v_lshlrev_b32 v26, 16, v26
    v_mul_f32 v28, s28, v26
    v_sub_f32 v28, 0, v28
    v_exp_f32 v28, v28
    s_nop 0
    v_add_f32 v28, 1.0, v28
    v_rcp_f32 v28, v28
    s_nop 0
    v_mul_f32 v26, v26, v28

    v_cvt_pk_bf16_f32 v27, v27, v27
    v_lshlrev_b32 v27, 16, v27
    v_mul_f32 v28, s28, v27
    v_sub_f32 v28, 0, v28
    v_exp_f32 v28, v28
    s_nop 0
    v_add_f32 v28, 1.0, v28
    v_rcp_f32 v28, v28
    s_nop 0
    v_mul_f32 v27, v27, v28

    v_cvt_pk_bf16_f32 v30, v24, v25
    v_cvt_pk_bf16_f32 v31, v26, v27
    v_add_u32 v29, 4096, v9
    buffer_store_dwordx2 v[30:31], v29, s[8:11], 0 offen

    v_accvgpr_read_b32 v24, a28
    v_accvgpr_read_b32 v25, a29
    v_accvgpr_read_b32 v26, a30
    v_accvgpr_read_b32 v27, a31
    v_cvt_pk_bf16_f32 v24, v24, v24
    v_lshlrev_b32 v24, 16, v24
    v_mul_f32 v28, s28, v24
    v_sub_f32 v28, 0, v28
    v_exp_f32 v28, v28
    s_nop 0
    v_add_f32 v28, 1.0, v28
    v_rcp_f32 v28, v28
    s_nop 0
    v_mul_f32 v24, v24, v28

    v_cvt_pk_bf16_f32 v25, v25, v25
    v_lshlrev_b32 v25, 16, v25
    v_mul_f32 v28, s28, v25
    v_sub_f32 v28, 0, v28
    v_exp_f32 v28, v28
    s_nop 0
    v_add_f32 v28, 1.0, v28
    v_rcp_f32 v28, v28
    s_nop 0
    v_mul_f32 v25, v25, v28

    v_cvt_pk_bf16_f32 v26, v26, v26
    v_lshlrev_b32 v26, 16, v26
    v_mul_f32 v28, s28, v26
    v_sub_f32 v28, 0, v28
    v_exp_f32 v28, v28
    s_nop 0
    v_add_f32 v28, 1.0, v28
    v_rcp_f32 v28, v28
    s_nop 0
    v_mul_f32 v26, v26, v28

    v_cvt_pk_bf16_f32 v27, v27, v27
    v_lshlrev_b32 v27, 16, v27
    v_mul_f32 v28, s28, v27
    v_sub_f32 v28, 0, v28
    v_exp_f32 v28, v28
    s_nop 0
    v_add_f32 v28, 1.0, v28
    v_rcp_f32 v28, v28
    s_nop 0
    v_mul_f32 v27, v27, v28

    v_cvt_pk_bf16_f32 v30, v24, v25
    v_cvt_pk_bf16_f32 v31, v26, v27
    v_add_u32 v29, 6144, v9
    buffer_store_dwordx2 v[30:31], v29, s[8:11], 0 offen

    s_add_u32 s31, s29, 32
    s_lshr_b32 s32, s31, 6
    s_lshl_b32 s32, s32, 14
    s_lshr_b32 s33, s31, 3
    s_and_b32 s33, s33, 7
    s_lshl_b32 s33, s33, 4
    v_xor_b32 v9, s33, v7
    v_add3_u32 v9, v9, v8, s32

    v_accvgpr_read_b32 v24, a32
    v_accvgpr_read_b32 v25, a33
    v_accvgpr_read_b32 v26, a34
    v_accvgpr_read_b32 v27, a35
    v_cvt_pk_bf16_f32 v24, v24, v24
    v_lshlrev_b32 v24, 16, v24
    v_mul_f32 v28, s28, v24
    v_sub_f32 v28, 0, v28
    v_exp_f32 v28, v28
    s_nop 0
    v_add_f32 v28, 1.0, v28
    v_rcp_f32 v28, v28
    s_nop 0
    v_mul_f32 v24, v24, v28

    v_cvt_pk_bf16_f32 v25, v25, v25
    v_lshlrev_b32 v25, 16, v25
    v_mul_f32 v28, s28, v25
    v_sub_f32 v28, 0, v28
    v_exp_f32 v28, v28
    s_nop 0
    v_add_f32 v28, 1.0, v28
    v_rcp_f32 v28, v28
    s_nop 0
    v_mul_f32 v25, v25, v28

    v_cvt_pk_bf16_f32 v26, v26, v26
    v_lshlrev_b32 v26, 16, v26
    v_mul_f32 v28, s28, v26
    v_sub_f32 v28, 0, v28
    v_exp_f32 v28, v28
    s_nop 0
    v_add_f32 v28, 1.0, v28
    v_rcp_f32 v28, v28
    s_nop 0
    v_mul_f32 v26, v26, v28

    v_cvt_pk_bf16_f32 v27, v27, v27
    v_lshlrev_b32 v27, 16, v27
    v_mul_f32 v28, s28, v27
    v_sub_f32 v28, 0, v28
    v_exp_f32 v28, v28
    s_nop 0
    v_add_f32 v28, 1.0, v28
    v_rcp_f32 v28, v28
    s_nop 0
    v_mul_f32 v27, v27, v28

    v_cvt_pk_bf16_f32 v30, v24, v25
    v_cvt_pk_bf16_f32 v31, v26, v27
    v_add_u32 v29, 0, v9
    buffer_store_dwordx2 v[30:31], v29, s[8:11], 0 offen

    v_accvgpr_read_b32 v24, a36
    v_accvgpr_read_b32 v25, a37
    v_accvgpr_read_b32 v26, a38
    v_accvgpr_read_b32 v27, a39
    v_cvt_pk_bf16_f32 v24, v24, v24
    v_lshlrev_b32 v24, 16, v24
    v_mul_f32 v28, s28, v24
    v_sub_f32 v28, 0, v28
    v_exp_f32 v28, v28
    s_nop 0
    v_add_f32 v28, 1.0, v28
    v_rcp_f32 v28, v28
    s_nop 0
    v_mul_f32 v24, v24, v28

    v_cvt_pk_bf16_f32 v25, v25, v25
    v_lshlrev_b32 v25, 16, v25
    v_mul_f32 v28, s28, v25
    v_sub_f32 v28, 0, v28
    v_exp_f32 v28, v28
    s_nop 0
    v_add_f32 v28, 1.0, v28
    v_rcp_f32 v28, v28
    s_nop 0
    v_mul_f32 v25, v25, v28

    v_cvt_pk_bf16_f32 v26, v26, v26
    v_lshlrev_b32 v26, 16, v26
    v_mul_f32 v28, s28, v26
    v_sub_f32 v28, 0, v28
    v_exp_f32 v28, v28
    s_nop 0
    v_add_f32 v28, 1.0, v28
    v_rcp_f32 v28, v28
    s_nop 0
    v_mul_f32 v26, v26, v28

    v_cvt_pk_bf16_f32 v27, v27, v27
    v_lshlrev_b32 v27, 16, v27
    v_mul_f32 v28, s28, v27
    v_sub_f32 v28, 0, v28
    v_exp_f32 v28, v28
    s_nop 0
    v_add_f32 v28, 1.0, v28
    v_rcp_f32 v28, v28
    s_nop 0
    v_mul_f32 v27, v27, v28

    v_cvt_pk_bf16_f32 v30, v24, v25
    v_cvt_pk_bf16_f32 v31, v26, v27
    v_add_u32 v29, 2048, v9
    buffer_store_dwordx2 v[30:31], v29, s[8:11], 0 offen

    v_accvgpr_read_b32 v24, a40
    v_accvgpr_read_b32 v25, a41
    v_accvgpr_read_b32 v26, a42
    v_accvgpr_read_b32 v27, a43
    v_cvt_pk_bf16_f32 v24, v24, v24
    v_lshlrev_b32 v24, 16, v24
    v_mul_f32 v28, s28, v24
    v_sub_f32 v28, 0, v28
    v_exp_f32 v28, v28
    s_nop 0
    v_add_f32 v28, 1.0, v28
    v_rcp_f32 v28, v28
    s_nop 0
    v_mul_f32 v24, v24, v28

    v_cvt_pk_bf16_f32 v25, v25, v25
    v_lshlrev_b32 v25, 16, v25
    v_mul_f32 v28, s28, v25
    v_sub_f32 v28, 0, v28
    v_exp_f32 v28, v28
    s_nop 0
    v_add_f32 v28, 1.0, v28
    v_rcp_f32 v28, v28
    s_nop 0
    v_mul_f32 v25, v25, v28

    v_cvt_pk_bf16_f32 v26, v26, v26
    v_lshlrev_b32 v26, 16, v26
    v_mul_f32 v28, s28, v26
    v_sub_f32 v28, 0, v28
    v_exp_f32 v28, v28
    s_nop 0
    v_add_f32 v28, 1.0, v28
    v_rcp_f32 v28, v28
    s_nop 0
    v_mul_f32 v26, v26, v28

    v_cvt_pk_bf16_f32 v27, v27, v27
    v_lshlrev_b32 v27, 16, v27
    v_mul_f32 v28, s28, v27
    v_sub_f32 v28, 0, v28
    v_exp_f32 v28, v28
    s_nop 0
    v_add_f32 v28, 1.0, v28
    v_rcp_f32 v28, v28
    s_nop 0
    v_mul_f32 v27, v27, v28

    v_cvt_pk_bf16_f32 v30, v24, v25
    v_cvt_pk_bf16_f32 v31, v26, v27
    v_add_u32 v29, 4096, v9
    buffer_store_dwordx2 v[30:31], v29, s[8:11], 0 offen

    v_accvgpr_read_b32 v24, a44
    v_accvgpr_read_b32 v25, a45
    v_accvgpr_read_b32 v26, a46
    v_accvgpr_read_b32 v27, a47
    v_cvt_pk_bf16_f32 v24, v24, v24
    v_lshlrev_b32 v24, 16, v24
    v_mul_f32 v28, s28, v24
    v_sub_f32 v28, 0, v28
    v_exp_f32 v28, v28
    s_nop 0
    v_add_f32 v28, 1.0, v28
    v_rcp_f32 v28, v28
    s_nop 0
    v_mul_f32 v24, v24, v28

    v_cvt_pk_bf16_f32 v25, v25, v25
    v_lshlrev_b32 v25, 16, v25
    v_mul_f32 v28, s28, v25
    v_sub_f32 v28, 0, v28
    v_exp_f32 v28, v28
    s_nop 0
    v_add_f32 v28, 1.0, v28
    v_rcp_f32 v28, v28
    s_nop 0
    v_mul_f32 v25, v25, v28

    v_cvt_pk_bf16_f32 v26, v26, v26
    v_lshlrev_b32 v26, 16, v26
    v_mul_f32 v28, s28, v26
    v_sub_f32 v28, 0, v28
    v_exp_f32 v28, v28
    s_nop 0
    v_add_f32 v28, 1.0, v28
    v_rcp_f32 v28, v28
    s_nop 0
    v_mul_f32 v26, v26, v28

    v_cvt_pk_bf16_f32 v27, v27, v27
    v_lshlrev_b32 v27, 16, v27
    v_mul_f32 v28, s28, v27
    v_sub_f32 v28, 0, v28
    v_exp_f32 v28, v28
    s_nop 0
    v_add_f32 v28, 1.0, v28
    v_rcp_f32 v28, v28
    s_nop 0
    v_mul_f32 v27, v27, v28

    v_cvt_pk_bf16_f32 v30, v24, v25
    v_cvt_pk_bf16_f32 v31, v26, v27
    v_add_u32 v29, 6144, v9
    buffer_store_dwordx2 v[30:31], v29, s[8:11], 0 offen

    s_add_u32 s31, s29, 48
    s_lshr_b32 s32, s31, 6
    s_lshl_b32 s32, s32, 14
    s_lshr_b32 s33, s31, 3
    s_and_b32 s33, s33, 7
    s_lshl_b32 s33, s33, 4
    v_xor_b32 v9, s33, v7
    v_add3_u32 v9, v9, v8, s32

    v_accvgpr_read_b32 v24, a48
    v_accvgpr_read_b32 v25, a49
    v_accvgpr_read_b32 v26, a50
    v_accvgpr_read_b32 v27, a51
    v_cvt_pk_bf16_f32 v24, v24, v24
    v_lshlrev_b32 v24, 16, v24
    v_mul_f32 v28, s28, v24
    v_sub_f32 v28, 0, v28
    v_exp_f32 v28, v28
    s_nop 0
    v_add_f32 v28, 1.0, v28
    v_rcp_f32 v28, v28
    s_nop 0
    v_mul_f32 v24, v24, v28

    v_cvt_pk_bf16_f32 v25, v25, v25
    v_lshlrev_b32 v25, 16, v25
    v_mul_f32 v28, s28, v25
    v_sub_f32 v28, 0, v28
    v_exp_f32 v28, v28
    s_nop 0
    v_add_f32 v28, 1.0, v28
    v_rcp_f32 v28, v28
    s_nop 0
    v_mul_f32 v25, v25, v28

    v_cvt_pk_bf16_f32 v26, v26, v26
    v_lshlrev_b32 v26, 16, v26
    v_mul_f32 v28, s28, v26
    v_sub_f32 v28, 0, v28
    v_exp_f32 v28, v28
    s_nop 0
    v_add_f32 v28, 1.0, v28
    v_rcp_f32 v28, v28
    s_nop 0
    v_mul_f32 v26, v26, v28

    v_cvt_pk_bf16_f32 v27, v27, v27
    v_lshlrev_b32 v27, 16, v27
    v_mul_f32 v28, s28, v27
    v_sub_f32 v28, 0, v28
    v_exp_f32 v28, v28
    s_nop 0
    v_add_f32 v28, 1.0, v28
    v_rcp_f32 v28, v28
    s_nop 0
    v_mul_f32 v27, v27, v28

    v_cvt_pk_bf16_f32 v30, v24, v25
    v_cvt_pk_bf16_f32 v31, v26, v27
    v_add_u32 v29, 0, v9
    buffer_store_dwordx2 v[30:31], v29, s[8:11], 0 offen

    v_accvgpr_read_b32 v24, a52
    v_accvgpr_read_b32 v25, a53
    v_accvgpr_read_b32 v26, a54
    v_accvgpr_read_b32 v27, a55
    v_cvt_pk_bf16_f32 v24, v24, v24
    v_lshlrev_b32 v24, 16, v24
    v_mul_f32 v28, s28, v24
    v_sub_f32 v28, 0, v28
    v_exp_f32 v28, v28
    s_nop 0
    v_add_f32 v28, 1.0, v28
    v_rcp_f32 v28, v28
    s_nop 0
    v_mul_f32 v24, v24, v28

    v_cvt_pk_bf16_f32 v25, v25, v25
    v_lshlrev_b32 v25, 16, v25
    v_mul_f32 v28, s28, v25
    v_sub_f32 v28, 0, v28
    v_exp_f32 v28, v28
    s_nop 0
    v_add_f32 v28, 1.0, v28
    v_rcp_f32 v28, v28
    s_nop 0
    v_mul_f32 v25, v25, v28

    v_cvt_pk_bf16_f32 v26, v26, v26
    v_lshlrev_b32 v26, 16, v26
    v_mul_f32 v28, s28, v26
    v_sub_f32 v28, 0, v28
    v_exp_f32 v28, v28
    s_nop 0
    v_add_f32 v28, 1.0, v28
    v_rcp_f32 v28, v28
    s_nop 0
    v_mul_f32 v26, v26, v28

    v_cvt_pk_bf16_f32 v27, v27, v27
    v_lshlrev_b32 v27, 16, v27
    v_mul_f32 v28, s28, v27
    v_sub_f32 v28, 0, v28
    v_exp_f32 v28, v28
    s_nop 0
    v_add_f32 v28, 1.0, v28
    v_rcp_f32 v28, v28
    s_nop 0
    v_mul_f32 v27, v27, v28

    v_cvt_pk_bf16_f32 v30, v24, v25
    v_cvt_pk_bf16_f32 v31, v26, v27
    v_add_u32 v29, 2048, v9
    buffer_store_dwordx2 v[30:31], v29, s[8:11], 0 offen

    v_accvgpr_read_b32 v24, a56
    v_accvgpr_read_b32 v25, a57
    v_accvgpr_read_b32 v26, a58
    v_accvgpr_read_b32 v27, a59
    v_cvt_pk_bf16_f32 v24, v24, v24
    v_lshlrev_b32 v24, 16, v24
    v_mul_f32 v28, s28, v24
    v_sub_f32 v28, 0, v28
    v_exp_f32 v28, v28
    s_nop 0
    v_add_f32 v28, 1.0, v28
    v_rcp_f32 v28, v28
    s_nop 0
    v_mul_f32 v24, v24, v28

    v_cvt_pk_bf16_f32 v25, v25, v25
    v_lshlrev_b32 v25, 16, v25
    v_mul_f32 v28, s28, v25
    v_sub_f32 v28, 0, v28
    v_exp_f32 v28, v28
    s_nop 0
    v_add_f32 v28, 1.0, v28
    v_rcp_f32 v28, v28
    s_nop 0
    v_mul_f32 v25, v25, v28

    v_cvt_pk_bf16_f32 v26, v26, v26
    v_lshlrev_b32 v26, 16, v26
    v_mul_f32 v28, s28, v26
    v_sub_f32 v28, 0, v28
    v_exp_f32 v28, v28
    s_nop 0
    v_add_f32 v28, 1.0, v28
    v_rcp_f32 v28, v28
    s_nop 0
    v_mul_f32 v26, v26, v28

    v_cvt_pk_bf16_f32 v27, v27, v27
    v_lshlrev_b32 v27, 16, v27
    v_mul_f32 v28, s28, v27
    v_sub_f32 v28, 0, v28
    v_exp_f32 v28, v28
    s_nop 0
    v_add_f32 v28, 1.0, v28
    v_rcp_f32 v28, v28
    s_nop 0
    v_mul_f32 v27, v27, v28

    v_cvt_pk_bf16_f32 v30, v24, v25
    v_cvt_pk_bf16_f32 v31, v26, v27
    v_add_u32 v29, 4096, v9
    buffer_store_dwordx2 v[30:31], v29, s[8:11], 0 offen

    v_accvgpr_read_b32 v24, a60
    v_accvgpr_read_b32 v25, a61
    v_accvgpr_read_b32 v26, a62
    v_accvgpr_read_b32 v27, a63
    v_cvt_pk_bf16_f32 v24, v24, v24
    v_lshlrev_b32 v24, 16, v24
    v_mul_f32 v28, s28, v24
    v_sub_f32 v28, 0, v28
    v_exp_f32 v28, v28
    s_nop 0
    v_add_f32 v28, 1.0, v28
    v_rcp_f32 v28, v28
    s_nop 0
    v_mul_f32 v24, v24, v28

    v_cvt_pk_bf16_f32 v25, v25, v25
    v_lshlrev_b32 v25, 16, v25
    v_mul_f32 v28, s28, v25
    v_sub_f32 v28, 0, v28
    v_exp_f32 v28, v28
    s_nop 0
    v_add_f32 v28, 1.0, v28
    v_rcp_f32 v28, v28
    s_nop 0
    v_mul_f32 v25, v25, v28

    v_cvt_pk_bf16_f32 v26, v26, v26
    v_lshlrev_b32 v26, 16, v26
    v_mul_f32 v28, s28, v26
    v_sub_f32 v28, 0, v28
    v_exp_f32 v28, v28
    s_nop 0
    v_add_f32 v28, 1.0, v28
    v_rcp_f32 v28, v28
    s_nop 0
    v_mul_f32 v26, v26, v28

    v_cvt_pk_bf16_f32 v27, v27, v27
    v_lshlrev_b32 v27, 16, v27
    v_mul_f32 v28, s28, v27
    v_sub_f32 v28, 0, v28
    v_exp_f32 v28, v28
    s_nop 0
    v_add_f32 v28, 1.0, v28
    v_rcp_f32 v28, v28
    s_nop 0
    v_mul_f32 v27, v27, v28

    v_cvt_pk_bf16_f32 v30, v24, v25
    v_cvt_pk_bf16_f32 v31, v26, v27
    v_add_u32 v29, 6144, v9
    buffer_store_dwordx2 v[30:31], v29, s[8:11], 0 offen

    s_add_u32 s31, s29, 64
    s_lshr_b32 s32, s31, 6
    s_lshl_b32 s32, s32, 14
    s_lshr_b32 s33, s31, 3
    s_and_b32 s33, s33, 7
    s_lshl_b32 s33, s33, 4
    v_xor_b32 v9, s33, v7
    v_add3_u32 v9, v9, v8, s32

    v_accvgpr_read_b32 v24, a64
    v_accvgpr_read_b32 v25, a65
    v_accvgpr_read_b32 v26, a66
    v_accvgpr_read_b32 v27, a67
    v_cvt_pk_bf16_f32 v24, v24, v24
    v_lshlrev_b32 v24, 16, v24
    v_mul_f32 v28, s28, v24
    v_sub_f32 v28, 0, v28
    v_exp_f32 v28, v28
    s_nop 0
    v_add_f32 v28, 1.0, v28
    v_rcp_f32 v28, v28
    s_nop 0
    v_mul_f32 v24, v24, v28

    v_cvt_pk_bf16_f32 v25, v25, v25
    v_lshlrev_b32 v25, 16, v25
    v_mul_f32 v28, s28, v25
    v_sub_f32 v28, 0, v28
    v_exp_f32 v28, v28
    s_nop 0
    v_add_f32 v28, 1.0, v28
    v_rcp_f32 v28, v28
    s_nop 0
    v_mul_f32 v25, v25, v28

    v_cvt_pk_bf16_f32 v26, v26, v26
    v_lshlrev_b32 v26, 16, v26
    v_mul_f32 v28, s28, v26
    v_sub_f32 v28, 0, v28
    v_exp_f32 v28, v28
    s_nop 0
    v_add_f32 v28, 1.0, v28
    v_rcp_f32 v28, v28
    s_nop 0
    v_mul_f32 v26, v26, v28

    v_cvt_pk_bf16_f32 v27, v27, v27
    v_lshlrev_b32 v27, 16, v27
    v_mul_f32 v28, s28, v27
    v_sub_f32 v28, 0, v28
    v_exp_f32 v28, v28
    s_nop 0
    v_add_f32 v28, 1.0, v28
    v_rcp_f32 v28, v28
    s_nop 0
    v_mul_f32 v27, v27, v28

    v_cvt_pk_bf16_f32 v30, v24, v25
    v_cvt_pk_bf16_f32 v31, v26, v27
    v_add_u32 v29, 0, v9
    buffer_store_dwordx2 v[30:31], v29, s[8:11], 0 offen

    v_accvgpr_read_b32 v24, a68
    v_accvgpr_read_b32 v25, a69
    v_accvgpr_read_b32 v26, a70
    v_accvgpr_read_b32 v27, a71
    v_cvt_pk_bf16_f32 v24, v24, v24
    v_lshlrev_b32 v24, 16, v24
    v_mul_f32 v28, s28, v24
    v_sub_f32 v28, 0, v28
    v_exp_f32 v28, v28
    s_nop 0
    v_add_f32 v28, 1.0, v28
    v_rcp_f32 v28, v28
    s_nop 0
    v_mul_f32 v24, v24, v28

    v_cvt_pk_bf16_f32 v25, v25, v25
    v_lshlrev_b32 v25, 16, v25
    v_mul_f32 v28, s28, v25
    v_sub_f32 v28, 0, v28
    v_exp_f32 v28, v28
    s_nop 0
    v_add_f32 v28, 1.0, v28
    v_rcp_f32 v28, v28
    s_nop 0
    v_mul_f32 v25, v25, v28

    v_cvt_pk_bf16_f32 v26, v26, v26
    v_lshlrev_b32 v26, 16, v26
    v_mul_f32 v28, s28, v26
    v_sub_f32 v28, 0, v28
    v_exp_f32 v28, v28
    s_nop 0
    v_add_f32 v28, 1.0, v28
    v_rcp_f32 v28, v28
    s_nop 0
    v_mul_f32 v26, v26, v28

    v_cvt_pk_bf16_f32 v27, v27, v27
    v_lshlrev_b32 v27, 16, v27
    v_mul_f32 v28, s28, v27
    v_sub_f32 v28, 0, v28
    v_exp_f32 v28, v28
    s_nop 0
    v_add_f32 v28, 1.0, v28
    v_rcp_f32 v28, v28
    s_nop 0
    v_mul_f32 v27, v27, v28

    v_cvt_pk_bf16_f32 v30, v24, v25
    v_cvt_pk_bf16_f32 v31, v26, v27
    v_add_u32 v29, 2048, v9
    buffer_store_dwordx2 v[30:31], v29, s[8:11], 0 offen

    v_accvgpr_read_b32 v24, a72
    v_accvgpr_read_b32 v25, a73
    v_accvgpr_read_b32 v26, a74
    v_accvgpr_read_b32 v27, a75
    v_cvt_pk_bf16_f32 v24, v24, v24
    v_lshlrev_b32 v24, 16, v24
    v_mul_f32 v28, s28, v24
    v_sub_f32 v28, 0, v28
    v_exp_f32 v28, v28
    s_nop 0
    v_add_f32 v28, 1.0, v28
    v_rcp_f32 v28, v28
    s_nop 0
    v_mul_f32 v24, v24, v28

    v_cvt_pk_bf16_f32 v25, v25, v25
    v_lshlrev_b32 v25, 16, v25
    v_mul_f32 v28, s28, v25
    v_sub_f32 v28, 0, v28
    v_exp_f32 v28, v28
    s_nop 0
    v_add_f32 v28, 1.0, v28
    v_rcp_f32 v28, v28
    s_nop 0
    v_mul_f32 v25, v25, v28

    v_cvt_pk_bf16_f32 v26, v26, v26
    v_lshlrev_b32 v26, 16, v26
    v_mul_f32 v28, s28, v26
    v_sub_f32 v28, 0, v28
    v_exp_f32 v28, v28
    s_nop 0
    v_add_f32 v28, 1.0, v28
    v_rcp_f32 v28, v28
    s_nop 0
    v_mul_f32 v26, v26, v28

    v_cvt_pk_bf16_f32 v27, v27, v27
    v_lshlrev_b32 v27, 16, v27
    v_mul_f32 v28, s28, v27
    v_sub_f32 v28, 0, v28
    v_exp_f32 v28, v28
    s_nop 0
    v_add_f32 v28, 1.0, v28
    v_rcp_f32 v28, v28
    s_nop 0
    v_mul_f32 v27, v27, v28

    v_cvt_pk_bf16_f32 v30, v24, v25
    v_cvt_pk_bf16_f32 v31, v26, v27
    v_add_u32 v29, 4096, v9
    buffer_store_dwordx2 v[30:31], v29, s[8:11], 0 offen

    v_accvgpr_read_b32 v24, a76
    v_accvgpr_read_b32 v25, a77
    v_accvgpr_read_b32 v26, a78
    v_accvgpr_read_b32 v27, a79
    v_cvt_pk_bf16_f32 v24, v24, v24
    v_lshlrev_b32 v24, 16, v24
    v_mul_f32 v28, s28, v24
    v_sub_f32 v28, 0, v28
    v_exp_f32 v28, v28
    s_nop 0
    v_add_f32 v28, 1.0, v28
    v_rcp_f32 v28, v28
    s_nop 0
    v_mul_f32 v24, v24, v28

    v_cvt_pk_bf16_f32 v25, v25, v25
    v_lshlrev_b32 v25, 16, v25
    v_mul_f32 v28, s28, v25
    v_sub_f32 v28, 0, v28
    v_exp_f32 v28, v28
    s_nop 0
    v_add_f32 v28, 1.0, v28
    v_rcp_f32 v28, v28
    s_nop 0
    v_mul_f32 v25, v25, v28

    v_cvt_pk_bf16_f32 v26, v26, v26
    v_lshlrev_b32 v26, 16, v26
    v_mul_f32 v28, s28, v26
    v_sub_f32 v28, 0, v28
    v_exp_f32 v28, v28
    s_nop 0
    v_add_f32 v28, 1.0, v28
    v_rcp_f32 v28, v28
    s_nop 0
    v_mul_f32 v26, v26, v28

    v_cvt_pk_bf16_f32 v27, v27, v27
    v_lshlrev_b32 v27, 16, v27
    v_mul_f32 v28, s28, v27
    v_sub_f32 v28, 0, v28
    v_exp_f32 v28, v28
    s_nop 0
    v_add_f32 v28, 1.0, v28
    v_rcp_f32 v28, v28
    s_nop 0
    v_mul_f32 v27, v27, v28

    v_cvt_pk_bf16_f32 v30, v24, v25
    v_cvt_pk_bf16_f32 v31, v26, v27
    v_add_u32 v29, 6144, v9
    buffer_store_dwordx2 v[30:31], v29, s[8:11], 0 offen

    s_add_u32 s31, s29, 80
    s_lshr_b32 s32, s31, 6
    s_lshl_b32 s32, s32, 14
    s_lshr_b32 s33, s31, 3
    s_and_b32 s33, s33, 7
    s_lshl_b32 s33, s33, 4
    v_xor_b32 v9, s33, v7
    v_add3_u32 v9, v9, v8, s32

    v_accvgpr_read_b32 v24, a80
    v_accvgpr_read_b32 v25, a81
    v_accvgpr_read_b32 v26, a82
    v_accvgpr_read_b32 v27, a83
    v_cvt_pk_bf16_f32 v24, v24, v24
    v_lshlrev_b32 v24, 16, v24
    v_mul_f32 v28, s28, v24
    v_sub_f32 v28, 0, v28
    v_exp_f32 v28, v28
    s_nop 0
    v_add_f32 v28, 1.0, v28
    v_rcp_f32 v28, v28
    s_nop 0
    v_mul_f32 v24, v24, v28

    v_cvt_pk_bf16_f32 v25, v25, v25
    v_lshlrev_b32 v25, 16, v25
    v_mul_f32 v28, s28, v25
    v_sub_f32 v28, 0, v28
    v_exp_f32 v28, v28
    s_nop 0
    v_add_f32 v28, 1.0, v28
    v_rcp_f32 v28, v28
    s_nop 0
    v_mul_f32 v25, v25, v28

    v_cvt_pk_bf16_f32 v26, v26, v26
    v_lshlrev_b32 v26, 16, v26
    v_mul_f32 v28, s28, v26
    v_sub_f32 v28, 0, v28
    v_exp_f32 v28, v28
    s_nop 0
    v_add_f32 v28, 1.0, v28
    v_rcp_f32 v28, v28
    s_nop 0
    v_mul_f32 v26, v26, v28

    v_cvt_pk_bf16_f32 v27, v27, v27
    v_lshlrev_b32 v27, 16, v27
    v_mul_f32 v28, s28, v27
    v_sub_f32 v28, 0, v28
    v_exp_f32 v28, v28
    s_nop 0
    v_add_f32 v28, 1.0, v28
    v_rcp_f32 v28, v28
    s_nop 0
    v_mul_f32 v27, v27, v28

    v_cvt_pk_bf16_f32 v30, v24, v25
    v_cvt_pk_bf16_f32 v31, v26, v27
    v_add_u32 v29, 0, v9
    buffer_store_dwordx2 v[30:31], v29, s[8:11], 0 offen

    v_accvgpr_read_b32 v24, a84
    v_accvgpr_read_b32 v25, a85
    v_accvgpr_read_b32 v26, a86
    v_accvgpr_read_b32 v27, a87
    v_cvt_pk_bf16_f32 v24, v24, v24
    v_lshlrev_b32 v24, 16, v24
    v_mul_f32 v28, s28, v24
    v_sub_f32 v28, 0, v28
    v_exp_f32 v28, v28
    s_nop 0
    v_add_f32 v28, 1.0, v28
    v_rcp_f32 v28, v28
    s_nop 0
    v_mul_f32 v24, v24, v28

    v_cvt_pk_bf16_f32 v25, v25, v25
    v_lshlrev_b32 v25, 16, v25
    v_mul_f32 v28, s28, v25
    v_sub_f32 v28, 0, v28
    v_exp_f32 v28, v28
    s_nop 0
    v_add_f32 v28, 1.0, v28
    v_rcp_f32 v28, v28
    s_nop 0
    v_mul_f32 v25, v25, v28

    v_cvt_pk_bf16_f32 v26, v26, v26
    v_lshlrev_b32 v26, 16, v26
    v_mul_f32 v28, s28, v26
    v_sub_f32 v28, 0, v28
    v_exp_f32 v28, v28
    s_nop 0
    v_add_f32 v28, 1.0, v28
    v_rcp_f32 v28, v28
    s_nop 0
    v_mul_f32 v26, v26, v28

    v_cvt_pk_bf16_f32 v27, v27, v27
    v_lshlrev_b32 v27, 16, v27
    v_mul_f32 v28, s28, v27
    v_sub_f32 v28, 0, v28
    v_exp_f32 v28, v28
    s_nop 0
    v_add_f32 v28, 1.0, v28
    v_rcp_f32 v28, v28
    s_nop 0
    v_mul_f32 v27, v27, v28

    v_cvt_pk_bf16_f32 v30, v24, v25
    v_cvt_pk_bf16_f32 v31, v26, v27
    v_add_u32 v29, 2048, v9
    buffer_store_dwordx2 v[30:31], v29, s[8:11], 0 offen

    v_accvgpr_read_b32 v24, a88
    v_accvgpr_read_b32 v25, a89
    v_accvgpr_read_b32 v26, a90
    v_accvgpr_read_b32 v27, a91
    v_cvt_pk_bf16_f32 v24, v24, v24
    v_lshlrev_b32 v24, 16, v24
    v_mul_f32 v28, s28, v24
    v_sub_f32 v28, 0, v28
    v_exp_f32 v28, v28
    s_nop 0
    v_add_f32 v28, 1.0, v28
    v_rcp_f32 v28, v28
    s_nop 0
    v_mul_f32 v24, v24, v28

    v_cvt_pk_bf16_f32 v25, v25, v25
    v_lshlrev_b32 v25, 16, v25
    v_mul_f32 v28, s28, v25
    v_sub_f32 v28, 0, v28
    v_exp_f32 v28, v28
    s_nop 0
    v_add_f32 v28, 1.0, v28
    v_rcp_f32 v28, v28
    s_nop 0
    v_mul_f32 v25, v25, v28

    v_cvt_pk_bf16_f32 v26, v26, v26
    v_lshlrev_b32 v26, 16, v26
    v_mul_f32 v28, s28, v26
    v_sub_f32 v28, 0, v28
    v_exp_f32 v28, v28
    s_nop 0
    v_add_f32 v28, 1.0, v28
    v_rcp_f32 v28, v28
    s_nop 0
    v_mul_f32 v26, v26, v28

    v_cvt_pk_bf16_f32 v27, v27, v27
    v_lshlrev_b32 v27, 16, v27
    v_mul_f32 v28, s28, v27
    v_sub_f32 v28, 0, v28
    v_exp_f32 v28, v28
    s_nop 0
    v_add_f32 v28, 1.0, v28
    v_rcp_f32 v28, v28
    s_nop 0
    v_mul_f32 v27, v27, v28

    v_cvt_pk_bf16_f32 v30, v24, v25
    v_cvt_pk_bf16_f32 v31, v26, v27
    v_add_u32 v29, 4096, v9
    buffer_store_dwordx2 v[30:31], v29, s[8:11], 0 offen

    v_accvgpr_read_b32 v24, a92
    v_accvgpr_read_b32 v25, a93
    v_accvgpr_read_b32 v26, a94
    v_accvgpr_read_b32 v27, a95
    v_cvt_pk_bf16_f32 v24, v24, v24
    v_lshlrev_b32 v24, 16, v24
    v_mul_f32 v28, s28, v24
    v_sub_f32 v28, 0, v28
    v_exp_f32 v28, v28
    s_nop 0
    v_add_f32 v28, 1.0, v28
    v_rcp_f32 v28, v28
    s_nop 0
    v_mul_f32 v24, v24, v28

    v_cvt_pk_bf16_f32 v25, v25, v25
    v_lshlrev_b32 v25, 16, v25
    v_mul_f32 v28, s28, v25
    v_sub_f32 v28, 0, v28
    v_exp_f32 v28, v28
    s_nop 0
    v_add_f32 v28, 1.0, v28
    v_rcp_f32 v28, v28
    s_nop 0
    v_mul_f32 v25, v25, v28

    v_cvt_pk_bf16_f32 v26, v26, v26
    v_lshlrev_b32 v26, 16, v26
    v_mul_f32 v28, s28, v26
    v_sub_f32 v28, 0, v28
    v_exp_f32 v28, v28
    s_nop 0
    v_add_f32 v28, 1.0, v28
    v_rcp_f32 v28, v28
    s_nop 0
    v_mul_f32 v26, v26, v28

    v_cvt_pk_bf16_f32 v27, v27, v27
    v_lshlrev_b32 v27, 16, v27
    v_mul_f32 v28, s28, v27
    v_sub_f32 v28, 0, v28
    v_exp_f32 v28, v28
    s_nop 0
    v_add_f32 v28, 1.0, v28
    v_rcp_f32 v28, v28
    s_nop 0
    v_mul_f32 v27, v27, v28

    v_cvt_pk_bf16_f32 v30, v24, v25
    v_cvt_pk_bf16_f32 v31, v26, v27
    v_add_u32 v29, 6144, v9
    buffer_store_dwordx2 v[30:31], v29, s[8:11], 0 offen

    s_add_u32 s31, s29, 96
    s_lshr_b32 s32, s31, 6
    s_lshl_b32 s32, s32, 14
    s_lshr_b32 s33, s31, 3
    s_and_b32 s33, s33, 7
    s_lshl_b32 s33, s33, 4
    v_xor_b32 v9, s33, v7
    v_add3_u32 v9, v9, v8, s32

    v_accvgpr_read_b32 v24, a96
    v_accvgpr_read_b32 v25, a97
    v_accvgpr_read_b32 v26, a98
    v_accvgpr_read_b32 v27, a99
    v_cvt_pk_bf16_f32 v24, v24, v24
    v_lshlrev_b32 v24, 16, v24
    v_mul_f32 v28, s28, v24
    v_sub_f32 v28, 0, v28
    v_exp_f32 v28, v28
    s_nop 0
    v_add_f32 v28, 1.0, v28
    v_rcp_f32 v28, v28
    s_nop 0
    v_mul_f32 v24, v24, v28

    v_cvt_pk_bf16_f32 v25, v25, v25
    v_lshlrev_b32 v25, 16, v25
    v_mul_f32 v28, s28, v25
    v_sub_f32 v28, 0, v28
    v_exp_f32 v28, v28
    s_nop 0
    v_add_f32 v28, 1.0, v28
    v_rcp_f32 v28, v28
    s_nop 0
    v_mul_f32 v25, v25, v28

    v_cvt_pk_bf16_f32 v26, v26, v26
    v_lshlrev_b32 v26, 16, v26
    v_mul_f32 v28, s28, v26
    v_sub_f32 v28, 0, v28
    v_exp_f32 v28, v28
    s_nop 0
    v_add_f32 v28, 1.0, v28
    v_rcp_f32 v28, v28
    s_nop 0
    v_mul_f32 v26, v26, v28

    v_cvt_pk_bf16_f32 v27, v27, v27
    v_lshlrev_b32 v27, 16, v27
    v_mul_f32 v28, s28, v27
    v_sub_f32 v28, 0, v28
    v_exp_f32 v28, v28
    s_nop 0
    v_add_f32 v28, 1.0, v28
    v_rcp_f32 v28, v28
    s_nop 0
    v_mul_f32 v27, v27, v28

    v_cvt_pk_bf16_f32 v30, v24, v25
    v_cvt_pk_bf16_f32 v31, v26, v27
    v_add_u32 v29, 0, v9
    buffer_store_dwordx2 v[30:31], v29, s[8:11], 0 offen

    v_accvgpr_read_b32 v24, a100
    v_accvgpr_read_b32 v25, a101
    v_accvgpr_read_b32 v26, a102
    v_accvgpr_read_b32 v27, a103
    v_cvt_pk_bf16_f32 v24, v24, v24
    v_lshlrev_b32 v24, 16, v24
    v_mul_f32 v28, s28, v24
    v_sub_f32 v28, 0, v28
    v_exp_f32 v28, v28
    s_nop 0
    v_add_f32 v28, 1.0, v28
    v_rcp_f32 v28, v28
    s_nop 0
    v_mul_f32 v24, v24, v28

    v_cvt_pk_bf16_f32 v25, v25, v25
    v_lshlrev_b32 v25, 16, v25
    v_mul_f32 v28, s28, v25
    v_sub_f32 v28, 0, v28
    v_exp_f32 v28, v28
    s_nop 0
    v_add_f32 v28, 1.0, v28
    v_rcp_f32 v28, v28
    s_nop 0
    v_mul_f32 v25, v25, v28

    v_cvt_pk_bf16_f32 v26, v26, v26
    v_lshlrev_b32 v26, 16, v26
    v_mul_f32 v28, s28, v26
    v_sub_f32 v28, 0, v28
    v_exp_f32 v28, v28
    s_nop 0
    v_add_f32 v28, 1.0, v28
    v_rcp_f32 v28, v28
    s_nop 0
    v_mul_f32 v26, v26, v28

    v_cvt_pk_bf16_f32 v27, v27, v27
    v_lshlrev_b32 v27, 16, v27
    v_mul_f32 v28, s28, v27
    v_sub_f32 v28, 0, v28
    v_exp_f32 v28, v28
    s_nop 0
    v_add_f32 v28, 1.0, v28
    v_rcp_f32 v28, v28
    s_nop 0
    v_mul_f32 v27, v27, v28

    v_cvt_pk_bf16_f32 v30, v24, v25
    v_cvt_pk_bf16_f32 v31, v26, v27
    v_add_u32 v29, 2048, v9
    buffer_store_dwordx2 v[30:31], v29, s[8:11], 0 offen

    v_accvgpr_read_b32 v24, a104
    v_accvgpr_read_b32 v25, a105
    v_accvgpr_read_b32 v26, a106
    v_accvgpr_read_b32 v27, a107
    v_cvt_pk_bf16_f32 v24, v24, v24
    v_lshlrev_b32 v24, 16, v24
    v_mul_f32 v28, s28, v24
    v_sub_f32 v28, 0, v28
    v_exp_f32 v28, v28
    s_nop 0
    v_add_f32 v28, 1.0, v28
    v_rcp_f32 v28, v28
    s_nop 0
    v_mul_f32 v24, v24, v28

    v_cvt_pk_bf16_f32 v25, v25, v25
    v_lshlrev_b32 v25, 16, v25
    v_mul_f32 v28, s28, v25
    v_sub_f32 v28, 0, v28
    v_exp_f32 v28, v28
    s_nop 0
    v_add_f32 v28, 1.0, v28
    v_rcp_f32 v28, v28
    s_nop 0
    v_mul_f32 v25, v25, v28

    v_cvt_pk_bf16_f32 v26, v26, v26
    v_lshlrev_b32 v26, 16, v26
    v_mul_f32 v28, s28, v26
    v_sub_f32 v28, 0, v28
    v_exp_f32 v28, v28
    s_nop 0
    v_add_f32 v28, 1.0, v28
    v_rcp_f32 v28, v28
    s_nop 0
    v_mul_f32 v26, v26, v28

    v_cvt_pk_bf16_f32 v27, v27, v27
    v_lshlrev_b32 v27, 16, v27
    v_mul_f32 v28, s28, v27
    v_sub_f32 v28, 0, v28
    v_exp_f32 v28, v28
    s_nop 0
    v_add_f32 v28, 1.0, v28
    v_rcp_f32 v28, v28
    s_nop 0
    v_mul_f32 v27, v27, v28

    v_cvt_pk_bf16_f32 v30, v24, v25
    v_cvt_pk_bf16_f32 v31, v26, v27
    v_add_u32 v29, 4096, v9
    buffer_store_dwordx2 v[30:31], v29, s[8:11], 0 offen

    v_accvgpr_read_b32 v24, a108
    v_accvgpr_read_b32 v25, a109
    v_accvgpr_read_b32 v26, a110
    v_accvgpr_read_b32 v27, a111
    v_cvt_pk_bf16_f32 v24, v24, v24
    v_lshlrev_b32 v24, 16, v24
    v_mul_f32 v28, s28, v24
    v_sub_f32 v28, 0, v28
    v_exp_f32 v28, v28
    s_nop 0
    v_add_f32 v28, 1.0, v28
    v_rcp_f32 v28, v28
    s_nop 0
    v_mul_f32 v24, v24, v28

    v_cvt_pk_bf16_f32 v25, v25, v25
    v_lshlrev_b32 v25, 16, v25
    v_mul_f32 v28, s28, v25
    v_sub_f32 v28, 0, v28
    v_exp_f32 v28, v28
    s_nop 0
    v_add_f32 v28, 1.0, v28
    v_rcp_f32 v28, v28
    s_nop 0
    v_mul_f32 v25, v25, v28

    v_cvt_pk_bf16_f32 v26, v26, v26
    v_lshlrev_b32 v26, 16, v26
    v_mul_f32 v28, s28, v26
    v_sub_f32 v28, 0, v28
    v_exp_f32 v28, v28
    s_nop 0
    v_add_f32 v28, 1.0, v28
    v_rcp_f32 v28, v28
    s_nop 0
    v_mul_f32 v26, v26, v28

    v_cvt_pk_bf16_f32 v27, v27, v27
    v_lshlrev_b32 v27, 16, v27
    v_mul_f32 v28, s28, v27
    v_sub_f32 v28, 0, v28
    v_exp_f32 v28, v28
    s_nop 0
    v_add_f32 v28, 1.0, v28
    v_rcp_f32 v28, v28
    s_nop 0
    v_mul_f32 v27, v27, v28

    v_cvt_pk_bf16_f32 v30, v24, v25
    v_cvt_pk_bf16_f32 v31, v26, v27
    v_add_u32 v29, 6144, v9
    buffer_store_dwordx2 v[30:31], v29, s[8:11], 0 offen

    s_add_u32 s31, s29, 112
    s_lshr_b32 s32, s31, 6
    s_lshl_b32 s32, s32, 14
    s_lshr_b32 s33, s31, 3
    s_and_b32 s33, s33, 7
    s_lshl_b32 s33, s33, 4
    v_xor_b32 v9, s33, v7
    v_add3_u32 v9, v9, v8, s32

    v_accvgpr_read_b32 v24, a112
    v_accvgpr_read_b32 v25, a113
    v_accvgpr_read_b32 v26, a114
    v_accvgpr_read_b32 v27, a115
    v_cvt_pk_bf16_f32 v24, v24, v24
    v_lshlrev_b32 v24, 16, v24
    v_mul_f32 v28, s28, v24
    v_sub_f32 v28, 0, v28
    v_exp_f32 v28, v28
    s_nop 0
    v_add_f32 v28, 1.0, v28
    v_rcp_f32 v28, v28
    s_nop 0
    v_mul_f32 v24, v24, v28

    v_cvt_pk_bf16_f32 v25, v25, v25
    v_lshlrev_b32 v25, 16, v25
    v_mul_f32 v28, s28, v25
    v_sub_f32 v28, 0, v28
    v_exp_f32 v28, v28
    s_nop 0
    v_add_f32 v28, 1.0, v28
    v_rcp_f32 v28, v28
    s_nop 0
    v_mul_f32 v25, v25, v28

    v_cvt_pk_bf16_f32 v26, v26, v26
    v_lshlrev_b32 v26, 16, v26
    v_mul_f32 v28, s28, v26
    v_sub_f32 v28, 0, v28
    v_exp_f32 v28, v28
    s_nop 0
    v_add_f32 v28, 1.0, v28
    v_rcp_f32 v28, v28
    s_nop 0
    v_mul_f32 v26, v26, v28

    v_cvt_pk_bf16_f32 v27, v27, v27
    v_lshlrev_b32 v27, 16, v27
    v_mul_f32 v28, s28, v27
    v_sub_f32 v28, 0, v28
    v_exp_f32 v28, v28
    s_nop 0
    v_add_f32 v28, 1.0, v28
    v_rcp_f32 v28, v28
    s_nop 0
    v_mul_f32 v27, v27, v28

    v_cvt_pk_bf16_f32 v30, v24, v25
    v_cvt_pk_bf16_f32 v31, v26, v27
    v_add_u32 v29, 0, v9
    buffer_store_dwordx2 v[30:31], v29, s[8:11], 0 offen

    v_accvgpr_read_b32 v24, a116
    v_accvgpr_read_b32 v25, a117
    v_accvgpr_read_b32 v26, a118
    v_accvgpr_read_b32 v27, a119
    v_cvt_pk_bf16_f32 v24, v24, v24
    v_lshlrev_b32 v24, 16, v24
    v_mul_f32 v28, s28, v24
    v_sub_f32 v28, 0, v28
    v_exp_f32 v28, v28
    s_nop 0
    v_add_f32 v28, 1.0, v28
    v_rcp_f32 v28, v28
    s_nop 0
    v_mul_f32 v24, v24, v28

    v_cvt_pk_bf16_f32 v25, v25, v25
    v_lshlrev_b32 v25, 16, v25
    v_mul_f32 v28, s28, v25
    v_sub_f32 v28, 0, v28
    v_exp_f32 v28, v28
    s_nop 0
    v_add_f32 v28, 1.0, v28
    v_rcp_f32 v28, v28
    s_nop 0
    v_mul_f32 v25, v25, v28

    v_cvt_pk_bf16_f32 v26, v26, v26
    v_lshlrev_b32 v26, 16, v26
    v_mul_f32 v28, s28, v26
    v_sub_f32 v28, 0, v28
    v_exp_f32 v28, v28
    s_nop 0
    v_add_f32 v28, 1.0, v28
    v_rcp_f32 v28, v28
    s_nop 0
    v_mul_f32 v26, v26, v28

    v_cvt_pk_bf16_f32 v27, v27, v27
    v_lshlrev_b32 v27, 16, v27
    v_mul_f32 v28, s28, v27
    v_sub_f32 v28, 0, v28
    v_exp_f32 v28, v28
    s_nop 0
    v_add_f32 v28, 1.0, v28
    v_rcp_f32 v28, v28
    s_nop 0
    v_mul_f32 v27, v27, v28

    v_cvt_pk_bf16_f32 v30, v24, v25
    v_cvt_pk_bf16_f32 v31, v26, v27
    v_add_u32 v29, 2048, v9
    buffer_store_dwordx2 v[30:31], v29, s[8:11], 0 offen

    v_accvgpr_read_b32 v24, a120
    v_accvgpr_read_b32 v25, a121
    v_accvgpr_read_b32 v26, a122
    v_accvgpr_read_b32 v27, a123
    v_cvt_pk_bf16_f32 v24, v24, v24
    v_lshlrev_b32 v24, 16, v24
    v_mul_f32 v28, s28, v24
    v_sub_f32 v28, 0, v28
    v_exp_f32 v28, v28
    s_nop 0
    v_add_f32 v28, 1.0, v28
    v_rcp_f32 v28, v28
    s_nop 0
    v_mul_f32 v24, v24, v28

    v_cvt_pk_bf16_f32 v25, v25, v25
    v_lshlrev_b32 v25, 16, v25
    v_mul_f32 v28, s28, v25
    v_sub_f32 v28, 0, v28
    v_exp_f32 v28, v28
    s_nop 0
    v_add_f32 v28, 1.0, v28
    v_rcp_f32 v28, v28
    s_nop 0
    v_mul_f32 v25, v25, v28

    v_cvt_pk_bf16_f32 v26, v26, v26
    v_lshlrev_b32 v26, 16, v26
    v_mul_f32 v28, s28, v26
    v_sub_f32 v28, 0, v28
    v_exp_f32 v28, v28
    s_nop 0
    v_add_f32 v28, 1.0, v28
    v_rcp_f32 v28, v28
    s_nop 0
    v_mul_f32 v26, v26, v28

    v_cvt_pk_bf16_f32 v27, v27, v27
    v_lshlrev_b32 v27, 16, v27
    v_mul_f32 v28, s28, v27
    v_sub_f32 v28, 0, v28
    v_exp_f32 v28, v28
    s_nop 0
    v_add_f32 v28, 1.0, v28
    v_rcp_f32 v28, v28
    s_nop 0
    v_mul_f32 v27, v27, v28

    v_cvt_pk_bf16_f32 v30, v24, v25
    v_cvt_pk_bf16_f32 v31, v26, v27
    v_add_u32 v29, 4096, v9
    buffer_store_dwordx2 v[30:31], v29, s[8:11], 0 offen

    v_accvgpr_read_b32 v24, a124
    v_accvgpr_read_b32 v25, a125
    v_accvgpr_read_b32 v26, a126
    v_accvgpr_read_b32 v27, a127
    v_cvt_pk_bf16_f32 v24, v24, v24
    v_lshlrev_b32 v24, 16, v24
    v_mul_f32 v28, s28, v24
    v_sub_f32 v28, 0, v28
    v_exp_f32 v28, v28
    s_nop 0
    v_add_f32 v28, 1.0, v28
    v_rcp_f32 v28, v28
    s_nop 0
    v_mul_f32 v24, v24, v28

    v_cvt_pk_bf16_f32 v25, v25, v25
    v_lshlrev_b32 v25, 16, v25
    v_mul_f32 v28, s28, v25
    v_sub_f32 v28, 0, v28
    v_exp_f32 v28, v28
    s_nop 0
    v_add_f32 v28, 1.0, v28
    v_rcp_f32 v28, v28
    s_nop 0
    v_mul_f32 v25, v25, v28

    v_cvt_pk_bf16_f32 v26, v26, v26
    v_lshlrev_b32 v26, 16, v26
    v_mul_f32 v28, s28, v26
    v_sub_f32 v28, 0, v28
    v_exp_f32 v28, v28
    s_nop 0
    v_add_f32 v28, 1.0, v28
    v_rcp_f32 v28, v28
    s_nop 0
    v_mul_f32 v26, v26, v28

    v_cvt_pk_bf16_f32 v27, v27, v27
    v_lshlrev_b32 v27, 16, v27
    v_mul_f32 v28, s28, v27
    v_sub_f32 v28, 0, v28
    v_exp_f32 v28, v28
    s_nop 0
    v_add_f32 v28, 1.0, v28
    v_rcp_f32 v28, v28
    s_nop 0
    v_mul_f32 v27, v27, v28

    v_cvt_pk_bf16_f32 v30, v24, v25
    v_cvt_pk_bf16_f32 v31, v26, v27
    v_add_u32 v29, 6144, v9
    buffer_store_dwordx2 v[30:31], v29, s[8:11], 0 offen

    s_add_u32 s31, s29, 128
    s_lshr_b32 s32, s31, 6
    s_lshl_b32 s32, s32, 14
    s_lshr_b32 s33, s31, 3
    s_and_b32 s33, s33, 7
    s_lshl_b32 s33, s33, 4
    v_xor_b32 v9, s33, v7
    v_add3_u32 v9, v9, v8, s32

    v_accvgpr_read_b32 v24, a128
    v_accvgpr_read_b32 v25, a129
    v_accvgpr_read_b32 v26, a130
    v_accvgpr_read_b32 v27, a131
    v_cvt_pk_bf16_f32 v24, v24, v24
    v_lshlrev_b32 v24, 16, v24
    v_mul_f32 v28, s28, v24
    v_sub_f32 v28, 0, v28
    v_exp_f32 v28, v28
    s_nop 0
    v_add_f32 v28, 1.0, v28
    v_rcp_f32 v28, v28
    s_nop 0
    v_mul_f32 v24, v24, v28

    v_cvt_pk_bf16_f32 v25, v25, v25
    v_lshlrev_b32 v25, 16, v25
    v_mul_f32 v28, s28, v25
    v_sub_f32 v28, 0, v28
    v_exp_f32 v28, v28
    s_nop 0
    v_add_f32 v28, 1.0, v28
    v_rcp_f32 v28, v28
    s_nop 0
    v_mul_f32 v25, v25, v28

    v_cvt_pk_bf16_f32 v26, v26, v26
    v_lshlrev_b32 v26, 16, v26
    v_mul_f32 v28, s28, v26
    v_sub_f32 v28, 0, v28
    v_exp_f32 v28, v28
    s_nop 0
    v_add_f32 v28, 1.0, v28
    v_rcp_f32 v28, v28
    s_nop 0
    v_mul_f32 v26, v26, v28

    v_cvt_pk_bf16_f32 v27, v27, v27
    v_lshlrev_b32 v27, 16, v27
    v_mul_f32 v28, s28, v27
    v_sub_f32 v28, 0, v28
    v_exp_f32 v28, v28
    s_nop 0
    v_add_f32 v28, 1.0, v28
    v_rcp_f32 v28, v28
    s_nop 0
    v_mul_f32 v27, v27, v28

    v_cvt_pk_bf16_f32 v30, v24, v25
    v_cvt_pk_bf16_f32 v31, v26, v27
    v_add_u32 v29, 0, v9
    buffer_store_dwordx2 v[30:31], v29, s[8:11], 0 offen

    v_accvgpr_read_b32 v24, a132
    v_accvgpr_read_b32 v25, a133
    v_accvgpr_read_b32 v26, a134
    v_accvgpr_read_b32 v27, a135
    v_cvt_pk_bf16_f32 v24, v24, v24
    v_lshlrev_b32 v24, 16, v24
    v_mul_f32 v28, s28, v24
    v_sub_f32 v28, 0, v28
    v_exp_f32 v28, v28
    s_nop 0
    v_add_f32 v28, 1.0, v28
    v_rcp_f32 v28, v28
    s_nop 0
    v_mul_f32 v24, v24, v28

    v_cvt_pk_bf16_f32 v25, v25, v25
    v_lshlrev_b32 v25, 16, v25
    v_mul_f32 v28, s28, v25
    v_sub_f32 v28, 0, v28
    v_exp_f32 v28, v28
    s_nop 0
    v_add_f32 v28, 1.0, v28
    v_rcp_f32 v28, v28
    s_nop 0
    v_mul_f32 v25, v25, v28

    v_cvt_pk_bf16_f32 v26, v26, v26
    v_lshlrev_b32 v26, 16, v26
    v_mul_f32 v28, s28, v26
    v_sub_f32 v28, 0, v28
    v_exp_f32 v28, v28
    s_nop 0
    v_add_f32 v28, 1.0, v28
    v_rcp_f32 v28, v28
    s_nop 0
    v_mul_f32 v26, v26, v28

    v_cvt_pk_bf16_f32 v27, v27, v27
    v_lshlrev_b32 v27, 16, v27
    v_mul_f32 v28, s28, v27
    v_sub_f32 v28, 0, v28
    v_exp_f32 v28, v28
    s_nop 0
    v_add_f32 v28, 1.0, v28
    v_rcp_f32 v28, v28
    s_nop 0
    v_mul_f32 v27, v27, v28

    v_cvt_pk_bf16_f32 v30, v24, v25
    v_cvt_pk_bf16_f32 v31, v26, v27
    v_add_u32 v29, 2048, v9
    buffer_store_dwordx2 v[30:31], v29, s[8:11], 0 offen

    v_accvgpr_read_b32 v24, a136
    v_accvgpr_read_b32 v25, a137
    v_accvgpr_read_b32 v26, a138
    v_accvgpr_read_b32 v27, a139
    v_cvt_pk_bf16_f32 v24, v24, v24
    v_lshlrev_b32 v24, 16, v24
    v_mul_f32 v28, s28, v24
    v_sub_f32 v28, 0, v28
    v_exp_f32 v28, v28
    s_nop 0
    v_add_f32 v28, 1.0, v28
    v_rcp_f32 v28, v28
    s_nop 0
    v_mul_f32 v24, v24, v28

    v_cvt_pk_bf16_f32 v25, v25, v25
    v_lshlrev_b32 v25, 16, v25
    v_mul_f32 v28, s28, v25
    v_sub_f32 v28, 0, v28
    v_exp_f32 v28, v28
    s_nop 0
    v_add_f32 v28, 1.0, v28
    v_rcp_f32 v28, v28
    s_nop 0
    v_mul_f32 v25, v25, v28

    v_cvt_pk_bf16_f32 v26, v26, v26
    v_lshlrev_b32 v26, 16, v26
    v_mul_f32 v28, s28, v26
    v_sub_f32 v28, 0, v28
    v_exp_f32 v28, v28
    s_nop 0
    v_add_f32 v28, 1.0, v28
    v_rcp_f32 v28, v28
    s_nop 0
    v_mul_f32 v26, v26, v28

    v_cvt_pk_bf16_f32 v27, v27, v27
    v_lshlrev_b32 v27, 16, v27
    v_mul_f32 v28, s28, v27
    v_sub_f32 v28, 0, v28
    v_exp_f32 v28, v28
    s_nop 0
    v_add_f32 v28, 1.0, v28
    v_rcp_f32 v28, v28
    s_nop 0
    v_mul_f32 v27, v27, v28

    v_cvt_pk_bf16_f32 v30, v24, v25
    v_cvt_pk_bf16_f32 v31, v26, v27
    v_add_u32 v29, 4096, v9
    buffer_store_dwordx2 v[30:31], v29, s[8:11], 0 offen

    v_accvgpr_read_b32 v24, a140
    v_accvgpr_read_b32 v25, a141
    v_accvgpr_read_b32 v26, a142
    v_accvgpr_read_b32 v27, a143
    v_cvt_pk_bf16_f32 v24, v24, v24
    v_lshlrev_b32 v24, 16, v24
    v_mul_f32 v28, s28, v24
    v_sub_f32 v28, 0, v28
    v_exp_f32 v28, v28
    s_nop 0
    v_add_f32 v28, 1.0, v28
    v_rcp_f32 v28, v28
    s_nop 0
    v_mul_f32 v24, v24, v28

    v_cvt_pk_bf16_f32 v25, v25, v25
    v_lshlrev_b32 v25, 16, v25
    v_mul_f32 v28, s28, v25
    v_sub_f32 v28, 0, v28
    v_exp_f32 v28, v28
    s_nop 0
    v_add_f32 v28, 1.0, v28
    v_rcp_f32 v28, v28
    s_nop 0
    v_mul_f32 v25, v25, v28

    v_cvt_pk_bf16_f32 v26, v26, v26
    v_lshlrev_b32 v26, 16, v26
    v_mul_f32 v28, s28, v26
    v_sub_f32 v28, 0, v28
    v_exp_f32 v28, v28
    s_nop 0
    v_add_f32 v28, 1.0, v28
    v_rcp_f32 v28, v28
    s_nop 0
    v_mul_f32 v26, v26, v28

    v_cvt_pk_bf16_f32 v27, v27, v27
    v_lshlrev_b32 v27, 16, v27
    v_mul_f32 v28, s28, v27
    v_sub_f32 v28, 0, v28
    v_exp_f32 v28, v28
    s_nop 0
    v_add_f32 v28, 1.0, v28
    v_rcp_f32 v28, v28
    s_nop 0
    v_mul_f32 v27, v27, v28

    v_cvt_pk_bf16_f32 v30, v24, v25
    v_cvt_pk_bf16_f32 v31, v26, v27
    v_add_u32 v29, 6144, v9
    buffer_store_dwordx2 v[30:31], v29, s[8:11], 0 offen

L_g1_end:
    s_endpgm

.globl gemm2_kernel
.p2align 8
.type gemm2_kernel,@function
gemm2_kernel:
    s_cmp_ge_u32 s2, 256
    s_cbranch_scc1 L_g2_end
    s_load_dwordx2 s[4:5], s[0:1], 128
    s_waitcnt lgkmcnt(0)

    s_mov_b32 s8, s4
    s_mov_b32 s9, s5
    s_mov_b32 s10, 268435456
    s_mov_b32 s11, 0x00020000
    v_lshrrev_b32 v1, 6, v0
    s_nop 1
    v_readfirstlane_b32 s12, v1
    s_and_b32 s13, s2, 15
    s_lshr_b32 s14, s2, 4

    s_and_b32 s17, s14, 3
    s_lshr_b32 s18, s14, 2
    s_mul_i32 s15, s13, 1179648
    s_mul_i32 s19, s18, 294912
    s_add_u32 s15, s15, s19
    s_add_u32 s15, s15, 24952832
    s_mul_i32 s16, s17, 1327104
    s_mul_i32 s19, s18, 331776
    s_add_u32 s16, s16, s19
    s_add_u32 s16, s16, 12566528
    s_mul_i32 s19, s12, 9
    s_add_u32 s20, s19, 0
    s_lshl_b32 s21, s20, 10
    s_add_u32 s22, s15, s21
    s_sub_u32 s23, s21, 16384
    s_add_u32 s23, s16, s23
    s_cmp_lt_u32 s20, 16
    s_cselect_b32 s40, s22, s23
    s_mov_b32 s34, 16384
    s_cselect_b32 s56, s34, 18432
    s_cmp_lt_u32 s20, 34
    s_cselect_b32 s72, s21, 104448
    s_cselect_b32 s40, s40, s15
    s_cselect_b32 s56, s56, 0

    s_add_u32 s20, s19, 1
    s_lshl_b32 s21, s20, 10
    s_add_u32 s22, s15, s21
    s_sub_u32 s23, s21, 16384
    s_add_u32 s23, s16, s23
    s_cmp_lt_u32 s20, 16
    s_cselect_b32 s41, s22, s23
    s_mov_b32 s34, 16384
    s_cselect_b32 s57, s34, 18432
    s_cmp_lt_u32 s20, 34
    s_cselect_b32 s73, s21, 104448
    s_cselect_b32 s41, s41, s15
    s_cselect_b32 s57, s57, 0

    s_add_u32 s20, s19, 2
    s_lshl_b32 s21, s20, 10
    s_add_u32 s22, s15, s21
    s_sub_u32 s23, s21, 16384
    s_add_u32 s23, s16, s23
    s_cmp_lt_u32 s20, 16
    s_cselect_b32 s42, s22, s23
    s_mov_b32 s34, 16384
    s_cselect_b32 s58, s34, 18432
    s_cmp_lt_u32 s20, 34
    s_cselect_b32 s74, s21, 104448
    s_cselect_b32 s42, s42, s15
    s_cselect_b32 s58, s58, 0

    s_add_u32 s20, s19, 3
    s_lshl_b32 s21, s20, 10
    s_add_u32 s22, s15, s21
    s_sub_u32 s23, s21, 16384
    s_add_u32 s23, s16, s23
    s_cmp_lt_u32 s20, 16
    s_cselect_b32 s43, s22, s23
    s_mov_b32 s34, 16384
    s_cselect_b32 s59, s34, 18432
    s_cmp_lt_u32 s20, 34
    s_cselect_b32 s75, s21, 104448
    s_cselect_b32 s43, s43, s15
    s_cselect_b32 s59, s59, 0

    s_add_u32 s20, s19, 4
    s_lshl_b32 s21, s20, 10
    s_add_u32 s22, s15, s21
    s_sub_u32 s23, s21, 16384
    s_add_u32 s23, s16, s23
    s_cmp_lt_u32 s20, 16
    s_cselect_b32 s44, s22, s23
    s_mov_b32 s34, 16384
    s_cselect_b32 s60, s34, 18432
    s_cmp_lt_u32 s20, 34
    s_cselect_b32 s76, s21, 104448
    s_cselect_b32 s44, s44, s15
    s_cselect_b32 s60, s60, 0

    s_add_u32 s20, s19, 5
    s_lshl_b32 s21, s20, 10
    s_add_u32 s22, s15, s21
    s_sub_u32 s23, s21, 16384
    s_add_u32 s23, s16, s23
    s_cmp_lt_u32 s20, 16
    s_cselect_b32 s45, s22, s23
    s_mov_b32 s34, 16384
    s_cselect_b32 s61, s34, 18432
    s_cmp_lt_u32 s20, 34
    s_cselect_b32 s77, s21, 104448
    s_cselect_b32 s45, s45, s15
    s_cselect_b32 s61, s61, 0

    s_add_u32 s20, s19, 6
    s_lshl_b32 s21, s20, 10
    s_add_u32 s22, s15, s21
    s_sub_u32 s23, s21, 16384
    s_add_u32 s23, s16, s23
    s_cmp_lt_u32 s20, 16
    s_cselect_b32 s46, s22, s23
    s_mov_b32 s34, 16384
    s_cselect_b32 s62, s34, 18432
    s_cmp_lt_u32 s20, 34
    s_cselect_b32 s78, s21, 104448
    s_cselect_b32 s46, s46, s15
    s_cselect_b32 s62, s62, 0

    s_add_u32 s20, s19, 7
    s_lshl_b32 s21, s20, 10
    s_add_u32 s22, s15, s21
    s_sub_u32 s23, s21, 16384
    s_add_u32 s23, s16, s23
    s_cmp_lt_u32 s20, 16
    s_cselect_b32 s47, s22, s23
    s_mov_b32 s34, 16384
    s_cselect_b32 s63, s34, 18432
    s_cmp_lt_u32 s20, 34
    s_cselect_b32 s79, s21, 104448
    s_cselect_b32 s47, s47, s15
    s_cselect_b32 s63, s63, 0

    s_add_u32 s20, s19, 8
    s_lshl_b32 s21, s20, 10
    s_add_u32 s22, s15, s21
    s_sub_u32 s23, s21, 16384
    s_add_u32 s23, s16, s23
    s_cmp_lt_u32 s20, 16
    s_cselect_b32 s48, s22, s23
    s_mov_b32 s34, 16384
    s_cselect_b32 s64, s34, 18432
    s_cmp_lt_u32 s20, 34
    s_cselect_b32 s80, s21, 104448
    s_cselect_b32 s48, s48, s15
    s_cselect_b32 s64, s64, 0

    v_and_b32 v2, 63, v0
    v_lshlrev_b32 v2, 4, v2
    v_and_b32 v3, 15, v0
    v_bfe_u32 v4, v0, 4, 2
    v_lshrrev_b32 v5, 1, v3
    v_xor_b32 v6, v4, v5
    v_lshlrev_b32 v6, 4, v6
    v_lshl_add_u32 v6, v3, 7, v6

    s_mul_i32 s26, s12, 4096
    s_mov_b32 s27, 16384
    v_xor_b32 v10, 0, v6
    v_add_u32 v10, 0, v10
    v_add_u32 v11, s27, v10
    v_add_u32 v10, s26, v10
    v_xor_b32 v12, 64, v6
    v_add_u32 v12, 0, v12
    v_add_u32 v13, s27, v12
    v_add_u32 v12, s26, v12
    v_xor_b32 v14, 0, v6
    v_add_u32 v14, 34816, v14
    v_add_u32 v15, s27, v14
    v_add_u32 v14, s26, v14
    v_xor_b32 v16, 64, v6
    v_add_u32 v16, 34816, v16
    v_add_u32 v17, s27, v16
    v_add_u32 v16, s26, v16
    v_xor_b32 v18, 0, v6
    v_add_u32 v18, 69632, v18
    v_add_u32 v19, s27, v18
    v_add_u32 v18, s26, v18
    v_xor_b32 v20, 64, v6
    v_add_u32 v20, 69632, v20
    v_add_u32 v21, s27, v20
    v_add_u32 v20, s26, v20
    v_accvgpr_write_b32 a0, 0
    v_accvgpr_write_b32 a1, 0
    v_accvgpr_write_b32 a2, 0
    v_accvgpr_write_b32 a3, 0
    v_accvgpr_write_b32 a4, 0
    v_accvgpr_write_b32 a5, 0
    v_accvgpr_write_b32 a6, 0
    v_accvgpr_write_b32 a7, 0
    v_accvgpr_write_b32 a8, 0
    v_accvgpr_write_b32 a9, 0
    v_accvgpr_write_b32 a10, 0
    v_accvgpr_write_b32 a11, 0
    v_accvgpr_write_b32 a12, 0
    v_accvgpr_write_b32 a13, 0
    v_accvgpr_write_b32 a14, 0
    v_accvgpr_write_b32 a15, 0
    v_accvgpr_write_b32 a16, 0
    v_accvgpr_write_b32 a17, 0
    v_accvgpr_write_b32 a18, 0
    v_accvgpr_write_b32 a19, 0
    v_accvgpr_write_b32 a20, 0
    v_accvgpr_write_b32 a21, 0
    v_accvgpr_write_b32 a22, 0
    v_accvgpr_write_b32 a23, 0
    v_accvgpr_write_b32 a24, 0
    v_accvgpr_write_b32 a25, 0
    v_accvgpr_write_b32 a26, 0
    v_accvgpr_write_b32 a27, 0
    v_accvgpr_write_b32 a28, 0
    v_accvgpr_write_b32 a29, 0
    v_accvgpr_write_b32 a30, 0
    v_accvgpr_write_b32 a31, 0
    v_accvgpr_write_b32 a32, 0
    v_accvgpr_write_b32 a33, 0
    v_accvgpr_write_b32 a34, 0
    v_accvgpr_write_b32 a35, 0
    v_accvgpr_write_b32 a36, 0
    v_accvgpr_write_b32 a37, 0
    v_accvgpr_write_b32 a38, 0
    v_accvgpr_write_b32 a39, 0
    v_accvgpr_write_b32 a40, 0
    v_accvgpr_write_b32 a41, 0
    v_accvgpr_write_b32 a42, 0
    v_accvgpr_write_b32 a43, 0
    v_accvgpr_write_b32 a44, 0
    v_accvgpr_write_b32 a45, 0
    v_accvgpr_write_b32 a46, 0
    v_accvgpr_write_b32 a47, 0
    v_accvgpr_write_b32 a48, 0
    v_accvgpr_write_b32 a49, 0
    v_accvgpr_write_b32 a50, 0
    v_accvgpr_write_b32 a51, 0
    v_accvgpr_write_b32 a52, 0
    v_accvgpr_write_b32 a53, 0
    v_accvgpr_write_b32 a54, 0
    v_accvgpr_write_b32 a55, 0
    v_accvgpr_write_b32 a56, 0
    v_accvgpr_write_b32 a57, 0
    v_accvgpr_write_b32 a58, 0
    v_accvgpr_write_b32 a59, 0
    v_accvgpr_write_b32 a60, 0
    v_accvgpr_write_b32 a61, 0
    v_accvgpr_write_b32 a62, 0
    v_accvgpr_write_b32 a63, 0
    v_accvgpr_write_b32 a64, 0
    v_accvgpr_write_b32 a65, 0
    v_accvgpr_write_b32 a66, 0
    v_accvgpr_write_b32 a67, 0
    v_accvgpr_write_b32 a68, 0
    v_accvgpr_write_b32 a69, 0
    v_accvgpr_write_b32 a70, 0
    v_accvgpr_write_b32 a71, 0
    s_add_u32 m0, s72, 0
    s_nop 0
    buffer_load_dwordx4 v2, s[8:11], s40 offen lds
    s_add_u32 s40, s40, s56

    s_add_u32 m0, s73, 0
    s_nop 0
    buffer_load_dwordx4 v2, s[8:11], s41 offen lds
    s_add_u32 s41, s41, s57

    s_add_u32 m0, s74, 0
    s_nop 0
    buffer_load_dwordx4 v2, s[8:11], s42 offen lds
    s_add_u32 s42, s42, s58

    s_add_u32 m0, s75, 0
    s_nop 0
    buffer_load_dwordx4 v2, s[8:11], s43 offen lds
    s_add_u32 s43, s43, s59

    s_add_u32 m0, s76, 0
    s_nop 0
    buffer_load_dwordx4 v2, s[8:11], s44 offen lds
    s_add_u32 s44, s44, s60

    s_add_u32 m0, s77, 0
    s_nop 0
    buffer_load_dwordx4 v2, s[8:11], s45 offen lds
    s_add_u32 s45, s45, s61

    s_add_u32 m0, s78, 0
    s_nop 0
    buffer_load_dwordx4 v2, s[8:11], s46 offen lds
    s_add_u32 s46, s46, s62

    s_add_u32 m0, s79, 0
    s_nop 0
    buffer_load_dwordx4 v2, s[8:11], s47 offen lds
    s_add_u32 s47, s47, s63

    s_add_u32 m0, s80, 0
    s_nop 0
    buffer_load_dwordx4 v2, s[8:11], s48 offen lds
    s_add_u32 s48, s48, s64

    s_add_u32 m0, s72, 34816
    s_nop 0
    buffer_load_dwordx4 v2, s[8:11], s40 offen lds
    s_add_u32 s40, s40, s56

    s_add_u32 m0, s73, 34816
    s_nop 0
    buffer_load_dwordx4 v2, s[8:11], s41 offen lds
    s_add_u32 s41, s41, s57

    s_add_u32 m0, s74, 34816
    s_nop 0
    buffer_load_dwordx4 v2, s[8:11], s42 offen lds
    s_add_u32 s42, s42, s58

    s_add_u32 m0, s75, 34816
    s_nop 0
    buffer_load_dwordx4 v2, s[8:11], s43 offen lds
    s_add_u32 s43, s43, s59

    s_add_u32 m0, s76, 34816
    s_nop 0
    buffer_load_dwordx4 v2, s[8:11], s44 offen lds
    s_add_u32 s44, s44, s60

    s_add_u32 m0, s77, 34816
    s_nop 0
    buffer_load_dwordx4 v2, s[8:11], s45 offen lds
    s_add_u32 s45, s45, s61

    s_add_u32 m0, s78, 34816
    s_nop 0
    buffer_load_dwordx4 v2, s[8:11], s46 offen lds
    s_add_u32 s46, s46, s62

    s_add_u32 m0, s79, 34816
    s_nop 0
    buffer_load_dwordx4 v2, s[8:11], s47 offen lds
    s_add_u32 s47, s47, s63

    s_add_u32 m0, s80, 34816
    s_nop 0
    buffer_load_dwordx4 v2, s[8:11], s48 offen lds
    s_add_u32 s48, s48, s64

    s_waitcnt vmcnt(9)
    s_barrier
    s_add_u32 m0, s72, 69632
    s_nop 0
    buffer_load_dwordx4 v2, s[8:11], s40 offen lds
    s_add_u32 s40, s40, s56

    s_add_u32 m0, s73, 69632
    s_nop 0
    buffer_load_dwordx4 v2, s[8:11], s41 offen lds
    s_add_u32 s41, s41, s57

    s_add_u32 m0, s74, 69632
    s_nop 0
    buffer_load_dwordx4 v2, s[8:11], s42 offen lds
    s_add_u32 s42, s42, s58

    s_add_u32 m0, s75, 69632
    s_nop 0
    buffer_load_dwordx4 v2, s[8:11], s43 offen lds
    s_add_u32 s43, s43, s59

    s_add_u32 m0, s76, 69632
    s_nop 0
    buffer_load_dwordx4 v2, s[8:11], s44 offen lds
    s_add_u32 s44, s44, s60

    s_add_u32 m0, s77, 69632
    s_nop 0
    buffer_load_dwordx4 v2, s[8:11], s45 offen lds
    s_add_u32 s45, s45, s61

    s_add_u32 m0, s78, 69632
    s_nop 0
    buffer_load_dwordx4 v2, s[8:11], s46 offen lds
    s_add_u32 s46, s46, s62

    s_add_u32 m0, s79, 69632
    s_nop 0
    buffer_load_dwordx4 v2, s[8:11], s47 offen lds
    s_add_u32 s47, s47, s63

    s_add_u32 m0, s80, 69632
    s_nop 0
    buffer_load_dwordx4 v2, s[8:11], s48 offen lds
    s_add_u32 s48, s48, s64

    ds_read_b128 v[104:107], v10 offset:0
    ds_read_b128 v[108:111], v10 offset:2048
    ds_read_b128 v[32:35], v11 offset:0
    ds_read_b128 v[36:39], v11 offset:2048
    ds_read_b128 v[40:43], v11 offset:4096
    ds_read_b128 v[44:47], v11 offset:6144
    ds_read_b128 v[48:51], v11 offset:8192
    ds_read_b128 v[52:55], v11 offset:10240
    ds_read_b128 v[56:59], v11 offset:12288
    ds_read_b128 v[60:63], v11 offset:14336
    ds_read_b128 v[64:67], v11 offset:16384
    ds_read_b128 v[112:115], v12 offset:0
    ds_read_b128 v[116:119], v12 offset:2048
    ds_read_b128 v[68:71], v13 offset:0
    ds_read_b128 v[72:75], v13 offset:2048
    ds_read_b128 v[76:79], v13 offset:4096
    ds_read_b128 v[80:83], v13 offset:6144
    ds_read_b128 v[84:87], v13 offset:8192
    ds_read_b128 v[88:91], v13 offset:10240
    ds_read_b128 v[92:95], v13 offset:12288
    ds_read_b128 v[96:99], v13 offset:14336
    ds_read_b128 v[100:103], v13 offset:16384
    s_waitcnt lgkmcnt(11)
    v_mfma_f32_16x16x32_bf16 a[0:3], v[32:35], v[104:107], a[0:3]
    v_mfma_f32_16x16x32_bf16 a[4:7], v[32:35], v[108:111], a[4:7]
    v_mfma_f32_16x16x32_bf16 a[8:11], v[36:39], v[104:107], a[8:11]
    v_mfma_f32_16x16x32_bf16 a[12:15], v[36:39], v[108:111], a[12:15]
    v_mfma_f32_16x16x32_bf16 a[16:19], v[40:43], v[104:107], a[16:19]
    v_mfma_f32_16x16x32_bf16 a[20:23], v[40:43], v[108:111], a[20:23]
    v_mfma_f32_16x16x32_bf16 a[24:27], v[44:47], v[104:107], a[24:27]
    v_mfma_f32_16x16x32_bf16 a[28:31], v[44:47], v[108:111], a[28:31]
    v_mfma_f32_16x16x32_bf16 a[32:35], v[48:51], v[104:107], a[32:35]
    v_mfma_f32_16x16x32_bf16 a[36:39], v[48:51], v[108:111], a[36:39]
    v_mfma_f32_16x16x32_bf16 a[40:43], v[52:55], v[104:107], a[40:43]
    v_mfma_f32_16x16x32_bf16 a[44:47], v[52:55], v[108:111], a[44:47]
    v_mfma_f32_16x16x32_bf16 a[48:51], v[56:59], v[104:107], a[48:51]
    v_mfma_f32_16x16x32_bf16 a[52:55], v[56:59], v[108:111], a[52:55]
    v_mfma_f32_16x16x32_bf16 a[56:59], v[60:63], v[104:107], a[56:59]
    v_mfma_f32_16x16x32_bf16 a[60:63], v[60:63], v[108:111], a[60:63]
    v_mfma_f32_16x16x32_bf16 a[64:67], v[64:67], v[104:107], a[64:67]
    v_mfma_f32_16x16x32_bf16 a[68:71], v[64:67], v[108:111], a[68:71]
    s_waitcnt lgkmcnt(0)
    v_mfma_f32_16x16x32_bf16 a[0:3], v[68:71], v[112:115], a[0:3]
    v_mfma_f32_16x16x32_bf16 a[4:7], v[68:71], v[116:119], a[4:7]
    v_mfma_f32_16x16x32_bf16 a[8:11], v[72:75], v[112:115], a[8:11]
    v_mfma_f32_16x16x32_bf16 a[12:15], v[72:75], v[116:119], a[12:15]
    v_mfma_f32_16x16x32_bf16 a[16:19], v[76:79], v[112:115], a[16:19]
    v_mfma_f32_16x16x32_bf16 a[20:23], v[76:79], v[116:119], a[20:23]
    v_mfma_f32_16x16x32_bf16 a[24:27], v[80:83], v[112:115], a[24:27]
    v_mfma_f32_16x16x32_bf16 a[28:31], v[80:83], v[116:119], a[28:31]
    v_mfma_f32_16x16x32_bf16 a[32:35], v[84:87], v[112:115], a[32:35]
    v_mfma_f32_16x16x32_bf16 a[36:39], v[84:87], v[116:119], a[36:39]
    v_mfma_f32_16x16x32_bf16 a[40:43], v[88:91], v[112:115], a[40:43]
    v_mfma_f32_16x16x32_bf16 a[44:47], v[88:91], v[116:119], a[44:47]
    v_mfma_f32_16x16x32_bf16 a[48:51], v[92:95], v[112:115], a[48:51]
    v_mfma_f32_16x16x32_bf16 a[52:55], v[92:95], v[116:119], a[52:55]
    v_mfma_f32_16x16x32_bf16 a[56:59], v[96:99], v[112:115], a[56:59]
    v_mfma_f32_16x16x32_bf16 a[60:63], v[96:99], v[116:119], a[60:63]
    v_mfma_f32_16x16x32_bf16 a[64:67], v[100:103], v[112:115], a[64:67]
    v_mfma_f32_16x16x32_bf16 a[68:71], v[100:103], v[116:119], a[68:71]
    s_waitcnt vmcnt(9)
    s_barrier
    s_add_u32 m0, s72, 0
    s_nop 0
    buffer_load_dwordx4 v2, s[8:11], s40 offen lds
    s_add_u32 s40, s40, s56

    s_add_u32 m0, s73, 0
    s_nop 0
    buffer_load_dwordx4 v2, s[8:11], s41 offen lds
    s_add_u32 s41, s41, s57

    s_add_u32 m0, s74, 0
    s_nop 0
    buffer_load_dwordx4 v2, s[8:11], s42 offen lds
    s_add_u32 s42, s42, s58

    s_add_u32 m0, s75, 0
    s_nop 0
    buffer_load_dwordx4 v2, s[8:11], s43 offen lds
    s_add_u32 s43, s43, s59

    s_add_u32 m0, s76, 0
    s_nop 0
    buffer_load_dwordx4 v2, s[8:11], s44 offen lds
    s_add_u32 s44, s44, s60

    s_add_u32 m0, s77, 0
    s_nop 0
    buffer_load_dwordx4 v2, s[8:11], s45 offen lds
    s_add_u32 s45, s45, s61

    s_add_u32 m0, s78, 0
    s_nop 0
    buffer_load_dwordx4 v2, s[8:11], s46 offen lds
    s_add_u32 s46, s46, s62

    s_add_u32 m0, s79, 0
    s_nop 0
    buffer_load_dwordx4 v2, s[8:11], s47 offen lds
    s_add_u32 s47, s47, s63

    s_add_u32 m0, s80, 0
    s_nop 0
    buffer_load_dwordx4 v2, s[8:11], s48 offen lds
    s_add_u32 s48, s48, s64

    ds_read_b128 v[104:107], v14 offset:0
    ds_read_b128 v[108:111], v14 offset:2048
    ds_read_b128 v[32:35], v15 offset:0
    ds_read_b128 v[36:39], v15 offset:2048
    ds_read_b128 v[40:43], v15 offset:4096
    ds_read_b128 v[44:47], v15 offset:6144
    ds_read_b128 v[48:51], v15 offset:8192
    ds_read_b128 v[52:55], v15 offset:10240
    ds_read_b128 v[56:59], v15 offset:12288
    ds_read_b128 v[60:63], v15 offset:14336
    ds_read_b128 v[64:67], v15 offset:16384
    ds_read_b128 v[112:115], v16 offset:0
    ds_read_b128 v[116:119], v16 offset:2048
    ds_read_b128 v[68:71], v17 offset:0
    ds_read_b128 v[72:75], v17 offset:2048
    ds_read_b128 v[76:79], v17 offset:4096
    ds_read_b128 v[80:83], v17 offset:6144
    ds_read_b128 v[84:87], v17 offset:8192
    ds_read_b128 v[88:91], v17 offset:10240
    ds_read_b128 v[92:95], v17 offset:12288
    ds_read_b128 v[96:99], v17 offset:14336
    ds_read_b128 v[100:103], v17 offset:16384
    s_waitcnt lgkmcnt(11)
    v_mfma_f32_16x16x32_bf16 a[0:3], v[32:35], v[104:107], a[0:3]
    v_mfma_f32_16x16x32_bf16 a[4:7], v[32:35], v[108:111], a[4:7]
    v_mfma_f32_16x16x32_bf16 a[8:11], v[36:39], v[104:107], a[8:11]
    v_mfma_f32_16x16x32_bf16 a[12:15], v[36:39], v[108:111], a[12:15]
    v_mfma_f32_16x16x32_bf16 a[16:19], v[40:43], v[104:107], a[16:19]
    v_mfma_f32_16x16x32_bf16 a[20:23], v[40:43], v[108:111], a[20:23]
    v_mfma_f32_16x16x32_bf16 a[24:27], v[44:47], v[104:107], a[24:27]
    v_mfma_f32_16x16x32_bf16 a[28:31], v[44:47], v[108:111], a[28:31]
    v_mfma_f32_16x16x32_bf16 a[32:35], v[48:51], v[104:107], a[32:35]
    v_mfma_f32_16x16x32_bf16 a[36:39], v[48:51], v[108:111], a[36:39]
    v_mfma_f32_16x16x32_bf16 a[40:43], v[52:55], v[104:107], a[40:43]
    v_mfma_f32_16x16x32_bf16 a[44:47], v[52:55], v[108:111], a[44:47]
    v_mfma_f32_16x16x32_bf16 a[48:51], v[56:59], v[104:107], a[48:51]
    v_mfma_f32_16x16x32_bf16 a[52:55], v[56:59], v[108:111], a[52:55]
    v_mfma_f32_16x16x32_bf16 a[56:59], v[60:63], v[104:107], a[56:59]
    v_mfma_f32_16x16x32_bf16 a[60:63], v[60:63], v[108:111], a[60:63]
    v_mfma_f32_16x16x32_bf16 a[64:67], v[64:67], v[104:107], a[64:67]
    v_mfma_f32_16x16x32_bf16 a[68:71], v[64:67], v[108:111], a[68:71]
    s_waitcnt lgkmcnt(0)
    v_mfma_f32_16x16x32_bf16 a[0:3], v[68:71], v[112:115], a[0:3]
    v_mfma_f32_16x16x32_bf16 a[4:7], v[68:71], v[116:119], a[4:7]
    v_mfma_f32_16x16x32_bf16 a[8:11], v[72:75], v[112:115], a[8:11]
    v_mfma_f32_16x16x32_bf16 a[12:15], v[72:75], v[116:119], a[12:15]
    v_mfma_f32_16x16x32_bf16 a[16:19], v[76:79], v[112:115], a[16:19]
    v_mfma_f32_16x16x32_bf16 a[20:23], v[76:79], v[116:119], a[20:23]
    v_mfma_f32_16x16x32_bf16 a[24:27], v[80:83], v[112:115], a[24:27]
    v_mfma_f32_16x16x32_bf16 a[28:31], v[80:83], v[116:119], a[28:31]
    v_mfma_f32_16x16x32_bf16 a[32:35], v[84:87], v[112:115], a[32:35]
    v_mfma_f32_16x16x32_bf16 a[36:39], v[84:87], v[116:119], a[36:39]
    v_mfma_f32_16x16x32_bf16 a[40:43], v[88:91], v[112:115], a[40:43]
    v_mfma_f32_16x16x32_bf16 a[44:47], v[88:91], v[116:119], a[44:47]
    v_mfma_f32_16x16x32_bf16 a[48:51], v[92:95], v[112:115], a[48:51]
    v_mfma_f32_16x16x32_bf16 a[52:55], v[92:95], v[116:119], a[52:55]
    v_mfma_f32_16x16x32_bf16 a[56:59], v[96:99], v[112:115], a[56:59]
    v_mfma_f32_16x16x32_bf16 a[60:63], v[96:99], v[116:119], a[60:63]
    v_mfma_f32_16x16x32_bf16 a[64:67], v[100:103], v[112:115], a[64:67]
    v_mfma_f32_16x16x32_bf16 a[68:71], v[100:103], v[116:119], a[68:71]
    s_waitcnt vmcnt(9)
    s_barrier
    s_add_u32 m0, s72, 34816
    s_nop 0
    buffer_load_dwordx4 v2, s[8:11], s40 offen lds
    s_add_u32 s40, s40, s56

    s_add_u32 m0, s73, 34816
    s_nop 0
    buffer_load_dwordx4 v2, s[8:11], s41 offen lds
    s_add_u32 s41, s41, s57

    s_add_u32 m0, s74, 34816
    s_nop 0
    buffer_load_dwordx4 v2, s[8:11], s42 offen lds
    s_add_u32 s42, s42, s58

    s_add_u32 m0, s75, 34816
    s_nop 0
    buffer_load_dwordx4 v2, s[8:11], s43 offen lds
    s_add_u32 s43, s43, s59

    s_add_u32 m0, s76, 34816
    s_nop 0
    buffer_load_dwordx4 v2, s[8:11], s44 offen lds
    s_add_u32 s44, s44, s60

    s_add_u32 m0, s77, 34816
    s_nop 0
    buffer_load_dwordx4 v2, s[8:11], s45 offen lds
    s_add_u32 s45, s45, s61

    s_add_u32 m0, s78, 34816
    s_nop 0
    buffer_load_dwordx4 v2, s[8:11], s46 offen lds
    s_add_u32 s46, s46, s62

    s_add_u32 m0, s79, 34816
    s_nop 0
    buffer_load_dwordx4 v2, s[8:11], s47 offen lds
    s_add_u32 s47, s47, s63

    s_add_u32 m0, s80, 34816
    s_nop 0
    buffer_load_dwordx4 v2, s[8:11], s48 offen lds
    s_add_u32 s48, s48, s64

    ds_read_b128 v[104:107], v18 offset:0
    ds_read_b128 v[108:111], v18 offset:2048
    ds_read_b128 v[32:35], v19 offset:0
    ds_read_b128 v[36:39], v19 offset:2048
    ds_read_b128 v[40:43], v19 offset:4096
    ds_read_b128 v[44:47], v19 offset:6144
    ds_read_b128 v[48:51], v19 offset:8192
    ds_read_b128 v[52:55], v19 offset:10240
    ds_read_b128 v[56:59], v19 offset:12288
    ds_read_b128 v[60:63], v19 offset:14336
    ds_read_b128 v[64:67], v19 offset:16384
    ds_read_b128 v[112:115], v20 offset:0
    ds_read_b128 v[116:119], v20 offset:2048
    ds_read_b128 v[68:71], v21 offset:0
    ds_read_b128 v[72:75], v21 offset:2048
    ds_read_b128 v[76:79], v21 offset:4096
    ds_read_b128 v[80:83], v21 offset:6144
    ds_read_b128 v[84:87], v21 offset:8192
    ds_read_b128 v[88:91], v21 offset:10240
    ds_read_b128 v[92:95], v21 offset:12288
    ds_read_b128 v[96:99], v21 offset:14336
    ds_read_b128 v[100:103], v21 offset:16384
    s_waitcnt lgkmcnt(11)
    v_mfma_f32_16x16x32_bf16 a[0:3], v[32:35], v[104:107], a[0:3]
    v_mfma_f32_16x16x32_bf16 a[4:7], v[32:35], v[108:111], a[4:7]
    v_mfma_f32_16x16x32_bf16 a[8:11], v[36:39], v[104:107], a[8:11]
    v_mfma_f32_16x16x32_bf16 a[12:15], v[36:39], v[108:111], a[12:15]
    v_mfma_f32_16x16x32_bf16 a[16:19], v[40:43], v[104:107], a[16:19]
    v_mfma_f32_16x16x32_bf16 a[20:23], v[40:43], v[108:111], a[20:23]
    v_mfma_f32_16x16x32_bf16 a[24:27], v[44:47], v[104:107], a[24:27]
    v_mfma_f32_16x16x32_bf16 a[28:31], v[44:47], v[108:111], a[28:31]
    v_mfma_f32_16x16x32_bf16 a[32:35], v[48:51], v[104:107], a[32:35]
    v_mfma_f32_16x16x32_bf16 a[36:39], v[48:51], v[108:111], a[36:39]
    v_mfma_f32_16x16x32_bf16 a[40:43], v[52:55], v[104:107], a[40:43]
    v_mfma_f32_16x16x32_bf16 a[44:47], v[52:55], v[108:111], a[44:47]
    v_mfma_f32_16x16x32_bf16 a[48:51], v[56:59], v[104:107], a[48:51]
    v_mfma_f32_16x16x32_bf16 a[52:55], v[56:59], v[108:111], a[52:55]
    v_mfma_f32_16x16x32_bf16 a[56:59], v[60:63], v[104:107], a[56:59]
    v_mfma_f32_16x16x32_bf16 a[60:63], v[60:63], v[108:111], a[60:63]
    v_mfma_f32_16x16x32_bf16 a[64:67], v[64:67], v[104:107], a[64:67]
    v_mfma_f32_16x16x32_bf16 a[68:71], v[64:67], v[108:111], a[68:71]
    s_waitcnt lgkmcnt(0)
    v_mfma_f32_16x16x32_bf16 a[0:3], v[68:71], v[112:115], a[0:3]
    v_mfma_f32_16x16x32_bf16 a[4:7], v[68:71], v[116:119], a[4:7]
    v_mfma_f32_16x16x32_bf16 a[8:11], v[72:75], v[112:115], a[8:11]
    v_mfma_f32_16x16x32_bf16 a[12:15], v[72:75], v[116:119], a[12:15]
    v_mfma_f32_16x16x32_bf16 a[16:19], v[76:79], v[112:115], a[16:19]
    v_mfma_f32_16x16x32_bf16 a[20:23], v[76:79], v[116:119], a[20:23]
    v_mfma_f32_16x16x32_bf16 a[24:27], v[80:83], v[112:115], a[24:27]
    v_mfma_f32_16x16x32_bf16 a[28:31], v[80:83], v[116:119], a[28:31]
    v_mfma_f32_16x16x32_bf16 a[32:35], v[84:87], v[112:115], a[32:35]
    v_mfma_f32_16x16x32_bf16 a[36:39], v[84:87], v[116:119], a[36:39]
    v_mfma_f32_16x16x32_bf16 a[40:43], v[88:91], v[112:115], a[40:43]
    v_mfma_f32_16x16x32_bf16 a[44:47], v[88:91], v[116:119], a[44:47]
    v_mfma_f32_16x16x32_bf16 a[48:51], v[92:95], v[112:115], a[48:51]
    v_mfma_f32_16x16x32_bf16 a[52:55], v[92:95], v[116:119], a[52:55]
    v_mfma_f32_16x16x32_bf16 a[56:59], v[96:99], v[112:115], a[56:59]
    v_mfma_f32_16x16x32_bf16 a[60:63], v[96:99], v[116:119], a[60:63]
    v_mfma_f32_16x16x32_bf16 a[64:67], v[100:103], v[112:115], a[64:67]
    v_mfma_f32_16x16x32_bf16 a[68:71], v[100:103], v[116:119], a[68:71]
    s_waitcnt vmcnt(9)
    s_barrier
    s_add_u32 m0, s72, 69632
    s_nop 0
    buffer_load_dwordx4 v2, s[8:11], s40 offen lds
    s_add_u32 s40, s40, s56

    s_add_u32 m0, s73, 69632
    s_nop 0
    buffer_load_dwordx4 v2, s[8:11], s41 offen lds
    s_add_u32 s41, s41, s57

    s_add_u32 m0, s74, 69632
    s_nop 0
    buffer_load_dwordx4 v2, s[8:11], s42 offen lds
    s_add_u32 s42, s42, s58

    s_add_u32 m0, s75, 69632
    s_nop 0
    buffer_load_dwordx4 v2, s[8:11], s43 offen lds
    s_add_u32 s43, s43, s59

    s_add_u32 m0, s76, 69632
    s_nop 0
    buffer_load_dwordx4 v2, s[8:11], s44 offen lds
    s_add_u32 s44, s44, s60

    s_add_u32 m0, s77, 69632
    s_nop 0
    buffer_load_dwordx4 v2, s[8:11], s45 offen lds
    s_add_u32 s45, s45, s61

    s_add_u32 m0, s78, 69632
    s_nop 0
    buffer_load_dwordx4 v2, s[8:11], s46 offen lds
    s_add_u32 s46, s46, s62

    s_add_u32 m0, s79, 69632
    s_nop 0
    buffer_load_dwordx4 v2, s[8:11], s47 offen lds
    s_add_u32 s47, s47, s63

    s_add_u32 m0, s80, 69632
    s_nop 0
    buffer_load_dwordx4 v2, s[8:11], s48 offen lds
    s_add_u32 s48, s48, s64

    ds_read_b128 v[104:107], v10 offset:0
    ds_read_b128 v[108:111], v10 offset:2048
    ds_read_b128 v[32:35], v11 offset:0
    ds_read_b128 v[36:39], v11 offset:2048
    ds_read_b128 v[40:43], v11 offset:4096
    ds_read_b128 v[44:47], v11 offset:6144
    ds_read_b128 v[48:51], v11 offset:8192
    ds_read_b128 v[52:55], v11 offset:10240
    ds_read_b128 v[56:59], v11 offset:12288
    ds_read_b128 v[60:63], v11 offset:14336
    ds_read_b128 v[64:67], v11 offset:16384
    ds_read_b128 v[112:115], v12 offset:0
    ds_read_b128 v[116:119], v12 offset:2048
    ds_read_b128 v[68:71], v13 offset:0
    ds_read_b128 v[72:75], v13 offset:2048
    ds_read_b128 v[76:79], v13 offset:4096
    ds_read_b128 v[80:83], v13 offset:6144
    ds_read_b128 v[84:87], v13 offset:8192
    ds_read_b128 v[88:91], v13 offset:10240
    ds_read_b128 v[92:95], v13 offset:12288
    ds_read_b128 v[96:99], v13 offset:14336
    ds_read_b128 v[100:103], v13 offset:16384
    s_waitcnt lgkmcnt(11)
    v_mfma_f32_16x16x32_bf16 a[0:3], v[32:35], v[104:107], a[0:3]
    v_mfma_f32_16x16x32_bf16 a[4:7], v[32:35], v[108:111], a[4:7]
    v_mfma_f32_16x16x32_bf16 a[8:11], v[36:39], v[104:107], a[8:11]
    v_mfma_f32_16x16x32_bf16 a[12:15], v[36:39], v[108:111], a[12:15]
    v_mfma_f32_16x16x32_bf16 a[16:19], v[40:43], v[104:107], a[16:19]
    v_mfma_f32_16x16x32_bf16 a[20:23], v[40:43], v[108:111], a[20:23]
    v_mfma_f32_16x16x32_bf16 a[24:27], v[44:47], v[104:107], a[24:27]
    v_mfma_f32_16x16x32_bf16 a[28:31], v[44:47], v[108:111], a[28:31]
    v_mfma_f32_16x16x32_bf16 a[32:35], v[48:51], v[104:107], a[32:35]
    v_mfma_f32_16x16x32_bf16 a[36:39], v[48:51], v[108:111], a[36:39]
    v_mfma_f32_16x16x32_bf16 a[40:43], v[52:55], v[104:107], a[40:43]
    v_mfma_f32_16x16x32_bf16 a[44:47], v[52:55], v[108:111], a[44:47]
    v_mfma_f32_16x16x32_bf16 a[48:51], v[56:59], v[104:107], a[48:51]
    v_mfma_f32_16x16x32_bf16 a[52:55], v[56:59], v[108:111], a[52:55]
    v_mfma_f32_16x16x32_bf16 a[56:59], v[60:63], v[104:107], a[56:59]
    v_mfma_f32_16x16x32_bf16 a[60:63], v[60:63], v[108:111], a[60:63]
    v_mfma_f32_16x16x32_bf16 a[64:67], v[64:67], v[104:107], a[64:67]
    v_mfma_f32_16x16x32_bf16 a[68:71], v[64:67], v[108:111], a[68:71]
    s_waitcnt lgkmcnt(0)
    v_mfma_f32_16x16x32_bf16 a[0:3], v[68:71], v[112:115], a[0:3]
    v_mfma_f32_16x16x32_bf16 a[4:7], v[68:71], v[116:119], a[4:7]
    v_mfma_f32_16x16x32_bf16 a[8:11], v[72:75], v[112:115], a[8:11]
    v_mfma_f32_16x16x32_bf16 a[12:15], v[72:75], v[116:119], a[12:15]
    v_mfma_f32_16x16x32_bf16 a[16:19], v[76:79], v[112:115], a[16:19]
    v_mfma_f32_16x16x32_bf16 a[20:23], v[76:79], v[116:119], a[20:23]
    v_mfma_f32_16x16x32_bf16 a[24:27], v[80:83], v[112:115], a[24:27]
    v_mfma_f32_16x16x32_bf16 a[28:31], v[80:83], v[116:119], a[28:31]
    v_mfma_f32_16x16x32_bf16 a[32:35], v[84:87], v[112:115], a[32:35]
    v_mfma_f32_16x16x32_bf16 a[36:39], v[84:87], v[116:119], a[36:39]
    v_mfma_f32_16x16x32_bf16 a[40:43], v[88:91], v[112:115], a[40:43]
    v_mfma_f32_16x16x32_bf16 a[44:47], v[88:91], v[116:119], a[44:47]
    v_mfma_f32_16x16x32_bf16 a[48:51], v[92:95], v[112:115], a[48:51]
    v_mfma_f32_16x16x32_bf16 a[52:55], v[92:95], v[116:119], a[52:55]
    v_mfma_f32_16x16x32_bf16 a[56:59], v[96:99], v[112:115], a[56:59]
    v_mfma_f32_16x16x32_bf16 a[60:63], v[96:99], v[116:119], a[60:63]
    v_mfma_f32_16x16x32_bf16 a[64:67], v[100:103], v[112:115], a[64:67]
    v_mfma_f32_16x16x32_bf16 a[68:71], v[100:103], v[116:119], a[68:71]
    s_waitcnt vmcnt(9)
    s_barrier
    s_add_u32 m0, s72, 0
    s_nop 0
    buffer_load_dwordx4 v2, s[8:11], s40 offen lds
    s_add_u32 s40, s40, s56

    s_add_u32 m0, s73, 0
    s_nop 0
    buffer_load_dwordx4 v2, s[8:11], s41 offen lds
    s_add_u32 s41, s41, s57

    s_add_u32 m0, s74, 0
    s_nop 0
    buffer_load_dwordx4 v2, s[8:11], s42 offen lds
    s_add_u32 s42, s42, s58

    s_add_u32 m0, s75, 0
    s_nop 0
    buffer_load_dwordx4 v2, s[8:11], s43 offen lds
    s_add_u32 s43, s43, s59

    s_add_u32 m0, s76, 0
    s_nop 0
    buffer_load_dwordx4 v2, s[8:11], s44 offen lds
    s_add_u32 s44, s44, s60

    s_add_u32 m0, s77, 0
    s_nop 0
    buffer_load_dwordx4 v2, s[8:11], s45 offen lds
    s_add_u32 s45, s45, s61

    s_add_u32 m0, s78, 0
    s_nop 0
    buffer_load_dwordx4 v2, s[8:11], s46 offen lds
    s_add_u32 s46, s46, s62

    s_add_u32 m0, s79, 0
    s_nop 0
    buffer_load_dwordx4 v2, s[8:11], s47 offen lds
    s_add_u32 s47, s47, s63

    s_add_u32 m0, s80, 0
    s_nop 0
    buffer_load_dwordx4 v2, s[8:11], s48 offen lds
    s_add_u32 s48, s48, s64

    ds_read_b128 v[104:107], v14 offset:0
    ds_read_b128 v[108:111], v14 offset:2048
    ds_read_b128 v[32:35], v15 offset:0
    ds_read_b128 v[36:39], v15 offset:2048
    ds_read_b128 v[40:43], v15 offset:4096
    ds_read_b128 v[44:47], v15 offset:6144
    ds_read_b128 v[48:51], v15 offset:8192
    ds_read_b128 v[52:55], v15 offset:10240
    ds_read_b128 v[56:59], v15 offset:12288
    ds_read_b128 v[60:63], v15 offset:14336
    ds_read_b128 v[64:67], v15 offset:16384
    ds_read_b128 v[112:115], v16 offset:0
    ds_read_b128 v[116:119], v16 offset:2048
    ds_read_b128 v[68:71], v17 offset:0
    ds_read_b128 v[72:75], v17 offset:2048
    ds_read_b128 v[76:79], v17 offset:4096
    ds_read_b128 v[80:83], v17 offset:6144
    ds_read_b128 v[84:87], v17 offset:8192
    ds_read_b128 v[88:91], v17 offset:10240
    ds_read_b128 v[92:95], v17 offset:12288
    ds_read_b128 v[96:99], v17 offset:14336
    ds_read_b128 v[100:103], v17 offset:16384
    s_waitcnt lgkmcnt(11)
    v_mfma_f32_16x16x32_bf16 a[0:3], v[32:35], v[104:107], a[0:3]
    v_mfma_f32_16x16x32_bf16 a[4:7], v[32:35], v[108:111], a[4:7]
    v_mfma_f32_16x16x32_bf16 a[8:11], v[36:39], v[104:107], a[8:11]
    v_mfma_f32_16x16x32_bf16 a[12:15], v[36:39], v[108:111], a[12:15]
    v_mfma_f32_16x16x32_bf16 a[16:19], v[40:43], v[104:107], a[16:19]
    v_mfma_f32_16x16x32_bf16 a[20:23], v[40:43], v[108:111], a[20:23]
    v_mfma_f32_16x16x32_bf16 a[24:27], v[44:47], v[104:107], a[24:27]
    v_mfma_f32_16x16x32_bf16 a[28:31], v[44:47], v[108:111], a[28:31]
    v_mfma_f32_16x16x32_bf16 a[32:35], v[48:51], v[104:107], a[32:35]
    v_mfma_f32_16x16x32_bf16 a[36:39], v[48:51], v[108:111], a[36:39]
    v_mfma_f32_16x16x32_bf16 a[40:43], v[52:55], v[104:107], a[40:43]
    v_mfma_f32_16x16x32_bf16 a[44:47], v[52:55], v[108:111], a[44:47]
    v_mfma_f32_16x16x32_bf16 a[48:51], v[56:59], v[104:107], a[48:51]
    v_mfma_f32_16x16x32_bf16 a[52:55], v[56:59], v[108:111], a[52:55]
    v_mfma_f32_16x16x32_bf16 a[56:59], v[60:63], v[104:107], a[56:59]
    v_mfma_f32_16x16x32_bf16 a[60:63], v[60:63], v[108:111], a[60:63]
    v_mfma_f32_16x16x32_bf16 a[64:67], v[64:67], v[104:107], a[64:67]
    v_mfma_f32_16x16x32_bf16 a[68:71], v[64:67], v[108:111], a[68:71]
    s_waitcnt lgkmcnt(0)
    v_mfma_f32_16x16x32_bf16 a[0:3], v[68:71], v[112:115], a[0:3]
    v_mfma_f32_16x16x32_bf16 a[4:7], v[68:71], v[116:119], a[4:7]
    v_mfma_f32_16x16x32_bf16 a[8:11], v[72:75], v[112:115], a[8:11]
    v_mfma_f32_16x16x32_bf16 a[12:15], v[72:75], v[116:119], a[12:15]
    v_mfma_f32_16x16x32_bf16 a[16:19], v[76:79], v[112:115], a[16:19]
    v_mfma_f32_16x16x32_bf16 a[20:23], v[76:79], v[116:119], a[20:23]
    v_mfma_f32_16x16x32_bf16 a[24:27], v[80:83], v[112:115], a[24:27]
    v_mfma_f32_16x16x32_bf16 a[28:31], v[80:83], v[116:119], a[28:31]
    v_mfma_f32_16x16x32_bf16 a[32:35], v[84:87], v[112:115], a[32:35]
    v_mfma_f32_16x16x32_bf16 a[36:39], v[84:87], v[116:119], a[36:39]
    v_mfma_f32_16x16x32_bf16 a[40:43], v[88:91], v[112:115], a[40:43]
    v_mfma_f32_16x16x32_bf16 a[44:47], v[88:91], v[116:119], a[44:47]
    v_mfma_f32_16x16x32_bf16 a[48:51], v[92:95], v[112:115], a[48:51]
    v_mfma_f32_16x16x32_bf16 a[52:55], v[92:95], v[116:119], a[52:55]
    v_mfma_f32_16x16x32_bf16 a[56:59], v[96:99], v[112:115], a[56:59]
    v_mfma_f32_16x16x32_bf16 a[60:63], v[96:99], v[116:119], a[60:63]
    v_mfma_f32_16x16x32_bf16 a[64:67], v[100:103], v[112:115], a[64:67]
    v_mfma_f32_16x16x32_bf16 a[68:71], v[100:103], v[116:119], a[68:71]
    s_waitcnt vmcnt(9)
    s_barrier
    s_add_u32 m0, s72, 34816
    s_nop 0
    buffer_load_dwordx4 v2, s[8:11], s40 offen lds
    s_add_u32 s40, s40, s56

    s_add_u32 m0, s73, 34816
    s_nop 0
    buffer_load_dwordx4 v2, s[8:11], s41 offen lds
    s_add_u32 s41, s41, s57

    s_add_u32 m0, s74, 34816
    s_nop 0
    buffer_load_dwordx4 v2, s[8:11], s42 offen lds
    s_add_u32 s42, s42, s58

    s_add_u32 m0, s75, 34816
    s_nop 0
    buffer_load_dwordx4 v2, s[8:11], s43 offen lds
    s_add_u32 s43, s43, s59

    s_add_u32 m0, s76, 34816
    s_nop 0
    buffer_load_dwordx4 v2, s[8:11], s44 offen lds
    s_add_u32 s44, s44, s60

    s_add_u32 m0, s77, 34816
    s_nop 0
    buffer_load_dwordx4 v2, s[8:11], s45 offen lds
    s_add_u32 s45, s45, s61

    s_add_u32 m0, s78, 34816
    s_nop 0
    buffer_load_dwordx4 v2, s[8:11], s46 offen lds
    s_add_u32 s46, s46, s62

    s_add_u32 m0, s79, 34816
    s_nop 0
    buffer_load_dwordx4 v2, s[8:11], s47 offen lds
    s_add_u32 s47, s47, s63

    s_add_u32 m0, s80, 34816
    s_nop 0
    buffer_load_dwordx4 v2, s[8:11], s48 offen lds
    s_add_u32 s48, s48, s64

    ds_read_b128 v[104:107], v18 offset:0
    ds_read_b128 v[108:111], v18 offset:2048
    ds_read_b128 v[32:35], v19 offset:0
    ds_read_b128 v[36:39], v19 offset:2048
    ds_read_b128 v[40:43], v19 offset:4096
    ds_read_b128 v[44:47], v19 offset:6144
    ds_read_b128 v[48:51], v19 offset:8192
    ds_read_b128 v[52:55], v19 offset:10240
    ds_read_b128 v[56:59], v19 offset:12288
    ds_read_b128 v[60:63], v19 offset:14336
    ds_read_b128 v[64:67], v19 offset:16384
    ds_read_b128 v[112:115], v20 offset:0
    ds_read_b128 v[116:119], v20 offset:2048
    ds_read_b128 v[68:71], v21 offset:0
    ds_read_b128 v[72:75], v21 offset:2048
    ds_read_b128 v[76:79], v21 offset:4096
    ds_read_b128 v[80:83], v21 offset:6144
    ds_read_b128 v[84:87], v21 offset:8192
    ds_read_b128 v[88:91], v21 offset:10240
    ds_read_b128 v[92:95], v21 offset:12288
    ds_read_b128 v[96:99], v21 offset:14336
    ds_read_b128 v[100:103], v21 offset:16384
    s_waitcnt lgkmcnt(11)
    v_mfma_f32_16x16x32_bf16 a[0:3], v[32:35], v[104:107], a[0:3]
    v_mfma_f32_16x16x32_bf16 a[4:7], v[32:35], v[108:111], a[4:7]
    v_mfma_f32_16x16x32_bf16 a[8:11], v[36:39], v[104:107], a[8:11]
    v_mfma_f32_16x16x32_bf16 a[12:15], v[36:39], v[108:111], a[12:15]
    v_mfma_f32_16x16x32_bf16 a[16:19], v[40:43], v[104:107], a[16:19]
    v_mfma_f32_16x16x32_bf16 a[20:23], v[40:43], v[108:111], a[20:23]
    v_mfma_f32_16x16x32_bf16 a[24:27], v[44:47], v[104:107], a[24:27]
    v_mfma_f32_16x16x32_bf16 a[28:31], v[44:47], v[108:111], a[28:31]
    v_mfma_f32_16x16x32_bf16 a[32:35], v[48:51], v[104:107], a[32:35]
    v_mfma_f32_16x16x32_bf16 a[36:39], v[48:51], v[108:111], a[36:39]
    v_mfma_f32_16x16x32_bf16 a[40:43], v[52:55], v[104:107], a[40:43]
    v_mfma_f32_16x16x32_bf16 a[44:47], v[52:55], v[108:111], a[44:47]
    v_mfma_f32_16x16x32_bf16 a[48:51], v[56:59], v[104:107], a[48:51]
    v_mfma_f32_16x16x32_bf16 a[52:55], v[56:59], v[108:111], a[52:55]
    v_mfma_f32_16x16x32_bf16 a[56:59], v[60:63], v[104:107], a[56:59]
    v_mfma_f32_16x16x32_bf16 a[60:63], v[60:63], v[108:111], a[60:63]
    v_mfma_f32_16x16x32_bf16 a[64:67], v[64:67], v[104:107], a[64:67]
    v_mfma_f32_16x16x32_bf16 a[68:71], v[64:67], v[108:111], a[68:71]
    s_waitcnt lgkmcnt(0)
    v_mfma_f32_16x16x32_bf16 a[0:3], v[68:71], v[112:115], a[0:3]
    v_mfma_f32_16x16x32_bf16 a[4:7], v[68:71], v[116:119], a[4:7]
    v_mfma_f32_16x16x32_bf16 a[8:11], v[72:75], v[112:115], a[8:11]
    v_mfma_f32_16x16x32_bf16 a[12:15], v[72:75], v[116:119], a[12:15]
    v_mfma_f32_16x16x32_bf16 a[16:19], v[76:79], v[112:115], a[16:19]
    v_mfma_f32_16x16x32_bf16 a[20:23], v[76:79], v[116:119], a[20:23]
    v_mfma_f32_16x16x32_bf16 a[24:27], v[80:83], v[112:115], a[24:27]
    v_mfma_f32_16x16x32_bf16 a[28:31], v[80:83], v[116:119], a[28:31]
    v_mfma_f32_16x16x32_bf16 a[32:35], v[84:87], v[112:115], a[32:35]
    v_mfma_f32_16x16x32_bf16 a[36:39], v[84:87], v[116:119], a[36:39]
    v_mfma_f32_16x16x32_bf16 a[40:43], v[88:91], v[112:115], a[40:43]
    v_mfma_f32_16x16x32_bf16 a[44:47], v[88:91], v[116:119], a[44:47]
    v_mfma_f32_16x16x32_bf16 a[48:51], v[92:95], v[112:115], a[48:51]
    v_mfma_f32_16x16x32_bf16 a[52:55], v[92:95], v[116:119], a[52:55]
    v_mfma_f32_16x16x32_bf16 a[56:59], v[96:99], v[112:115], a[56:59]
    v_mfma_f32_16x16x32_bf16 a[60:63], v[96:99], v[116:119], a[60:63]
    v_mfma_f32_16x16x32_bf16 a[64:67], v[100:103], v[112:115], a[64:67]
    v_mfma_f32_16x16x32_bf16 a[68:71], v[100:103], v[116:119], a[68:71]
    s_waitcnt vmcnt(9)
    s_barrier
    s_add_u32 m0, s72, 69632
    s_nop 0
    buffer_load_dwordx4 v2, s[8:11], s40 offen lds
    s_add_u32 s40, s40, s56

    s_add_u32 m0, s73, 69632
    s_nop 0
    buffer_load_dwordx4 v2, s[8:11], s41 offen lds
    s_add_u32 s41, s41, s57

    s_add_u32 m0, s74, 69632
    s_nop 0
    buffer_load_dwordx4 v2, s[8:11], s42 offen lds
    s_add_u32 s42, s42, s58

    s_add_u32 m0, s75, 69632
    s_nop 0
    buffer_load_dwordx4 v2, s[8:11], s43 offen lds
    s_add_u32 s43, s43, s59

    s_add_u32 m0, s76, 69632
    s_nop 0
    buffer_load_dwordx4 v2, s[8:11], s44 offen lds
    s_add_u32 s44, s44, s60

    s_add_u32 m0, s77, 69632
    s_nop 0
    buffer_load_dwordx4 v2, s[8:11], s45 offen lds
    s_add_u32 s45, s45, s61

    s_add_u32 m0, s78, 69632
    s_nop 0
    buffer_load_dwordx4 v2, s[8:11], s46 offen lds
    s_add_u32 s46, s46, s62

    s_add_u32 m0, s79, 69632
    s_nop 0
    buffer_load_dwordx4 v2, s[8:11], s47 offen lds
    s_add_u32 s47, s47, s63

    s_add_u32 m0, s80, 69632
    s_nop 0
    buffer_load_dwordx4 v2, s[8:11], s48 offen lds
    s_add_u32 s48, s48, s64

    ds_read_b128 v[104:107], v10 offset:0
    ds_read_b128 v[108:111], v10 offset:2048
    ds_read_b128 v[32:35], v11 offset:0
    ds_read_b128 v[36:39], v11 offset:2048
    ds_read_b128 v[40:43], v11 offset:4096
    ds_read_b128 v[44:47], v11 offset:6144
    ds_read_b128 v[48:51], v11 offset:8192
    ds_read_b128 v[52:55], v11 offset:10240
    ds_read_b128 v[56:59], v11 offset:12288
    ds_read_b128 v[60:63], v11 offset:14336
    ds_read_b128 v[64:67], v11 offset:16384
    ds_read_b128 v[112:115], v12 offset:0
    ds_read_b128 v[116:119], v12 offset:2048
    ds_read_b128 v[68:71], v13 offset:0
    ds_read_b128 v[72:75], v13 offset:2048
    ds_read_b128 v[76:79], v13 offset:4096
    ds_read_b128 v[80:83], v13 offset:6144
    ds_read_b128 v[84:87], v13 offset:8192
    ds_read_b128 v[88:91], v13 offset:10240
    ds_read_b128 v[92:95], v13 offset:12288
    ds_read_b128 v[96:99], v13 offset:14336
    ds_read_b128 v[100:103], v13 offset:16384
    s_waitcnt lgkmcnt(11)
    v_mfma_f32_16x16x32_bf16 a[0:3], v[32:35], v[104:107], a[0:3]
    v_mfma_f32_16x16x32_bf16 a[4:7], v[32:35], v[108:111], a[4:7]
    v_mfma_f32_16x16x32_bf16 a[8:11], v[36:39], v[104:107], a[8:11]
    v_mfma_f32_16x16x32_bf16 a[12:15], v[36:39], v[108:111], a[12:15]
    v_mfma_f32_16x16x32_bf16 a[16:19], v[40:43], v[104:107], a[16:19]
    v_mfma_f32_16x16x32_bf16 a[20:23], v[40:43], v[108:111], a[20:23]
    v_mfma_f32_16x16x32_bf16 a[24:27], v[44:47], v[104:107], a[24:27]
    v_mfma_f32_16x16x32_bf16 a[28:31], v[44:47], v[108:111], a[28:31]
    v_mfma_f32_16x16x32_bf16 a[32:35], v[48:51], v[104:107], a[32:35]
    v_mfma_f32_16x16x32_bf16 a[36:39], v[48:51], v[108:111], a[36:39]
    v_mfma_f32_16x16x32_bf16 a[40:43], v[52:55], v[104:107], a[40:43]
    v_mfma_f32_16x16x32_bf16 a[44:47], v[52:55], v[108:111], a[44:47]
    v_mfma_f32_16x16x32_bf16 a[48:51], v[56:59], v[104:107], a[48:51]
    v_mfma_f32_16x16x32_bf16 a[52:55], v[56:59], v[108:111], a[52:55]
    v_mfma_f32_16x16x32_bf16 a[56:59], v[60:63], v[104:107], a[56:59]
    v_mfma_f32_16x16x32_bf16 a[60:63], v[60:63], v[108:111], a[60:63]
    v_mfma_f32_16x16x32_bf16 a[64:67], v[64:67], v[104:107], a[64:67]
    v_mfma_f32_16x16x32_bf16 a[68:71], v[64:67], v[108:111], a[68:71]
    s_waitcnt lgkmcnt(0)
    v_mfma_f32_16x16x32_bf16 a[0:3], v[68:71], v[112:115], a[0:3]
    v_mfma_f32_16x16x32_bf16 a[4:7], v[68:71], v[116:119], a[4:7]
    v_mfma_f32_16x16x32_bf16 a[8:11], v[72:75], v[112:115], a[8:11]
    v_mfma_f32_16x16x32_bf16 a[12:15], v[72:75], v[116:119], a[12:15]
    v_mfma_f32_16x16x32_bf16 a[16:19], v[76:79], v[112:115], a[16:19]
    v_mfma_f32_16x16x32_bf16 a[20:23], v[76:79], v[116:119], a[20:23]
    v_mfma_f32_16x16x32_bf16 a[24:27], v[80:83], v[112:115], a[24:27]
    v_mfma_f32_16x16x32_bf16 a[28:31], v[80:83], v[116:119], a[28:31]
    v_mfma_f32_16x16x32_bf16 a[32:35], v[84:87], v[112:115], a[32:35]
    v_mfma_f32_16x16x32_bf16 a[36:39], v[84:87], v[116:119], a[36:39]
    v_mfma_f32_16x16x32_bf16 a[40:43], v[88:91], v[112:115], a[40:43]
    v_mfma_f32_16x16x32_bf16 a[44:47], v[88:91], v[116:119], a[44:47]
    v_mfma_f32_16x16x32_bf16 a[48:51], v[92:95], v[112:115], a[48:51]
    v_mfma_f32_16x16x32_bf16 a[52:55], v[92:95], v[116:119], a[52:55]
    v_mfma_f32_16x16x32_bf16 a[56:59], v[96:99], v[112:115], a[56:59]
    v_mfma_f32_16x16x32_bf16 a[60:63], v[96:99], v[116:119], a[60:63]
    v_mfma_f32_16x16x32_bf16 a[64:67], v[100:103], v[112:115], a[64:67]
    v_mfma_f32_16x16x32_bf16 a[68:71], v[100:103], v[116:119], a[68:71]
    s_waitcnt vmcnt(9)
    s_barrier
    s_add_u32 m0, s72, 0
    s_nop 0
    buffer_load_dwordx4 v2, s[8:11], s40 offen lds
    s_add_u32 s40, s40, s56

    s_add_u32 m0, s73, 0
    s_nop 0
    buffer_load_dwordx4 v2, s[8:11], s41 offen lds
    s_add_u32 s41, s41, s57

    s_add_u32 m0, s74, 0
    s_nop 0
    buffer_load_dwordx4 v2, s[8:11], s42 offen lds
    s_add_u32 s42, s42, s58

    s_add_u32 m0, s75, 0
    s_nop 0
    buffer_load_dwordx4 v2, s[8:11], s43 offen lds
    s_add_u32 s43, s43, s59

    s_add_u32 m0, s76, 0
    s_nop 0
    buffer_load_dwordx4 v2, s[8:11], s44 offen lds
    s_add_u32 s44, s44, s60

    s_add_u32 m0, s77, 0
    s_nop 0
    buffer_load_dwordx4 v2, s[8:11], s45 offen lds
    s_add_u32 s45, s45, s61

    s_add_u32 m0, s78, 0
    s_nop 0
    buffer_load_dwordx4 v2, s[8:11], s46 offen lds
    s_add_u32 s46, s46, s62

    s_add_u32 m0, s79, 0
    s_nop 0
    buffer_load_dwordx4 v2, s[8:11], s47 offen lds
    s_add_u32 s47, s47, s63

    s_add_u32 m0, s80, 0
    s_nop 0
    buffer_load_dwordx4 v2, s[8:11], s48 offen lds
    s_add_u32 s48, s48, s64

    ds_read_b128 v[104:107], v14 offset:0
    ds_read_b128 v[108:111], v14 offset:2048
    ds_read_b128 v[32:35], v15 offset:0
    ds_read_b128 v[36:39], v15 offset:2048
    ds_read_b128 v[40:43], v15 offset:4096
    ds_read_b128 v[44:47], v15 offset:6144
    ds_read_b128 v[48:51], v15 offset:8192
    ds_read_b128 v[52:55], v15 offset:10240
    ds_read_b128 v[56:59], v15 offset:12288
    ds_read_b128 v[60:63], v15 offset:14336
    ds_read_b128 v[64:67], v15 offset:16384
    ds_read_b128 v[112:115], v16 offset:0
    ds_read_b128 v[116:119], v16 offset:2048
    ds_read_b128 v[68:71], v17 offset:0
    ds_read_b128 v[72:75], v17 offset:2048
    ds_read_b128 v[76:79], v17 offset:4096
    ds_read_b128 v[80:83], v17 offset:6144
    ds_read_b128 v[84:87], v17 offset:8192
    ds_read_b128 v[88:91], v17 offset:10240
    ds_read_b128 v[92:95], v17 offset:12288
    ds_read_b128 v[96:99], v17 offset:14336
    ds_read_b128 v[100:103], v17 offset:16384
    s_waitcnt lgkmcnt(11)
    v_mfma_f32_16x16x32_bf16 a[0:3], v[32:35], v[104:107], a[0:3]
    v_mfma_f32_16x16x32_bf16 a[4:7], v[32:35], v[108:111], a[4:7]
    v_mfma_f32_16x16x32_bf16 a[8:11], v[36:39], v[104:107], a[8:11]
    v_mfma_f32_16x16x32_bf16 a[12:15], v[36:39], v[108:111], a[12:15]
    v_mfma_f32_16x16x32_bf16 a[16:19], v[40:43], v[104:107], a[16:19]
    v_mfma_f32_16x16x32_bf16 a[20:23], v[40:43], v[108:111], a[20:23]
    v_mfma_f32_16x16x32_bf16 a[24:27], v[44:47], v[104:107], a[24:27]
    v_mfma_f32_16x16x32_bf16 a[28:31], v[44:47], v[108:111], a[28:31]
    v_mfma_f32_16x16x32_bf16 a[32:35], v[48:51], v[104:107], a[32:35]
    v_mfma_f32_16x16x32_bf16 a[36:39], v[48:51], v[108:111], a[36:39]
    v_mfma_f32_16x16x32_bf16 a[40:43], v[52:55], v[104:107], a[40:43]
    v_mfma_f32_16x16x32_bf16 a[44:47], v[52:55], v[108:111], a[44:47]
    v_mfma_f32_16x16x32_bf16 a[48:51], v[56:59], v[104:107], a[48:51]
    v_mfma_f32_16x16x32_bf16 a[52:55], v[56:59], v[108:111], a[52:55]
    v_mfma_f32_16x16x32_bf16 a[56:59], v[60:63], v[104:107], a[56:59]
    v_mfma_f32_16x16x32_bf16 a[60:63], v[60:63], v[108:111], a[60:63]
    v_mfma_f32_16x16x32_bf16 a[64:67], v[64:67], v[104:107], a[64:67]
    v_mfma_f32_16x16x32_bf16 a[68:71], v[64:67], v[108:111], a[68:71]
    s_waitcnt lgkmcnt(0)
    v_mfma_f32_16x16x32_bf16 a[0:3], v[68:71], v[112:115], a[0:3]
    v_mfma_f32_16x16x32_bf16 a[4:7], v[68:71], v[116:119], a[4:7]
    v_mfma_f32_16x16x32_bf16 a[8:11], v[72:75], v[112:115], a[8:11]
    v_mfma_f32_16x16x32_bf16 a[12:15], v[72:75], v[116:119], a[12:15]
    v_mfma_f32_16x16x32_bf16 a[16:19], v[76:79], v[112:115], a[16:19]
    v_mfma_f32_16x16x32_bf16 a[20:23], v[76:79], v[116:119], a[20:23]
    v_mfma_f32_16x16x32_bf16 a[24:27], v[80:83], v[112:115], a[24:27]
    v_mfma_f32_16x16x32_bf16 a[28:31], v[80:83], v[116:119], a[28:31]
    v_mfma_f32_16x16x32_bf16 a[32:35], v[84:87], v[112:115], a[32:35]
    v_mfma_f32_16x16x32_bf16 a[36:39], v[84:87], v[116:119], a[36:39]
    v_mfma_f32_16x16x32_bf16 a[40:43], v[88:91], v[112:115], a[40:43]
    v_mfma_f32_16x16x32_bf16 a[44:47], v[88:91], v[116:119], a[44:47]
    v_mfma_f32_16x16x32_bf16 a[48:51], v[92:95], v[112:115], a[48:51]
    v_mfma_f32_16x16x32_bf16 a[52:55], v[92:95], v[116:119], a[52:55]
    v_mfma_f32_16x16x32_bf16 a[56:59], v[96:99], v[112:115], a[56:59]
    v_mfma_f32_16x16x32_bf16 a[60:63], v[96:99], v[116:119], a[60:63]
    v_mfma_f32_16x16x32_bf16 a[64:67], v[100:103], v[112:115], a[64:67]
    v_mfma_f32_16x16x32_bf16 a[68:71], v[100:103], v[116:119], a[68:71]
    s_waitcnt vmcnt(9)
    s_barrier
    s_add_u32 m0, s72, 34816
    s_nop 0
    buffer_load_dwordx4 v2, s[8:11], s40 offen lds
    s_add_u32 s40, s40, s56

    s_add_u32 m0, s73, 34816
    s_nop 0
    buffer_load_dwordx4 v2, s[8:11], s41 offen lds
    s_add_u32 s41, s41, s57

    s_add_u32 m0, s74, 34816
    s_nop 0
    buffer_load_dwordx4 v2, s[8:11], s42 offen lds
    s_add_u32 s42, s42, s58

    s_add_u32 m0, s75, 34816
    s_nop 0
    buffer_load_dwordx4 v2, s[8:11], s43 offen lds
    s_add_u32 s43, s43, s59

    s_add_u32 m0, s76, 34816
    s_nop 0
    buffer_load_dwordx4 v2, s[8:11], s44 offen lds
    s_add_u32 s44, s44, s60

    s_add_u32 m0, s77, 34816
    s_nop 0
    buffer_load_dwordx4 v2, s[8:11], s45 offen lds
    s_add_u32 s45, s45, s61

    s_add_u32 m0, s78, 34816
    s_nop 0
    buffer_load_dwordx4 v2, s[8:11], s46 offen lds
    s_add_u32 s46, s46, s62

    s_add_u32 m0, s79, 34816
    s_nop 0
    buffer_load_dwordx4 v2, s[8:11], s47 offen lds
    s_add_u32 s47, s47, s63

    s_add_u32 m0, s80, 34816
    s_nop 0
    buffer_load_dwordx4 v2, s[8:11], s48 offen lds
    s_add_u32 s48, s48, s64

    ds_read_b128 v[104:107], v18 offset:0
    ds_read_b128 v[108:111], v18 offset:2048
    ds_read_b128 v[32:35], v19 offset:0
    ds_read_b128 v[36:39], v19 offset:2048
    ds_read_b128 v[40:43], v19 offset:4096
    ds_read_b128 v[44:47], v19 offset:6144
    ds_read_b128 v[48:51], v19 offset:8192
    ds_read_b128 v[52:55], v19 offset:10240
    ds_read_b128 v[56:59], v19 offset:12288
    ds_read_b128 v[60:63], v19 offset:14336
    ds_read_b128 v[64:67], v19 offset:16384
    ds_read_b128 v[112:115], v20 offset:0
    ds_read_b128 v[116:119], v20 offset:2048
    ds_read_b128 v[68:71], v21 offset:0
    ds_read_b128 v[72:75], v21 offset:2048
    ds_read_b128 v[76:79], v21 offset:4096
    ds_read_b128 v[80:83], v21 offset:6144
    ds_read_b128 v[84:87], v21 offset:8192
    ds_read_b128 v[88:91], v21 offset:10240
    ds_read_b128 v[92:95], v21 offset:12288
    ds_read_b128 v[96:99], v21 offset:14336
    ds_read_b128 v[100:103], v21 offset:16384
    s_waitcnt lgkmcnt(11)
    v_mfma_f32_16x16x32_bf16 a[0:3], v[32:35], v[104:107], a[0:3]
    v_mfma_f32_16x16x32_bf16 a[4:7], v[32:35], v[108:111], a[4:7]
    v_mfma_f32_16x16x32_bf16 a[8:11], v[36:39], v[104:107], a[8:11]
    v_mfma_f32_16x16x32_bf16 a[12:15], v[36:39], v[108:111], a[12:15]
    v_mfma_f32_16x16x32_bf16 a[16:19], v[40:43], v[104:107], a[16:19]
    v_mfma_f32_16x16x32_bf16 a[20:23], v[40:43], v[108:111], a[20:23]
    v_mfma_f32_16x16x32_bf16 a[24:27], v[44:47], v[104:107], a[24:27]
    v_mfma_f32_16x16x32_bf16 a[28:31], v[44:47], v[108:111], a[28:31]
    v_mfma_f32_16x16x32_bf16 a[32:35], v[48:51], v[104:107], a[32:35]
    v_mfma_f32_16x16x32_bf16 a[36:39], v[48:51], v[108:111], a[36:39]
    v_mfma_f32_16x16x32_bf16 a[40:43], v[52:55], v[104:107], a[40:43]
    v_mfma_f32_16x16x32_bf16 a[44:47], v[52:55], v[108:111], a[44:47]
    v_mfma_f32_16x16x32_bf16 a[48:51], v[56:59], v[104:107], a[48:51]
    v_mfma_f32_16x16x32_bf16 a[52:55], v[56:59], v[108:111], a[52:55]
    v_mfma_f32_16x16x32_bf16 a[56:59], v[60:63], v[104:107], a[56:59]
    v_mfma_f32_16x16x32_bf16 a[60:63], v[60:63], v[108:111], a[60:63]
    v_mfma_f32_16x16x32_bf16 a[64:67], v[64:67], v[104:107], a[64:67]
    v_mfma_f32_16x16x32_bf16 a[68:71], v[64:67], v[108:111], a[68:71]
    s_waitcnt lgkmcnt(0)
    v_mfma_f32_16x16x32_bf16 a[0:3], v[68:71], v[112:115], a[0:3]
    v_mfma_f32_16x16x32_bf16 a[4:7], v[68:71], v[116:119], a[4:7]
    v_mfma_f32_16x16x32_bf16 a[8:11], v[72:75], v[112:115], a[8:11]
    v_mfma_f32_16x16x32_bf16 a[12:15], v[72:75], v[116:119], a[12:15]
    v_mfma_f32_16x16x32_bf16 a[16:19], v[76:79], v[112:115], a[16:19]
    v_mfma_f32_16x16x32_bf16 a[20:23], v[76:79], v[116:119], a[20:23]
    v_mfma_f32_16x16x32_bf16 a[24:27], v[80:83], v[112:115], a[24:27]
    v_mfma_f32_16x16x32_bf16 a[28:31], v[80:83], v[116:119], a[28:31]
    v_mfma_f32_16x16x32_bf16 a[32:35], v[84:87], v[112:115], a[32:35]
    v_mfma_f32_16x16x32_bf16 a[36:39], v[84:87], v[116:119], a[36:39]
    v_mfma_f32_16x16x32_bf16 a[40:43], v[88:91], v[112:115], a[40:43]
    v_mfma_f32_16x16x32_bf16 a[44:47], v[88:91], v[116:119], a[44:47]
    v_mfma_f32_16x16x32_bf16 a[48:51], v[92:95], v[112:115], a[48:51]
    v_mfma_f32_16x16x32_bf16 a[52:55], v[92:95], v[116:119], a[52:55]
    v_mfma_f32_16x16x32_bf16 a[56:59], v[96:99], v[112:115], a[56:59]
    v_mfma_f32_16x16x32_bf16 a[60:63], v[96:99], v[116:119], a[60:63]
    v_mfma_f32_16x16x32_bf16 a[64:67], v[100:103], v[112:115], a[64:67]
    v_mfma_f32_16x16x32_bf16 a[68:71], v[100:103], v[116:119], a[68:71]
    s_waitcnt vmcnt(9)
    s_barrier
    s_add_u32 m0, s72, 69632
    s_nop 0
    buffer_load_dwordx4 v2, s[8:11], s40 offen lds
    s_add_u32 s40, s40, s56

    s_add_u32 m0, s73, 69632
    s_nop 0
    buffer_load_dwordx4 v2, s[8:11], s41 offen lds
    s_add_u32 s41, s41, s57

    s_add_u32 m0, s74, 69632
    s_nop 0
    buffer_load_dwordx4 v2, s[8:11], s42 offen lds
    s_add_u32 s42, s42, s58

    s_add_u32 m0, s75, 69632
    s_nop 0
    buffer_load_dwordx4 v2, s[8:11], s43 offen lds
    s_add_u32 s43, s43, s59

    s_add_u32 m0, s76, 69632
    s_nop 0
    buffer_load_dwordx4 v2, s[8:11], s44 offen lds
    s_add_u32 s44, s44, s60

    s_add_u32 m0, s77, 69632
    s_nop 0
    buffer_load_dwordx4 v2, s[8:11], s45 offen lds
    s_add_u32 s45, s45, s61

    s_add_u32 m0, s78, 69632
    s_nop 0
    buffer_load_dwordx4 v2, s[8:11], s46 offen lds
    s_add_u32 s46, s46, s62

    s_add_u32 m0, s79, 69632
    s_nop 0
    buffer_load_dwordx4 v2, s[8:11], s47 offen lds
    s_add_u32 s47, s47, s63

    s_add_u32 m0, s80, 69632
    s_nop 0
    buffer_load_dwordx4 v2, s[8:11], s48 offen lds
    s_add_u32 s48, s48, s64

    ds_read_b128 v[104:107], v10 offset:0
    ds_read_b128 v[108:111], v10 offset:2048
    ds_read_b128 v[32:35], v11 offset:0
    ds_read_b128 v[36:39], v11 offset:2048
    ds_read_b128 v[40:43], v11 offset:4096
    ds_read_b128 v[44:47], v11 offset:6144
    ds_read_b128 v[48:51], v11 offset:8192
    ds_read_b128 v[52:55], v11 offset:10240
    ds_read_b128 v[56:59], v11 offset:12288
    ds_read_b128 v[60:63], v11 offset:14336
    ds_read_b128 v[64:67], v11 offset:16384
    ds_read_b128 v[112:115], v12 offset:0
    ds_read_b128 v[116:119], v12 offset:2048
    ds_read_b128 v[68:71], v13 offset:0
    ds_read_b128 v[72:75], v13 offset:2048
    ds_read_b128 v[76:79], v13 offset:4096
    ds_read_b128 v[80:83], v13 offset:6144
    ds_read_b128 v[84:87], v13 offset:8192
    ds_read_b128 v[88:91], v13 offset:10240
    ds_read_b128 v[92:95], v13 offset:12288
    ds_read_b128 v[96:99], v13 offset:14336
    ds_read_b128 v[100:103], v13 offset:16384
    s_waitcnt lgkmcnt(11)
    v_mfma_f32_16x16x32_bf16 a[0:3], v[32:35], v[104:107], a[0:3]
    v_mfma_f32_16x16x32_bf16 a[4:7], v[32:35], v[108:111], a[4:7]
    v_mfma_f32_16x16x32_bf16 a[8:11], v[36:39], v[104:107], a[8:11]
    v_mfma_f32_16x16x32_bf16 a[12:15], v[36:39], v[108:111], a[12:15]
    v_mfma_f32_16x16x32_bf16 a[16:19], v[40:43], v[104:107], a[16:19]
    v_mfma_f32_16x16x32_bf16 a[20:23], v[40:43], v[108:111], a[20:23]
    v_mfma_f32_16x16x32_bf16 a[24:27], v[44:47], v[104:107], a[24:27]
    v_mfma_f32_16x16x32_bf16 a[28:31], v[44:47], v[108:111], a[28:31]
    v_mfma_f32_16x16x32_bf16 a[32:35], v[48:51], v[104:107], a[32:35]
    v_mfma_f32_16x16x32_bf16 a[36:39], v[48:51], v[108:111], a[36:39]
    v_mfma_f32_16x16x32_bf16 a[40:43], v[52:55], v[104:107], a[40:43]
    v_mfma_f32_16x16x32_bf16 a[44:47], v[52:55], v[108:111], a[44:47]
    v_mfma_f32_16x16x32_bf16 a[48:51], v[56:59], v[104:107], a[48:51]
    v_mfma_f32_16x16x32_bf16 a[52:55], v[56:59], v[108:111], a[52:55]
    v_mfma_f32_16x16x32_bf16 a[56:59], v[60:63], v[104:107], a[56:59]
    v_mfma_f32_16x16x32_bf16 a[60:63], v[60:63], v[108:111], a[60:63]
    v_mfma_f32_16x16x32_bf16 a[64:67], v[64:67], v[104:107], a[64:67]
    v_mfma_f32_16x16x32_bf16 a[68:71], v[64:67], v[108:111], a[68:71]
    s_waitcnt lgkmcnt(0)
    v_mfma_f32_16x16x32_bf16 a[0:3], v[68:71], v[112:115], a[0:3]
    v_mfma_f32_16x16x32_bf16 a[4:7], v[68:71], v[116:119], a[4:7]
    v_mfma_f32_16x16x32_bf16 a[8:11], v[72:75], v[112:115], a[8:11]
    v_mfma_f32_16x16x32_bf16 a[12:15], v[72:75], v[116:119], a[12:15]
    v_mfma_f32_16x16x32_bf16 a[16:19], v[76:79], v[112:115], a[16:19]
    v_mfma_f32_16x16x32_bf16 a[20:23], v[76:79], v[116:119], a[20:23]
    v_mfma_f32_16x16x32_bf16 a[24:27], v[80:83], v[112:115], a[24:27]
    v_mfma_f32_16x16x32_bf16 a[28:31], v[80:83], v[116:119], a[28:31]
    v_mfma_f32_16x16x32_bf16 a[32:35], v[84:87], v[112:115], a[32:35]
    v_mfma_f32_16x16x32_bf16 a[36:39], v[84:87], v[116:119], a[36:39]
    v_mfma_f32_16x16x32_bf16 a[40:43], v[88:91], v[112:115], a[40:43]
    v_mfma_f32_16x16x32_bf16 a[44:47], v[88:91], v[116:119], a[44:47]
    v_mfma_f32_16x16x32_bf16 a[48:51], v[92:95], v[112:115], a[48:51]
    v_mfma_f32_16x16x32_bf16 a[52:55], v[92:95], v[116:119], a[52:55]
    v_mfma_f32_16x16x32_bf16 a[56:59], v[96:99], v[112:115], a[56:59]
    v_mfma_f32_16x16x32_bf16 a[60:63], v[96:99], v[116:119], a[60:63]
    v_mfma_f32_16x16x32_bf16 a[64:67], v[100:103], v[112:115], a[64:67]
    v_mfma_f32_16x16x32_bf16 a[68:71], v[100:103], v[116:119], a[68:71]
    s_waitcnt vmcnt(9)
    s_barrier
    s_add_u32 m0, s72, 0
    s_nop 0
    buffer_load_dwordx4 v2, s[8:11], s40 offen lds
    s_add_u32 s40, s40, s56

    s_add_u32 m0, s73, 0
    s_nop 0
    buffer_load_dwordx4 v2, s[8:11], s41 offen lds
    s_add_u32 s41, s41, s57

    s_add_u32 m0, s74, 0
    s_nop 0
    buffer_load_dwordx4 v2, s[8:11], s42 offen lds
    s_add_u32 s42, s42, s58

    s_add_u32 m0, s75, 0
    s_nop 0
    buffer_load_dwordx4 v2, s[8:11], s43 offen lds
    s_add_u32 s43, s43, s59

    s_add_u32 m0, s76, 0
    s_nop 0
    buffer_load_dwordx4 v2, s[8:11], s44 offen lds
    s_add_u32 s44, s44, s60

    s_add_u32 m0, s77, 0
    s_nop 0
    buffer_load_dwordx4 v2, s[8:11], s45 offen lds
    s_add_u32 s45, s45, s61

    s_add_u32 m0, s78, 0
    s_nop 0
    buffer_load_dwordx4 v2, s[8:11], s46 offen lds
    s_add_u32 s46, s46, s62

    s_add_u32 m0, s79, 0
    s_nop 0
    buffer_load_dwordx4 v2, s[8:11], s47 offen lds
    s_add_u32 s47, s47, s63

    s_add_u32 m0, s80, 0
    s_nop 0
    buffer_load_dwordx4 v2, s[8:11], s48 offen lds
    s_add_u32 s48, s48, s64

    ds_read_b128 v[104:107], v14 offset:0
    ds_read_b128 v[108:111], v14 offset:2048
    ds_read_b128 v[32:35], v15 offset:0
    ds_read_b128 v[36:39], v15 offset:2048
    ds_read_b128 v[40:43], v15 offset:4096
    ds_read_b128 v[44:47], v15 offset:6144
    ds_read_b128 v[48:51], v15 offset:8192
    ds_read_b128 v[52:55], v15 offset:10240
    ds_read_b128 v[56:59], v15 offset:12288
    ds_read_b128 v[60:63], v15 offset:14336
    ds_read_b128 v[64:67], v15 offset:16384
    ds_read_b128 v[112:115], v16 offset:0
    ds_read_b128 v[116:119], v16 offset:2048
    ds_read_b128 v[68:71], v17 offset:0
    ds_read_b128 v[72:75], v17 offset:2048
    ds_read_b128 v[76:79], v17 offset:4096
    ds_read_b128 v[80:83], v17 offset:6144
    ds_read_b128 v[84:87], v17 offset:8192
    ds_read_b128 v[88:91], v17 offset:10240
    ds_read_b128 v[92:95], v17 offset:12288
    ds_read_b128 v[96:99], v17 offset:14336
    ds_read_b128 v[100:103], v17 offset:16384
    s_waitcnt lgkmcnt(11)
    v_mfma_f32_16x16x32_bf16 a[0:3], v[32:35], v[104:107], a[0:3]
    v_mfma_f32_16x16x32_bf16 a[4:7], v[32:35], v[108:111], a[4:7]
    v_mfma_f32_16x16x32_bf16 a[8:11], v[36:39], v[104:107], a[8:11]
    v_mfma_f32_16x16x32_bf16 a[12:15], v[36:39], v[108:111], a[12:15]
    v_mfma_f32_16x16x32_bf16 a[16:19], v[40:43], v[104:107], a[16:19]
    v_mfma_f32_16x16x32_bf16 a[20:23], v[40:43], v[108:111], a[20:23]
    v_mfma_f32_16x16x32_bf16 a[24:27], v[44:47], v[104:107], a[24:27]
    v_mfma_f32_16x16x32_bf16 a[28:31], v[44:47], v[108:111], a[28:31]
    v_mfma_f32_16x16x32_bf16 a[32:35], v[48:51], v[104:107], a[32:35]
    v_mfma_f32_16x16x32_bf16 a[36:39], v[48:51], v[108:111], a[36:39]
    v_mfma_f32_16x16x32_bf16 a[40:43], v[52:55], v[104:107], a[40:43]
    v_mfma_f32_16x16x32_bf16 a[44:47], v[52:55], v[108:111], a[44:47]
    v_mfma_f32_16x16x32_bf16 a[48:51], v[56:59], v[104:107], a[48:51]
    v_mfma_f32_16x16x32_bf16 a[52:55], v[56:59], v[108:111], a[52:55]
    v_mfma_f32_16x16x32_bf16 a[56:59], v[60:63], v[104:107], a[56:59]
    v_mfma_f32_16x16x32_bf16 a[60:63], v[60:63], v[108:111], a[60:63]
    v_mfma_f32_16x16x32_bf16 a[64:67], v[64:67], v[104:107], a[64:67]
    v_mfma_f32_16x16x32_bf16 a[68:71], v[64:67], v[108:111], a[68:71]
    s_waitcnt lgkmcnt(0)
    v_mfma_f32_16x16x32_bf16 a[0:3], v[68:71], v[112:115], a[0:3]
    v_mfma_f32_16x16x32_bf16 a[4:7], v[68:71], v[116:119], a[4:7]
    v_mfma_f32_16x16x32_bf16 a[8:11], v[72:75], v[112:115], a[8:11]
    v_mfma_f32_16x16x32_bf16 a[12:15], v[72:75], v[116:119], a[12:15]
    v_mfma_f32_16x16x32_bf16 a[16:19], v[76:79], v[112:115], a[16:19]
    v_mfma_f32_16x16x32_bf16 a[20:23], v[76:79], v[116:119], a[20:23]
    v_mfma_f32_16x16x32_bf16 a[24:27], v[80:83], v[112:115], a[24:27]
    v_mfma_f32_16x16x32_bf16 a[28:31], v[80:83], v[116:119], a[28:31]
    v_mfma_f32_16x16x32_bf16 a[32:35], v[84:87], v[112:115], a[32:35]
    v_mfma_f32_16x16x32_bf16 a[36:39], v[84:87], v[116:119], a[36:39]
    v_mfma_f32_16x16x32_bf16 a[40:43], v[88:91], v[112:115], a[40:43]
    v_mfma_f32_16x16x32_bf16 a[44:47], v[88:91], v[116:119], a[44:47]
    v_mfma_f32_16x16x32_bf16 a[48:51], v[92:95], v[112:115], a[48:51]
    v_mfma_f32_16x16x32_bf16 a[52:55], v[92:95], v[116:119], a[52:55]
    v_mfma_f32_16x16x32_bf16 a[56:59], v[96:99], v[112:115], a[56:59]
    v_mfma_f32_16x16x32_bf16 a[60:63], v[96:99], v[116:119], a[60:63]
    v_mfma_f32_16x16x32_bf16 a[64:67], v[100:103], v[112:115], a[64:67]
    v_mfma_f32_16x16x32_bf16 a[68:71], v[100:103], v[116:119], a[68:71]
    s_waitcnt vmcnt(9)
    s_barrier
    s_add_u32 m0, s72, 34816
    s_nop 0
    buffer_load_dwordx4 v2, s[8:11], s40 offen lds
    s_add_u32 s40, s40, s56

    s_add_u32 m0, s73, 34816
    s_nop 0
    buffer_load_dwordx4 v2, s[8:11], s41 offen lds
    s_add_u32 s41, s41, s57

    s_add_u32 m0, s74, 34816
    s_nop 0
    buffer_load_dwordx4 v2, s[8:11], s42 offen lds
    s_add_u32 s42, s42, s58

    s_add_u32 m0, s75, 34816
    s_nop 0
    buffer_load_dwordx4 v2, s[8:11], s43 offen lds
    s_add_u32 s43, s43, s59

    s_add_u32 m0, s76, 34816
    s_nop 0
    buffer_load_dwordx4 v2, s[8:11], s44 offen lds
    s_add_u32 s44, s44, s60

    s_add_u32 m0, s77, 34816
    s_nop 0
    buffer_load_dwordx4 v2, s[8:11], s45 offen lds
    s_add_u32 s45, s45, s61

    s_add_u32 m0, s78, 34816
    s_nop 0
    buffer_load_dwordx4 v2, s[8:11], s46 offen lds
    s_add_u32 s46, s46, s62

    s_add_u32 m0, s79, 34816
    s_nop 0
    buffer_load_dwordx4 v2, s[8:11], s47 offen lds
    s_add_u32 s47, s47, s63

    s_add_u32 m0, s80, 34816
    s_nop 0
    buffer_load_dwordx4 v2, s[8:11], s48 offen lds
    s_add_u32 s48, s48, s64

    ds_read_b128 v[104:107], v18 offset:0
    ds_read_b128 v[108:111], v18 offset:2048
    ds_read_b128 v[32:35], v19 offset:0
    ds_read_b128 v[36:39], v19 offset:2048
    ds_read_b128 v[40:43], v19 offset:4096
    ds_read_b128 v[44:47], v19 offset:6144
    ds_read_b128 v[48:51], v19 offset:8192
    ds_read_b128 v[52:55], v19 offset:10240
    ds_read_b128 v[56:59], v19 offset:12288
    ds_read_b128 v[60:63], v19 offset:14336
    ds_read_b128 v[64:67], v19 offset:16384
    ds_read_b128 v[112:115], v20 offset:0
    ds_read_b128 v[116:119], v20 offset:2048
    ds_read_b128 v[68:71], v21 offset:0
    ds_read_b128 v[72:75], v21 offset:2048
    ds_read_b128 v[76:79], v21 offset:4096
    ds_read_b128 v[80:83], v21 offset:6144
    ds_read_b128 v[84:87], v21 offset:8192
    ds_read_b128 v[88:91], v21 offset:10240
    ds_read_b128 v[92:95], v21 offset:12288
    ds_read_b128 v[96:99], v21 offset:14336
    ds_read_b128 v[100:103], v21 offset:16384
    s_waitcnt lgkmcnt(11)
    v_mfma_f32_16x16x32_bf16 a[0:3], v[32:35], v[104:107], a[0:3]
    v_mfma_f32_16x16x32_bf16 a[4:7], v[32:35], v[108:111], a[4:7]
    v_mfma_f32_16x16x32_bf16 a[8:11], v[36:39], v[104:107], a[8:11]
    v_mfma_f32_16x16x32_bf16 a[12:15], v[36:39], v[108:111], a[12:15]
    v_mfma_f32_16x16x32_bf16 a[16:19], v[40:43], v[104:107], a[16:19]
    v_mfma_f32_16x16x32_bf16 a[20:23], v[40:43], v[108:111], a[20:23]
    v_mfma_f32_16x16x32_bf16 a[24:27], v[44:47], v[104:107], a[24:27]
    v_mfma_f32_16x16x32_bf16 a[28:31], v[44:47], v[108:111], a[28:31]
    v_mfma_f32_16x16x32_bf16 a[32:35], v[48:51], v[104:107], a[32:35]
    v_mfma_f32_16x16x32_bf16 a[36:39], v[48:51], v[108:111], a[36:39]
    v_mfma_f32_16x16x32_bf16 a[40:43], v[52:55], v[104:107], a[40:43]
    v_mfma_f32_16x16x32_bf16 a[44:47], v[52:55], v[108:111], a[44:47]
    v_mfma_f32_16x16x32_bf16 a[48:51], v[56:59], v[104:107], a[48:51]
    v_mfma_f32_16x16x32_bf16 a[52:55], v[56:59], v[108:111], a[52:55]
    v_mfma_f32_16x16x32_bf16 a[56:59], v[60:63], v[104:107], a[56:59]
    v_mfma_f32_16x16x32_bf16 a[60:63], v[60:63], v[108:111], a[60:63]
    v_mfma_f32_16x16x32_bf16 a[64:67], v[64:67], v[104:107], a[64:67]
    v_mfma_f32_16x16x32_bf16 a[68:71], v[64:67], v[108:111], a[68:71]
    s_waitcnt lgkmcnt(0)
    v_mfma_f32_16x16x32_bf16 a[0:3], v[68:71], v[112:115], a[0:3]
    v_mfma_f32_16x16x32_bf16 a[4:7], v[68:71], v[116:119], a[4:7]
    v_mfma_f32_16x16x32_bf16 a[8:11], v[72:75], v[112:115], a[8:11]
    v_mfma_f32_16x16x32_bf16 a[12:15], v[72:75], v[116:119], a[12:15]
    v_mfma_f32_16x16x32_bf16 a[16:19], v[76:79], v[112:115], a[16:19]
    v_mfma_f32_16x16x32_bf16 a[20:23], v[76:79], v[116:119], a[20:23]
    v_mfma_f32_16x16x32_bf16 a[24:27], v[80:83], v[112:115], a[24:27]
    v_mfma_f32_16x16x32_bf16 a[28:31], v[80:83], v[116:119], a[28:31]
    v_mfma_f32_16x16x32_bf16 a[32:35], v[84:87], v[112:115], a[32:35]
    v_mfma_f32_16x16x32_bf16 a[36:39], v[84:87], v[116:119], a[36:39]
    v_mfma_f32_16x16x32_bf16 a[40:43], v[88:91], v[112:115], a[40:43]
    v_mfma_f32_16x16x32_bf16 a[44:47], v[88:91], v[116:119], a[44:47]
    v_mfma_f32_16x16x32_bf16 a[48:51], v[92:95], v[112:115], a[48:51]
    v_mfma_f32_16x16x32_bf16 a[52:55], v[92:95], v[116:119], a[52:55]
    v_mfma_f32_16x16x32_bf16 a[56:59], v[96:99], v[112:115], a[56:59]
    v_mfma_f32_16x16x32_bf16 a[60:63], v[96:99], v[116:119], a[60:63]
    v_mfma_f32_16x16x32_bf16 a[64:67], v[100:103], v[112:115], a[64:67]
    v_mfma_f32_16x16x32_bf16 a[68:71], v[100:103], v[116:119], a[68:71]
    s_waitcnt vmcnt(9)
    s_barrier
    s_add_u32 m0, s72, 69632
    s_nop 0
    buffer_load_dwordx4 v2, s[8:11], s40 offen lds
    s_add_u32 s40, s40, s56

    s_add_u32 m0, s73, 69632
    s_nop 0
    buffer_load_dwordx4 v2, s[8:11], s41 offen lds
    s_add_u32 s41, s41, s57

    s_add_u32 m0, s74, 69632
    s_nop 0
    buffer_load_dwordx4 v2, s[8:11], s42 offen lds
    s_add_u32 s42, s42, s58

    s_add_u32 m0, s75, 69632
    s_nop 0
    buffer_load_dwordx4 v2, s[8:11], s43 offen lds
    s_add_u32 s43, s43, s59

    s_add_u32 m0, s76, 69632
    s_nop 0
    buffer_load_dwordx4 v2, s[8:11], s44 offen lds
    s_add_u32 s44, s44, s60

    s_add_u32 m0, s77, 69632
    s_nop 0
    buffer_load_dwordx4 v2, s[8:11], s45 offen lds
    s_add_u32 s45, s45, s61

    s_add_u32 m0, s78, 69632
    s_nop 0
    buffer_load_dwordx4 v2, s[8:11], s46 offen lds
    s_add_u32 s46, s46, s62

    s_add_u32 m0, s79, 69632
    s_nop 0
    buffer_load_dwordx4 v2, s[8:11], s47 offen lds
    s_add_u32 s47, s47, s63

    s_add_u32 m0, s80, 69632
    s_nop 0
    buffer_load_dwordx4 v2, s[8:11], s48 offen lds
    s_add_u32 s48, s48, s64

    ds_read_b128 v[104:107], v10 offset:0
    ds_read_b128 v[108:111], v10 offset:2048
    ds_read_b128 v[32:35], v11 offset:0
    ds_read_b128 v[36:39], v11 offset:2048
    ds_read_b128 v[40:43], v11 offset:4096
    ds_read_b128 v[44:47], v11 offset:6144
    ds_read_b128 v[48:51], v11 offset:8192
    ds_read_b128 v[52:55], v11 offset:10240
    ds_read_b128 v[56:59], v11 offset:12288
    ds_read_b128 v[60:63], v11 offset:14336
    ds_read_b128 v[64:67], v11 offset:16384
    ds_read_b128 v[112:115], v12 offset:0
    ds_read_b128 v[116:119], v12 offset:2048
    ds_read_b128 v[68:71], v13 offset:0
    ds_read_b128 v[72:75], v13 offset:2048
    ds_read_b128 v[76:79], v13 offset:4096
    ds_read_b128 v[80:83], v13 offset:6144
    ds_read_b128 v[84:87], v13 offset:8192
    ds_read_b128 v[88:91], v13 offset:10240
    ds_read_b128 v[92:95], v13 offset:12288
    ds_read_b128 v[96:99], v13 offset:14336
    ds_read_b128 v[100:103], v13 offset:16384
    s_waitcnt lgkmcnt(11)
    v_mfma_f32_16x16x32_bf16 a[0:3], v[32:35], v[104:107], a[0:3]
    v_mfma_f32_16x16x32_bf16 a[4:7], v[32:35], v[108:111], a[4:7]
    v_mfma_f32_16x16x32_bf16 a[8:11], v[36:39], v[104:107], a[8:11]
    v_mfma_f32_16x16x32_bf16 a[12:15], v[36:39], v[108:111], a[12:15]
    v_mfma_f32_16x16x32_bf16 a[16:19], v[40:43], v[104:107], a[16:19]
    v_mfma_f32_16x16x32_bf16 a[20:23], v[40:43], v[108:111], a[20:23]
    v_mfma_f32_16x16x32_bf16 a[24:27], v[44:47], v[104:107], a[24:27]
    v_mfma_f32_16x16x32_bf16 a[28:31], v[44:47], v[108:111], a[28:31]
    v_mfma_f32_16x16x32_bf16 a[32:35], v[48:51], v[104:107], a[32:35]
    v_mfma_f32_16x16x32_bf16 a[36:39], v[48:51], v[108:111], a[36:39]
    v_mfma_f32_16x16x32_bf16 a[40:43], v[52:55], v[104:107], a[40:43]
    v_mfma_f32_16x16x32_bf16 a[44:47], v[52:55], v[108:111], a[44:47]
    v_mfma_f32_16x16x32_bf16 a[48:51], v[56:59], v[104:107], a[48:51]
    v_mfma_f32_16x16x32_bf16 a[52:55], v[56:59], v[108:111], a[52:55]
    v_mfma_f32_16x16x32_bf16 a[56:59], v[60:63], v[104:107], a[56:59]
    v_mfma_f32_16x16x32_bf16 a[60:63], v[60:63], v[108:111], a[60:63]
    v_mfma_f32_16x16x32_bf16 a[64:67], v[64:67], v[104:107], a[64:67]
    v_mfma_f32_16x16x32_bf16 a[68:71], v[64:67], v[108:111], a[68:71]
    s_waitcnt lgkmcnt(0)
    v_mfma_f32_16x16x32_bf16 a[0:3], v[68:71], v[112:115], a[0:3]
    v_mfma_f32_16x16x32_bf16 a[4:7], v[68:71], v[116:119], a[4:7]
    v_mfma_f32_16x16x32_bf16 a[8:11], v[72:75], v[112:115], a[8:11]
    v_mfma_f32_16x16x32_bf16 a[12:15], v[72:75], v[116:119], a[12:15]
    v_mfma_f32_16x16x32_bf16 a[16:19], v[76:79], v[112:115], a[16:19]
    v_mfma_f32_16x16x32_bf16 a[20:23], v[76:79], v[116:119], a[20:23]
    v_mfma_f32_16x16x32_bf16 a[24:27], v[80:83], v[112:115], a[24:27]
    v_mfma_f32_16x16x32_bf16 a[28:31], v[80:83], v[116:119], a[28:31]
    v_mfma_f32_16x16x32_bf16 a[32:35], v[84:87], v[112:115], a[32:35]
    v_mfma_f32_16x16x32_bf16 a[36:39], v[84:87], v[116:119], a[36:39]
    v_mfma_f32_16x16x32_bf16 a[40:43], v[88:91], v[112:115], a[40:43]
    v_mfma_f32_16x16x32_bf16 a[44:47], v[88:91], v[116:119], a[44:47]
    v_mfma_f32_16x16x32_bf16 a[48:51], v[92:95], v[112:115], a[48:51]
    v_mfma_f32_16x16x32_bf16 a[52:55], v[92:95], v[116:119], a[52:55]
    v_mfma_f32_16x16x32_bf16 a[56:59], v[96:99], v[112:115], a[56:59]
    v_mfma_f32_16x16x32_bf16 a[60:63], v[96:99], v[116:119], a[60:63]
    v_mfma_f32_16x16x32_bf16 a[64:67], v[100:103], v[112:115], a[64:67]
    v_mfma_f32_16x16x32_bf16 a[68:71], v[100:103], v[116:119], a[68:71]
    s_waitcnt vmcnt(9)
    s_barrier
    s_add_u32 m0, s72, 0
    s_nop 0
    buffer_load_dwordx4 v2, s[8:11], s40 offen lds
    s_add_u32 s40, s40, s56

    s_add_u32 m0, s73, 0
    s_nop 0
    buffer_load_dwordx4 v2, s[8:11], s41 offen lds
    s_add_u32 s41, s41, s57

    s_add_u32 m0, s74, 0
    s_nop 0
    buffer_load_dwordx4 v2, s[8:11], s42 offen lds
    s_add_u32 s42, s42, s58

    s_add_u32 m0, s75, 0
    s_nop 0
    buffer_load_dwordx4 v2, s[8:11], s43 offen lds
    s_add_u32 s43, s43, s59

    s_add_u32 m0, s76, 0
    s_nop 0
    buffer_load_dwordx4 v2, s[8:11], s44 offen lds
    s_add_u32 s44, s44, s60

    s_add_u32 m0, s77, 0
    s_nop 0
    buffer_load_dwordx4 v2, s[8:11], s45 offen lds
    s_add_u32 s45, s45, s61

    s_add_u32 m0, s78, 0
    s_nop 0
    buffer_load_dwordx4 v2, s[8:11], s46 offen lds
    s_add_u32 s46, s46, s62

    s_add_u32 m0, s79, 0
    s_nop 0
    buffer_load_dwordx4 v2, s[8:11], s47 offen lds
    s_add_u32 s47, s47, s63

    s_add_u32 m0, s80, 0
    s_nop 0
    buffer_load_dwordx4 v2, s[8:11], s48 offen lds
    s_add_u32 s48, s48, s64

    ds_read_b128 v[104:107], v14 offset:0
    ds_read_b128 v[108:111], v14 offset:2048
    ds_read_b128 v[32:35], v15 offset:0
    ds_read_b128 v[36:39], v15 offset:2048
    ds_read_b128 v[40:43], v15 offset:4096
    ds_read_b128 v[44:47], v15 offset:6144
    ds_read_b128 v[48:51], v15 offset:8192
    ds_read_b128 v[52:55], v15 offset:10240
    ds_read_b128 v[56:59], v15 offset:12288
    ds_read_b128 v[60:63], v15 offset:14336
    ds_read_b128 v[64:67], v15 offset:16384
    ds_read_b128 v[112:115], v16 offset:0
    ds_read_b128 v[116:119], v16 offset:2048
    ds_read_b128 v[68:71], v17 offset:0
    ds_read_b128 v[72:75], v17 offset:2048
    ds_read_b128 v[76:79], v17 offset:4096
    ds_read_b128 v[80:83], v17 offset:6144
    ds_read_b128 v[84:87], v17 offset:8192
    ds_read_b128 v[88:91], v17 offset:10240
    ds_read_b128 v[92:95], v17 offset:12288
    ds_read_b128 v[96:99], v17 offset:14336
    ds_read_b128 v[100:103], v17 offset:16384
    s_waitcnt lgkmcnt(11)
    v_mfma_f32_16x16x32_bf16 a[0:3], v[32:35], v[104:107], a[0:3]
    v_mfma_f32_16x16x32_bf16 a[4:7], v[32:35], v[108:111], a[4:7]
    v_mfma_f32_16x16x32_bf16 a[8:11], v[36:39], v[104:107], a[8:11]
    v_mfma_f32_16x16x32_bf16 a[12:15], v[36:39], v[108:111], a[12:15]
    v_mfma_f32_16x16x32_bf16 a[16:19], v[40:43], v[104:107], a[16:19]
    v_mfma_f32_16x16x32_bf16 a[20:23], v[40:43], v[108:111], a[20:23]
    v_mfma_f32_16x16x32_bf16 a[24:27], v[44:47], v[104:107], a[24:27]
    v_mfma_f32_16x16x32_bf16 a[28:31], v[44:47], v[108:111], a[28:31]
    v_mfma_f32_16x16x32_bf16 a[32:35], v[48:51], v[104:107], a[32:35]
    v_mfma_f32_16x16x32_bf16 a[36:39], v[48:51], v[108:111], a[36:39]
    v_mfma_f32_16x16x32_bf16 a[40:43], v[52:55], v[104:107], a[40:43]
    v_mfma_f32_16x16x32_bf16 a[44:47], v[52:55], v[108:111], a[44:47]
    v_mfma_f32_16x16x32_bf16 a[48:51], v[56:59], v[104:107], a[48:51]
    v_mfma_f32_16x16x32_bf16 a[52:55], v[56:59], v[108:111], a[52:55]
    v_mfma_f32_16x16x32_bf16 a[56:59], v[60:63], v[104:107], a[56:59]
    v_mfma_f32_16x16x32_bf16 a[60:63], v[60:63], v[108:111], a[60:63]
    v_mfma_f32_16x16x32_bf16 a[64:67], v[64:67], v[104:107], a[64:67]
    v_mfma_f32_16x16x32_bf16 a[68:71], v[64:67], v[108:111], a[68:71]
    s_waitcnt lgkmcnt(0)
    v_mfma_f32_16x16x32_bf16 a[0:3], v[68:71], v[112:115], a[0:3]
    v_mfma_f32_16x16x32_bf16 a[4:7], v[68:71], v[116:119], a[4:7]
    v_mfma_f32_16x16x32_bf16 a[8:11], v[72:75], v[112:115], a[8:11]
    v_mfma_f32_16x16x32_bf16 a[12:15], v[72:75], v[116:119], a[12:15]
    v_mfma_f32_16x16x32_bf16 a[16:19], v[76:79], v[112:115], a[16:19]
    v_mfma_f32_16x16x32_bf16 a[20:23], v[76:79], v[116:119], a[20:23]
    v_mfma_f32_16x16x32_bf16 a[24:27], v[80:83], v[112:115], a[24:27]
    v_mfma_f32_16x16x32_bf16 a[28:31], v[80:83], v[116:119], a[28:31]
    v_mfma_f32_16x16x32_bf16 a[32:35], v[84:87], v[112:115], a[32:35]
    v_mfma_f32_16x16x32_bf16 a[36:39], v[84:87], v[116:119], a[36:39]
    v_mfma_f32_16x16x32_bf16 a[40:43], v[88:91], v[112:115], a[40:43]
    v_mfma_f32_16x16x32_bf16 a[44:47], v[88:91], v[116:119], a[44:47]
    v_mfma_f32_16x16x32_bf16 a[48:51], v[92:95], v[112:115], a[48:51]
    v_mfma_f32_16x16x32_bf16 a[52:55], v[92:95], v[116:119], a[52:55]
    v_mfma_f32_16x16x32_bf16 a[56:59], v[96:99], v[112:115], a[56:59]
    v_mfma_f32_16x16x32_bf16 a[60:63], v[96:99], v[116:119], a[60:63]
    v_mfma_f32_16x16x32_bf16 a[64:67], v[100:103], v[112:115], a[64:67]
    v_mfma_f32_16x16x32_bf16 a[68:71], v[100:103], v[116:119], a[68:71]
    s_waitcnt vmcnt(9)
    s_barrier
    s_add_u32 m0, s72, 34816
    s_nop 0
    buffer_load_dwordx4 v2, s[8:11], s40 offen lds
    s_add_u32 s40, s40, s56

    s_add_u32 m0, s73, 34816
    s_nop 0
    buffer_load_dwordx4 v2, s[8:11], s41 offen lds
    s_add_u32 s41, s41, s57

    s_add_u32 m0, s74, 34816
    s_nop 0
    buffer_load_dwordx4 v2, s[8:11], s42 offen lds
    s_add_u32 s42, s42, s58

    s_add_u32 m0, s75, 34816
    s_nop 0
    buffer_load_dwordx4 v2, s[8:11], s43 offen lds
    s_add_u32 s43, s43, s59

    s_add_u32 m0, s76, 34816
    s_nop 0
    buffer_load_dwordx4 v2, s[8:11], s44 offen lds
    s_add_u32 s44, s44, s60

    s_add_u32 m0, s77, 34816
    s_nop 0
    buffer_load_dwordx4 v2, s[8:11], s45 offen lds
    s_add_u32 s45, s45, s61

    s_add_u32 m0, s78, 34816
    s_nop 0
    buffer_load_dwordx4 v2, s[8:11], s46 offen lds
    s_add_u32 s46, s46, s62

    s_add_u32 m0, s79, 34816
    s_nop 0
    buffer_load_dwordx4 v2, s[8:11], s47 offen lds
    s_add_u32 s47, s47, s63

    s_add_u32 m0, s80, 34816
    s_nop 0
    buffer_load_dwordx4 v2, s[8:11], s48 offen lds
    s_add_u32 s48, s48, s64

    ds_read_b128 v[104:107], v18 offset:0
    ds_read_b128 v[108:111], v18 offset:2048
    ds_read_b128 v[32:35], v19 offset:0
    ds_read_b128 v[36:39], v19 offset:2048
    ds_read_b128 v[40:43], v19 offset:4096
    ds_read_b128 v[44:47], v19 offset:6144
    ds_read_b128 v[48:51], v19 offset:8192
    ds_read_b128 v[52:55], v19 offset:10240
    ds_read_b128 v[56:59], v19 offset:12288
    ds_read_b128 v[60:63], v19 offset:14336
    ds_read_b128 v[64:67], v19 offset:16384
    ds_read_b128 v[112:115], v20 offset:0
    ds_read_b128 v[116:119], v20 offset:2048
    ds_read_b128 v[68:71], v21 offset:0
    ds_read_b128 v[72:75], v21 offset:2048
    ds_read_b128 v[76:79], v21 offset:4096
    ds_read_b128 v[80:83], v21 offset:6144
    ds_read_b128 v[84:87], v21 offset:8192
    ds_read_b128 v[88:91], v21 offset:10240
    ds_read_b128 v[92:95], v21 offset:12288
    ds_read_b128 v[96:99], v21 offset:14336
    ds_read_b128 v[100:103], v21 offset:16384
    s_waitcnt lgkmcnt(11)
    v_mfma_f32_16x16x32_bf16 a[0:3], v[32:35], v[104:107], a[0:3]
    v_mfma_f32_16x16x32_bf16 a[4:7], v[32:35], v[108:111], a[4:7]
    v_mfma_f32_16x16x32_bf16 a[8:11], v[36:39], v[104:107], a[8:11]
    v_mfma_f32_16x16x32_bf16 a[12:15], v[36:39], v[108:111], a[12:15]
    v_mfma_f32_16x16x32_bf16 a[16:19], v[40:43], v[104:107], a[16:19]
    v_mfma_f32_16x16x32_bf16 a[20:23], v[40:43], v[108:111], a[20:23]
    v_mfma_f32_16x16x32_bf16 a[24:27], v[44:47], v[104:107], a[24:27]
    v_mfma_f32_16x16x32_bf16 a[28:31], v[44:47], v[108:111], a[28:31]
    v_mfma_f32_16x16x32_bf16 a[32:35], v[48:51], v[104:107], a[32:35]
    v_mfma_f32_16x16x32_bf16 a[36:39], v[48:51], v[108:111], a[36:39]
    v_mfma_f32_16x16x32_bf16 a[40:43], v[52:55], v[104:107], a[40:43]
    v_mfma_f32_16x16x32_bf16 a[44:47], v[52:55], v[108:111], a[44:47]
    v_mfma_f32_16x16x32_bf16 a[48:51], v[56:59], v[104:107], a[48:51]
    v_mfma_f32_16x16x32_bf16 a[52:55], v[56:59], v[108:111], a[52:55]
    v_mfma_f32_16x16x32_bf16 a[56:59], v[60:63], v[104:107], a[56:59]
    v_mfma_f32_16x16x32_bf16 a[60:63], v[60:63], v[108:111], a[60:63]
    v_mfma_f32_16x16x32_bf16 a[64:67], v[64:67], v[104:107], a[64:67]
    v_mfma_f32_16x16x32_bf16 a[68:71], v[64:67], v[108:111], a[68:71]
    s_waitcnt lgkmcnt(0)
    v_mfma_f32_16x16x32_bf16 a[0:3], v[68:71], v[112:115], a[0:3]
    v_mfma_f32_16x16x32_bf16 a[4:7], v[68:71], v[116:119], a[4:7]
    v_mfma_f32_16x16x32_bf16 a[8:11], v[72:75], v[112:115], a[8:11]
    v_mfma_f32_16x16x32_bf16 a[12:15], v[72:75], v[116:119], a[12:15]
    v_mfma_f32_16x16x32_bf16 a[16:19], v[76:79], v[112:115], a[16:19]
    v_mfma_f32_16x16x32_bf16 a[20:23], v[76:79], v[116:119], a[20:23]
    v_mfma_f32_16x16x32_bf16 a[24:27], v[80:83], v[112:115], a[24:27]
    v_mfma_f32_16x16x32_bf16 a[28:31], v[80:83], v[116:119], a[28:31]
    v_mfma_f32_16x16x32_bf16 a[32:35], v[84:87], v[112:115], a[32:35]
    v_mfma_f32_16x16x32_bf16 a[36:39], v[84:87], v[116:119], a[36:39]
    v_mfma_f32_16x16x32_bf16 a[40:43], v[88:91], v[112:115], a[40:43]
    v_mfma_f32_16x16x32_bf16 a[44:47], v[88:91], v[116:119], a[44:47]
    v_mfma_f32_16x16x32_bf16 a[48:51], v[92:95], v[112:115], a[48:51]
    v_mfma_f32_16x16x32_bf16 a[52:55], v[92:95], v[116:119], a[52:55]
    v_mfma_f32_16x16x32_bf16 a[56:59], v[96:99], v[112:115], a[56:59]
    v_mfma_f32_16x16x32_bf16 a[60:63], v[96:99], v[116:119], a[60:63]
    v_mfma_f32_16x16x32_bf16 a[64:67], v[100:103], v[112:115], a[64:67]
    v_mfma_f32_16x16x32_bf16 a[68:71], v[100:103], v[116:119], a[68:71]
    s_waitcnt vmcnt(9)
    s_barrier
    s_add_u32 m0, s72, 69632
    s_nop 0
    buffer_load_dwordx4 v2, s[8:11], s40 offen lds
    s_add_u32 s40, s40, s56

    s_add_u32 m0, s73, 69632
    s_nop 0
    buffer_load_dwordx4 v2, s[8:11], s41 offen lds
    s_add_u32 s41, s41, s57

    s_add_u32 m0, s74, 69632
    s_nop 0
    buffer_load_dwordx4 v2, s[8:11], s42 offen lds
    s_add_u32 s42, s42, s58

    s_add_u32 m0, s75, 69632
    s_nop 0
    buffer_load_dwordx4 v2, s[8:11], s43 offen lds
    s_add_u32 s43, s43, s59

    s_add_u32 m0, s76, 69632
    s_nop 0
    buffer_load_dwordx4 v2, s[8:11], s44 offen lds
    s_add_u32 s44, s44, s60

    s_add_u32 m0, s77, 69632
    s_nop 0
    buffer_load_dwordx4 v2, s[8:11], s45 offen lds
    s_add_u32 s45, s45, s61

    s_add_u32 m0, s78, 69632
    s_nop 0
    buffer_load_dwordx4 v2, s[8:11], s46 offen lds
    s_add_u32 s46, s46, s62

    s_add_u32 m0, s79, 69632
    s_nop 0
    buffer_load_dwordx4 v2, s[8:11], s47 offen lds
    s_add_u32 s47, s47, s63

    s_add_u32 m0, s80, 69632
    s_nop 0
    buffer_load_dwordx4 v2, s[8:11], s48 offen lds
    s_add_u32 s48, s48, s64

    ds_read_b128 v[104:107], v10 offset:0
    ds_read_b128 v[108:111], v10 offset:2048
    ds_read_b128 v[32:35], v11 offset:0
    ds_read_b128 v[36:39], v11 offset:2048
    ds_read_b128 v[40:43], v11 offset:4096
    ds_read_b128 v[44:47], v11 offset:6144
    ds_read_b128 v[48:51], v11 offset:8192
    ds_read_b128 v[52:55], v11 offset:10240
    ds_read_b128 v[56:59], v11 offset:12288
    ds_read_b128 v[60:63], v11 offset:14336
    ds_read_b128 v[64:67], v11 offset:16384
    ds_read_b128 v[112:115], v12 offset:0
    ds_read_b128 v[116:119], v12 offset:2048
    ds_read_b128 v[68:71], v13 offset:0
    ds_read_b128 v[72:75], v13 offset:2048
    ds_read_b128 v[76:79], v13 offset:4096
    ds_read_b128 v[80:83], v13 offset:6144
    ds_read_b128 v[84:87], v13 offset:8192
    ds_read_b128 v[88:91], v13 offset:10240
    ds_read_b128 v[92:95], v13 offset:12288
    ds_read_b128 v[96:99], v13 offset:14336
    ds_read_b128 v[100:103], v13 offset:16384
    s_waitcnt lgkmcnt(11)
    v_mfma_f32_16x16x32_bf16 a[0:3], v[32:35], v[104:107], a[0:3]
    v_mfma_f32_16x16x32_bf16 a[4:7], v[32:35], v[108:111], a[4:7]
    v_mfma_f32_16x16x32_bf16 a[8:11], v[36:39], v[104:107], a[8:11]
    v_mfma_f32_16x16x32_bf16 a[12:15], v[36:39], v[108:111], a[12:15]
    v_mfma_f32_16x16x32_bf16 a[16:19], v[40:43], v[104:107], a[16:19]
    v_mfma_f32_16x16x32_bf16 a[20:23], v[40:43], v[108:111], a[20:23]
    v_mfma_f32_16x16x32_bf16 a[24:27], v[44:47], v[104:107], a[24:27]
    v_mfma_f32_16x16x32_bf16 a[28:31], v[44:47], v[108:111], a[28:31]
    v_mfma_f32_16x16x32_bf16 a[32:35], v[48:51], v[104:107], a[32:35]
    v_mfma_f32_16x16x32_bf16 a[36:39], v[48:51], v[108:111], a[36:39]
    v_mfma_f32_16x16x32_bf16 a[40:43], v[52:55], v[104:107], a[40:43]
    v_mfma_f32_16x16x32_bf16 a[44:47], v[52:55], v[108:111], a[44:47]
    v_mfma_f32_16x16x32_bf16 a[48:51], v[56:59], v[104:107], a[48:51]
    v_mfma_f32_16x16x32_bf16 a[52:55], v[56:59], v[108:111], a[52:55]
    v_mfma_f32_16x16x32_bf16 a[56:59], v[60:63], v[104:107], a[56:59]
    v_mfma_f32_16x16x32_bf16 a[60:63], v[60:63], v[108:111], a[60:63]
    v_mfma_f32_16x16x32_bf16 a[64:67], v[64:67], v[104:107], a[64:67]
    v_mfma_f32_16x16x32_bf16 a[68:71], v[64:67], v[108:111], a[68:71]
    s_waitcnt lgkmcnt(0)
    v_mfma_f32_16x16x32_bf16 a[0:3], v[68:71], v[112:115], a[0:3]
    v_mfma_f32_16x16x32_bf16 a[4:7], v[68:71], v[116:119], a[4:7]
    v_mfma_f32_16x16x32_bf16 a[8:11], v[72:75], v[112:115], a[8:11]
    v_mfma_f32_16x16x32_bf16 a[12:15], v[72:75], v[116:119], a[12:15]
    v_mfma_f32_16x16x32_bf16 a[16:19], v[76:79], v[112:115], a[16:19]
    v_mfma_f32_16x16x32_bf16 a[20:23], v[76:79], v[116:119], a[20:23]
    v_mfma_f32_16x16x32_bf16 a[24:27], v[80:83], v[112:115], a[24:27]
    v_mfma_f32_16x16x32_bf16 a[28:31], v[80:83], v[116:119], a[28:31]
    v_mfma_f32_16x16x32_bf16 a[32:35], v[84:87], v[112:115], a[32:35]
    v_mfma_f32_16x16x32_bf16 a[36:39], v[84:87], v[116:119], a[36:39]
    v_mfma_f32_16x16x32_bf16 a[40:43], v[88:91], v[112:115], a[40:43]
    v_mfma_f32_16x16x32_bf16 a[44:47], v[88:91], v[116:119], a[44:47]
    v_mfma_f32_16x16x32_bf16 a[48:51], v[92:95], v[112:115], a[48:51]
    v_mfma_f32_16x16x32_bf16 a[52:55], v[92:95], v[116:119], a[52:55]
    v_mfma_f32_16x16x32_bf16 a[56:59], v[96:99], v[112:115], a[56:59]
    v_mfma_f32_16x16x32_bf16 a[60:63], v[96:99], v[116:119], a[60:63]
    v_mfma_f32_16x16x32_bf16 a[64:67], v[100:103], v[112:115], a[64:67]
    v_mfma_f32_16x16x32_bf16 a[68:71], v[100:103], v[116:119], a[68:71]
    s_waitcnt vmcnt(9)
    s_barrier
    ds_read_b128 v[104:107], v14 offset:0
    ds_read_b128 v[108:111], v14 offset:2048
    ds_read_b128 v[32:35], v15 offset:0
    ds_read_b128 v[36:39], v15 offset:2048
    ds_read_b128 v[40:43], v15 offset:4096
    ds_read_b128 v[44:47], v15 offset:6144
    ds_read_b128 v[48:51], v15 offset:8192
    ds_read_b128 v[52:55], v15 offset:10240
    ds_read_b128 v[56:59], v15 offset:12288
    ds_read_b128 v[60:63], v15 offset:14336
    ds_read_b128 v[64:67], v15 offset:16384
    ds_read_b128 v[112:115], v16 offset:0
    ds_read_b128 v[116:119], v16 offset:2048
    ds_read_b128 v[68:71], v17 offset:0
    ds_read_b128 v[72:75], v17 offset:2048
    ds_read_b128 v[76:79], v17 offset:4096
    ds_read_b128 v[80:83], v17 offset:6144
    ds_read_b128 v[84:87], v17 offset:8192
    ds_read_b128 v[88:91], v17 offset:10240
    ds_read_b128 v[92:95], v17 offset:12288
    ds_read_b128 v[96:99], v17 offset:14336
    ds_read_b128 v[100:103], v17 offset:16384
    s_waitcnt lgkmcnt(11)
    v_mfma_f32_16x16x32_bf16 a[0:3], v[32:35], v[104:107], a[0:3]
    v_mfma_f32_16x16x32_bf16 a[4:7], v[32:35], v[108:111], a[4:7]
    v_mfma_f32_16x16x32_bf16 a[8:11], v[36:39], v[104:107], a[8:11]
    v_mfma_f32_16x16x32_bf16 a[12:15], v[36:39], v[108:111], a[12:15]
    v_mfma_f32_16x16x32_bf16 a[16:19], v[40:43], v[104:107], a[16:19]
    v_mfma_f32_16x16x32_bf16 a[20:23], v[40:43], v[108:111], a[20:23]
    v_mfma_f32_16x16x32_bf16 a[24:27], v[44:47], v[104:107], a[24:27]
    v_mfma_f32_16x16x32_bf16 a[28:31], v[44:47], v[108:111], a[28:31]
    v_mfma_f32_16x16x32_bf16 a[32:35], v[48:51], v[104:107], a[32:35]
    v_mfma_f32_16x16x32_bf16 a[36:39], v[48:51], v[108:111], a[36:39]
    v_mfma_f32_16x16x32_bf16 a[40:43], v[52:55], v[104:107], a[40:43]
    v_mfma_f32_16x16x32_bf16 a[44:47], v[52:55], v[108:111], a[44:47]
    v_mfma_f32_16x16x32_bf16 a[48:51], v[56:59], v[104:107], a[48:51]
    v_mfma_f32_16x16x32_bf16 a[52:55], v[56:59], v[108:111], a[52:55]
    v_mfma_f32_16x16x32_bf16 a[56:59], v[60:63], v[104:107], a[56:59]
    v_mfma_f32_16x16x32_bf16 a[60:63], v[60:63], v[108:111], a[60:63]
    v_mfma_f32_16x16x32_bf16 a[64:67], v[64:67], v[104:107], a[64:67]
    v_mfma_f32_16x16x32_bf16 a[68:71], v[64:67], v[108:111], a[68:71]
    s_waitcnt lgkmcnt(0)
    v_mfma_f32_16x16x32_bf16 a[0:3], v[68:71], v[112:115], a[0:3]
    v_mfma_f32_16x16x32_bf16 a[4:7], v[68:71], v[116:119], a[4:7]
    v_mfma_f32_16x16x32_bf16 a[8:11], v[72:75], v[112:115], a[8:11]
    v_mfma_f32_16x16x32_bf16 a[12:15], v[72:75], v[116:119], a[12:15]
    v_mfma_f32_16x16x32_bf16 a[16:19], v[76:79], v[112:115], a[16:19]
    v_mfma_f32_16x16x32_bf16 a[20:23], v[76:79], v[116:119], a[20:23]
    v_mfma_f32_16x16x32_bf16 a[24:27], v[80:83], v[112:115], a[24:27]
    v_mfma_f32_16x16x32_bf16 a[28:31], v[80:83], v[116:119], a[28:31]
    v_mfma_f32_16x16x32_bf16 a[32:35], v[84:87], v[112:115], a[32:35]
    v_mfma_f32_16x16x32_bf16 a[36:39], v[84:87], v[116:119], a[36:39]
    v_mfma_f32_16x16x32_bf16 a[40:43], v[88:91], v[112:115], a[40:43]
    v_mfma_f32_16x16x32_bf16 a[44:47], v[88:91], v[116:119], a[44:47]
    v_mfma_f32_16x16x32_bf16 a[48:51], v[92:95], v[112:115], a[48:51]
    v_mfma_f32_16x16x32_bf16 a[52:55], v[92:95], v[116:119], a[52:55]
    v_mfma_f32_16x16x32_bf16 a[56:59], v[96:99], v[112:115], a[56:59]
    v_mfma_f32_16x16x32_bf16 a[60:63], v[96:99], v[116:119], a[60:63]
    v_mfma_f32_16x16x32_bf16 a[64:67], v[100:103], v[112:115], a[64:67]
    v_mfma_f32_16x16x32_bf16 a[68:71], v[100:103], v[116:119], a[68:71]
    s_waitcnt vmcnt(0)
    s_barrier
    ds_read_b128 v[104:107], v18 offset:0
    ds_read_b128 v[108:111], v18 offset:2048
    ds_read_b128 v[32:35], v19 offset:0
    ds_read_b128 v[36:39], v19 offset:2048
    ds_read_b128 v[40:43], v19 offset:4096
    ds_read_b128 v[44:47], v19 offset:6144
    ds_read_b128 v[48:51], v19 offset:8192
    ds_read_b128 v[52:55], v19 offset:10240
    ds_read_b128 v[56:59], v19 offset:12288
    ds_read_b128 v[60:63], v19 offset:14336
    ds_read_b128 v[64:67], v19 offset:16384
    ds_read_b128 v[112:115], v20 offset:0
    ds_read_b128 v[116:119], v20 offset:2048
    ds_read_b128 v[68:71], v21 offset:0
    ds_read_b128 v[72:75], v21 offset:2048
    ds_read_b128 v[76:79], v21 offset:4096
    ds_read_b128 v[80:83], v21 offset:6144
    ds_read_b128 v[84:87], v21 offset:8192
    ds_read_b128 v[88:91], v21 offset:10240
    ds_read_b128 v[92:95], v21 offset:12288
    ds_read_b128 v[96:99], v21 offset:14336
    ds_read_b128 v[100:103], v21 offset:16384
    s_waitcnt lgkmcnt(11)
    v_mfma_f32_16x16x32_bf16 a[0:3], v[32:35], v[104:107], a[0:3]
    v_mfma_f32_16x16x32_bf16 a[4:7], v[32:35], v[108:111], a[4:7]
    v_mfma_f32_16x16x32_bf16 a[8:11], v[36:39], v[104:107], a[8:11]
    v_mfma_f32_16x16x32_bf16 a[12:15], v[36:39], v[108:111], a[12:15]
    v_mfma_f32_16x16x32_bf16 a[16:19], v[40:43], v[104:107], a[16:19]
    v_mfma_f32_16x16x32_bf16 a[20:23], v[40:43], v[108:111], a[20:23]
    v_mfma_f32_16x16x32_bf16 a[24:27], v[44:47], v[104:107], a[24:27]
    v_mfma_f32_16x16x32_bf16 a[28:31], v[44:47], v[108:111], a[28:31]
    v_mfma_f32_16x16x32_bf16 a[32:35], v[48:51], v[104:107], a[32:35]
    v_mfma_f32_16x16x32_bf16 a[36:39], v[48:51], v[108:111], a[36:39]
    v_mfma_f32_16x16x32_bf16 a[40:43], v[52:55], v[104:107], a[40:43]
    v_mfma_f32_16x16x32_bf16 a[44:47], v[52:55], v[108:111], a[44:47]
    v_mfma_f32_16x16x32_bf16 a[48:51], v[56:59], v[104:107], a[48:51]
    v_mfma_f32_16x16x32_bf16 a[52:55], v[56:59], v[108:111], a[52:55]
    v_mfma_f32_16x16x32_bf16 a[56:59], v[60:63], v[104:107], a[56:59]
    v_mfma_f32_16x16x32_bf16 a[60:63], v[60:63], v[108:111], a[60:63]
    v_mfma_f32_16x16x32_bf16 a[64:67], v[64:67], v[104:107], a[64:67]
    v_mfma_f32_16x16x32_bf16 a[68:71], v[64:67], v[108:111], a[68:71]
    s_waitcnt lgkmcnt(0)
    v_mfma_f32_16x16x32_bf16 a[0:3], v[68:71], v[112:115], a[0:3]
    v_mfma_f32_16x16x32_bf16 a[4:7], v[68:71], v[116:119], a[4:7]
    v_mfma_f32_16x16x32_bf16 a[8:11], v[72:75], v[112:115], a[8:11]
    v_mfma_f32_16x16x32_bf16 a[12:15], v[72:75], v[116:119], a[12:15]
    v_mfma_f32_16x16x32_bf16 a[16:19], v[76:79], v[112:115], a[16:19]
    v_mfma_f32_16x16x32_bf16 a[20:23], v[76:79], v[116:119], a[20:23]
    v_mfma_f32_16x16x32_bf16 a[24:27], v[80:83], v[112:115], a[24:27]
    v_mfma_f32_16x16x32_bf16 a[28:31], v[80:83], v[116:119], a[28:31]
    v_mfma_f32_16x16x32_bf16 a[32:35], v[84:87], v[112:115], a[32:35]
    v_mfma_f32_16x16x32_bf16 a[36:39], v[84:87], v[116:119], a[36:39]
    v_mfma_f32_16x16x32_bf16 a[40:43], v[88:91], v[112:115], a[40:43]
    v_mfma_f32_16x16x32_bf16 a[44:47], v[88:91], v[116:119], a[44:47]
    v_mfma_f32_16x16x32_bf16 a[48:51], v[92:95], v[112:115], a[48:51]
    v_mfma_f32_16x16x32_bf16 a[52:55], v[92:95], v[116:119], a[52:55]
    v_mfma_f32_16x16x32_bf16 a[56:59], v[96:99], v[112:115], a[56:59]
    v_mfma_f32_16x16x32_bf16 a[60:63], v[96:99], v[116:119], a[60:63]
    v_mfma_f32_16x16x32_bf16 a[64:67], v[100:103], v[112:115], a[64:67]
    v_mfma_f32_16x16x32_bf16 a[68:71], v[100:103], v[116:119], a[68:71]
    s_nop 7
    s_nop 3
    s_lshl_b32 s29, s18, 11
    s_lshl_b32 s30, s13, 7
    s_add_u32 s29, s29, s30
    s_lshl_b32 s30, s12, 5
    s_add_u32 s29, s29, s30
    s_mul_i32 s29, s29, 2304
    s_mul_i32 s30, s17, 576
    s_add_u32 s29, s29, s30
    s_add_u32 s29, s29, 43827200
    v_mul_u32_u24 v8, 2304, v3
    v_lshl_add_u32 v8, v4, 4, v8
    v_add_u32 v8, s29, v8

    v_accvgpr_read_b32 v24, a0
    v_accvgpr_read_b32 v25, a1
    v_accvgpr_read_b32 v26, a2
    v_accvgpr_read_b32 v27, a3
    v_add_u32 v29, 0, v8
    buffer_store_dwordx4 v[24:27], v29, s[8:11], 0 offen
    s_nop 1

    v_accvgpr_read_b32 v24, a4
    v_accvgpr_read_b32 v25, a5
    v_accvgpr_read_b32 v26, a6
    v_accvgpr_read_b32 v27, a7
    v_add_u32 v29, 36864, v8
    buffer_store_dwordx4 v[24:27], v29, s[8:11], 0 offen
    s_nop 1

    v_accvgpr_read_b32 v24, a8
    v_accvgpr_read_b32 v25, a9
    v_accvgpr_read_b32 v26, a10
    v_accvgpr_read_b32 v27, a11
    v_add_u32 v29, 64, v8
    buffer_store_dwordx4 v[24:27], v29, s[8:11], 0 offen
    s_nop 1

    v_accvgpr_read_b32 v24, a12
    v_accvgpr_read_b32 v25, a13
    v_accvgpr_read_b32 v26, a14
    v_accvgpr_read_b32 v27, a15
    v_add_u32 v29, 36928, v8
    buffer_store_dwordx4 v[24:27], v29, s[8:11], 0 offen
    s_nop 1

    v_accvgpr_read_b32 v24, a16
    v_accvgpr_read_b32 v25, a17
    v_accvgpr_read_b32 v26, a18
    v_accvgpr_read_b32 v27, a19
    v_add_u32 v29, 128, v8
    buffer_store_dwordx4 v[24:27], v29, s[8:11], 0 offen
    s_nop 1

    v_accvgpr_read_b32 v24, a20
    v_accvgpr_read_b32 v25, a21
    v_accvgpr_read_b32 v26, a22
    v_accvgpr_read_b32 v27, a23
    v_add_u32 v29, 36992, v8
    buffer_store_dwordx4 v[24:27], v29, s[8:11], 0 offen
    s_nop 1

    v_accvgpr_read_b32 v24, a24
    v_accvgpr_read_b32 v25, a25
    v_accvgpr_read_b32 v26, a26
    v_accvgpr_read_b32 v27, a27
    v_add_u32 v29, 192, v8
    buffer_store_dwordx4 v[24:27], v29, s[8:11], 0 offen
    s_nop 1

    v_accvgpr_read_b32 v24, a28
    v_accvgpr_read_b32 v25, a29
    v_accvgpr_read_b32 v26, a30
    v_accvgpr_read_b32 v27, a31
    v_add_u32 v29, 37056, v8
    buffer_store_dwordx4 v[24:27], v29, s[8:11], 0 offen
    s_nop 1

    v_accvgpr_read_b32 v24, a32
    v_accvgpr_read_b32 v25, a33
    v_accvgpr_read_b32 v26, a34
    v_accvgpr_read_b32 v27, a35
    v_add_u32 v29, 256, v8
    buffer_store_dwordx4 v[24:27], v29, s[8:11], 0 offen
    s_nop 1

    v_accvgpr_read_b32 v24, a36
    v_accvgpr_read_b32 v25, a37
    v_accvgpr_read_b32 v26, a38
    v_accvgpr_read_b32 v27, a39
    v_add_u32 v29, 37120, v8
    buffer_store_dwordx4 v[24:27], v29, s[8:11], 0 offen
    s_nop 1

    v_accvgpr_read_b32 v24, a40
    v_accvgpr_read_b32 v25, a41
    v_accvgpr_read_b32 v26, a42
    v_accvgpr_read_b32 v27, a43
    v_add_u32 v29, 320, v8
    buffer_store_dwordx4 v[24:27], v29, s[8:11], 0 offen
    s_nop 1

    v_accvgpr_read_b32 v24, a44
    v_accvgpr_read_b32 v25, a45
    v_accvgpr_read_b32 v26, a46
    v_accvgpr_read_b32 v27, a47
    v_add_u32 v29, 37184, v8
    buffer_store_dwordx4 v[24:27], v29, s[8:11], 0 offen
    s_nop 1

    v_accvgpr_read_b32 v24, a48
    v_accvgpr_read_b32 v25, a49
    v_accvgpr_read_b32 v26, a50
    v_accvgpr_read_b32 v27, a51
    v_add_u32 v29, 384, v8
    buffer_store_dwordx4 v[24:27], v29, s[8:11], 0 offen
    s_nop 1

    v_accvgpr_read_b32 v24, a52
    v_accvgpr_read_b32 v25, a53
    v_accvgpr_read_b32 v26, a54
    v_accvgpr_read_b32 v27, a55
    v_add_u32 v29, 37248, v8
    buffer_store_dwordx4 v[24:27], v29, s[8:11], 0 offen
    s_nop 1

    v_accvgpr_read_b32 v24, a56
    v_accvgpr_read_b32 v25, a57
    v_accvgpr_read_b32 v26, a58
    v_accvgpr_read_b32 v27, a59
    v_add_u32 v29, 448, v8
    buffer_store_dwordx4 v[24:27], v29, s[8:11], 0 offen
    s_nop 1

    v_accvgpr_read_b32 v24, a60
    v_accvgpr_read_b32 v25, a61
    v_accvgpr_read_b32 v26, a62
    v_accvgpr_read_b32 v27, a63
    v_add_u32 v29, 37312, v8
    buffer_store_dwordx4 v[24:27], v29, s[8:11], 0 offen
    s_nop 1

    v_accvgpr_read_b32 v24, a64
    v_accvgpr_read_b32 v25, a65
    v_accvgpr_read_b32 v26, a66
    v_accvgpr_read_b32 v27, a67
    v_add_u32 v29, 512, v8
    buffer_store_dwordx4 v[24:27], v29, s[8:11], 0 offen
    s_nop 1

    v_accvgpr_read_b32 v24, a68
    v_accvgpr_read_b32 v25, a69
    v_accvgpr_read_b32 v26, a70
    v_accvgpr_read_b32 v27, a71
    v_add_u32 v29, 37376, v8
    buffer_store_dwordx4 v[24:27], v29, s[8:11], 0 offen
    s_nop 1

L_g2_end:
    s_endpgm

.globl reduce_kernel
.p2align 8
.type reduce_kernel,@function
reduce_kernel:
    s_cmp_ge_u32 s2, 576
    s_cbranch_scc1 L_red_end
    s_load_dwordx2 s[4:5], s[0:1], 128
    s_load_dwordx2 s[6:7], s[0:1], 112
    s_waitcnt lgkmcnt(0)

    s_add_u32 s8, s4, 43827200
    s_addc_u32 s9, s5, 0
    s_mov_b32 s10, 18874368
    s_mov_b32 s11, 0x00020000
    s_add_u32 s12, s4, 20234240
    s_addc_u32 s13, s5, 0
    s_mov_b32 s14, 2359296
    s_mov_b32 s15, 0x00020000
    s_mov_b32 s16, s4
    s_mov_b32 s17, s5
    s_mov_b32 s18, 13824
    s_mov_b32 s19, 0x00020000
    s_mov_b32 s20, s6
    s_mov_b32 s21, s7
    s_mov_b32 s22, 2359296
    s_mov_b32 s23, 0x00020000
    s_lshl_b32 s24, s2, 8
    v_add_u32 v1, s24, v0
    v_lshlrev_b32 v2, 5, v1
    v_lshlrev_b32 v3, 4, v1
    s_mov_b32 s25, 59652324
    v_mul_hi_u32 v4, v1, s25
    v_mul_u32_u24 v4, 72, v4
    v_sub_u32 v4, v1, v4
    v_lshlrev_b32 v4, 5, v4
    v_add_u32 v4, 11520, v4

    v_add_u32 v5, 0, v2
    buffer_load_dwordx4 v[10:13], v5, s[8:11], 0 offen
    buffer_load_dwordx4 v[14:17], v5, s[8:11], 0 offen offset:16
    v_add_u32 v5, 4718592, v2
    buffer_load_dwordx4 v[18:21], v5, s[8:11], 0 offen
    buffer_load_dwordx4 v[22:25], v5, s[8:11], 0 offen offset:16
    v_add_u32 v5, 9437184, v2
    buffer_load_dwordx4 v[26:29], v5, s[8:11], 0 offen
    buffer_load_dwordx4 v[30:33], v5, s[8:11], 0 offen offset:16
    v_add_u32 v5, 14155776, v2
    buffer_load_dwordx4 v[34:37], v5, s[8:11], 0 offen
    buffer_load_dwordx4 v[38:41], v5, s[8:11], 0 offen offset:16
    buffer_load_dwordx4 v[44:47], v3, s[12:15], 0 offen
    buffer_load_dwordx4 v[48:51], v4, s[16:19], 0 offen
    buffer_load_dwordx4 v[52:55], v4, s[16:19], 0 offen offset:16
    s_mov_b32 s26, 0xffff0000
    s_waitcnt vmcnt(0)

    v_add_f32 v10, v10, v18
    v_add_f32 v26, v26, v34
    v_add_f32 v10, v10, v26
    v_cvt_pk_bf16_f32 v10, v10, v10
    v_lshlrev_b32 v10, 16, v10
    v_mul_f32 v10, v48, v10
    v_cvt_pk_bf16_f32 v10, v10, v10
    v_lshlrev_b32 v10, 16, v10
    v_lshlrev_b32 v56, 16, v44
    v_add_f32 v10, v56, v10
    v_add_f32 v11, v11, v19
    v_add_f32 v27, v27, v35
    v_add_f32 v11, v11, v27
    v_cvt_pk_bf16_f32 v11, v11, v11
    v_lshlrev_b32 v11, 16, v11
    v_mul_f32 v11, v49, v11
    v_cvt_pk_bf16_f32 v11, v11, v11
    v_lshlrev_b32 v11, 16, v11
    v_and_b32 v56, s26, v44
    v_add_f32 v11, v56, v11
    v_add_f32 v12, v12, v20
    v_add_f32 v28, v28, v36
    v_add_f32 v12, v12, v28
    v_cvt_pk_bf16_f32 v12, v12, v12
    v_lshlrev_b32 v12, 16, v12
    v_mul_f32 v12, v50, v12
    v_cvt_pk_bf16_f32 v12, v12, v12
    v_lshlrev_b32 v12, 16, v12
    v_lshlrev_b32 v56, 16, v45
    v_add_f32 v12, v56, v12
    v_add_f32 v13, v13, v21
    v_add_f32 v29, v29, v37
    v_add_f32 v13, v13, v29
    v_cvt_pk_bf16_f32 v13, v13, v13
    v_lshlrev_b32 v13, 16, v13
    v_mul_f32 v13, v51, v13
    v_cvt_pk_bf16_f32 v13, v13, v13
    v_lshlrev_b32 v13, 16, v13
    v_and_b32 v56, s26, v45
    v_add_f32 v13, v56, v13
    v_add_f32 v14, v14, v22
    v_add_f32 v30, v30, v38
    v_add_f32 v14, v14, v30
    v_cvt_pk_bf16_f32 v14, v14, v14
    v_lshlrev_b32 v14, 16, v14
    v_mul_f32 v14, v52, v14
    v_cvt_pk_bf16_f32 v14, v14, v14
    v_lshlrev_b32 v14, 16, v14
    v_lshlrev_b32 v56, 16, v46
    v_add_f32 v14, v56, v14
    v_add_f32 v15, v15, v23
    v_add_f32 v31, v31, v39
    v_add_f32 v15, v15, v31
    v_cvt_pk_bf16_f32 v15, v15, v15
    v_lshlrev_b32 v15, 16, v15
    v_mul_f32 v15, v53, v15
    v_cvt_pk_bf16_f32 v15, v15, v15
    v_lshlrev_b32 v15, 16, v15
    v_and_b32 v56, s26, v46
    v_add_f32 v15, v56, v15
    v_add_f32 v16, v16, v24
    v_add_f32 v32, v32, v40
    v_add_f32 v16, v16, v32
    v_cvt_pk_bf16_f32 v16, v16, v16
    v_lshlrev_b32 v16, 16, v16
    v_mul_f32 v16, v54, v16
    v_cvt_pk_bf16_f32 v16, v16, v16
    v_lshlrev_b32 v16, 16, v16
    v_lshlrev_b32 v56, 16, v47
    v_add_f32 v16, v56, v16
    v_add_f32 v17, v17, v25
    v_add_f32 v33, v33, v41
    v_add_f32 v17, v17, v33
    v_cvt_pk_bf16_f32 v17, v17, v17
    v_lshlrev_b32 v17, 16, v17
    v_mul_f32 v17, v55, v17
    v_cvt_pk_bf16_f32 v17, v17, v17
    v_lshlrev_b32 v17, 16, v17
    v_and_b32 v56, s26, v47
    v_add_f32 v17, v56, v17
    v_cvt_pk_bf16_f32 v60, v10, v11
    v_cvt_pk_bf16_f32 v61, v12, v13
    v_cvt_pk_bf16_f32 v62, v14, v15
    v_cvt_pk_bf16_f32 v63, v16, v17
    buffer_store_dwordx4 v[60:63], v3, s[20:23], 0 offen
L_red_end:
    s_endpgm

.section .rodata,"a"
.p2align 6
.amdhsa_kernel prep_kernel
  .amdhsa_next_free_vgpr 128
  .amdhsa_next_free_sgpr 72
  .amdhsa_accum_offset 128
  .amdhsa_group_segment_fixed_size 0
  .amdhsa_kernarg_size 136
  .amdhsa_user_sgpr_count 2
  .amdhsa_user_sgpr_kernarg_segment_ptr 1
  .amdhsa_system_sgpr_workgroup_id_x 1
.end_amdhsa_kernel
.p2align 6
.amdhsa_kernel conv_kernel
  .amdhsa_next_free_vgpr 208
  .amdhsa_next_free_sgpr 48
  .amdhsa_accum_offset 208
  .amdhsa_group_segment_fixed_size 0
  .amdhsa_kernarg_size 136
  .amdhsa_user_sgpr_count 2
  .amdhsa_user_sgpr_kernarg_segment_ptr 1
  .amdhsa_system_sgpr_workgroup_id_x 1
.end_amdhsa_kernel
.p2align 6
.amdhsa_kernel ln2_kernel
  .amdhsa_next_free_vgpr 224
  .amdhsa_next_free_sgpr 72
  .amdhsa_accum_offset 224
  .amdhsa_group_segment_fixed_size 0
  .amdhsa_kernarg_size 136
  .amdhsa_user_sgpr_count 2
  .amdhsa_user_sgpr_kernarg_segment_ptr 1
  .amdhsa_system_sgpr_workgroup_id_x 1
.end_amdhsa_kernel
.p2align 6
.amdhsa_kernel gemm1_kernel
  .amdhsa_next_free_vgpr 280
  .amdhsa_next_free_sgpr 90
  .amdhsa_accum_offset 136
  .amdhsa_group_segment_fixed_size 0
  .amdhsa_kernarg_size 136
  .amdhsa_user_sgpr_count 2
  .amdhsa_user_sgpr_kernarg_segment_ptr 1
  .amdhsa_system_sgpr_workgroup_id_x 1
.end_amdhsa_kernel
.p2align 6
.amdhsa_kernel gemm2_kernel
  .amdhsa_next_free_vgpr 192
  .amdhsa_next_free_sgpr 90
  .amdhsa_accum_offset 120
  .amdhsa_group_segment_fixed_size 0
  .amdhsa_kernarg_size 136
  .amdhsa_user_sgpr_count 2
  .amdhsa_user_sgpr_kernarg_segment_ptr 1
  .amdhsa_system_sgpr_workgroup_id_x 1
.end_amdhsa_kernel
.p2align 6
.amdhsa_kernel reduce_kernel
  .amdhsa_next_free_vgpr 64
  .amdhsa_next_free_sgpr 32
  .amdhsa_accum_offset 64
  .amdhsa_group_segment_fixed_size 0
  .amdhsa_kernarg_size 136
  .amdhsa_user_sgpr_count 2
  .amdhsa_user_sgpr_kernarg_segment_ptr 1
  .amdhsa_system_sgpr_workgroup_id_x 1
.end_amdhsa_kernel
```
